```python
import torch

def _softmax(x, axis=-1):
    return torch.softmax(x, dim=axis)

def _gelu(x):
    return torch.nn.functional.gelu(x, approximate='tanh')

def _silu(x):
    return torch.nn.functional.silu(x)

def _sigmoid(x):
    return torch.sigmoid(x)

def _layernorm(x, axis=-1, eps=1e-05):
    m = x.mean(dim=axis, keepdim=True)
    v = x.var(dim=axis, keepdim=True, unbiased=False)
    return (x - m) / torch.sqrt(v + eps)

def _scatter_add(tgt, idx, src, axis=0):
    return tgt.clone().index_add_(axis, idx, src)

def _segment_sum(src, seg, n):
    out = torch.zeros((n,) + src.shape[1:], dtype=src.dtype)
    return out.index_add_(0, seg, src)

def _pad(x, pw):
    flat = tuple((v for pair in reversed(pw) for v in pair))
    return torch.nn.functional.pad(x, flat)
kernel_name = 'sequential_preLN__memory_aug_recurrent_mem_tr__glu_gated_geglu__prompt'

def setup_inputs():

    _w = lambda a: (lambda t: t.to(torch.bfloat16) if t.is_floating_point() else t)(torch.as_tensor(a))

    def _A_setup():
        B, S, Dm = (1, 2048, 640)
        H, Dh = (32, 192)
        M, seg = (8, 32)
        seg = min(seg, S)
        S = S // seg * seg
        return {'x': _w((lambda *s: torch.randn(*s, dtype=torch.bfloat16) * 0.05)(B, S, Dm)), 'mem0': _w((lambda *s: torch.randn(*s, dtype=torch.bfloat16) * 0.2)(B, M, Dm)), 'Wq': _w((lambda *s: torch.randn(*s, dtype=torch.bfloat16) * 1.6)(Dm, H, Dh) * Dm ** (-0.5)), 'Wk': _w((lambda *s: torch.randn(*s, dtype=torch.bfloat16) * 1.6)(Dm, H, Dh) * Dm ** (-0.5)), 'Wv': _w((lambda *s: torch.randn(*s, dtype=torch.bfloat16) * 0.2)(Dm, H, Dh) * Dm ** (-0.5)), 'Wo': _w((lambda *s: torch.randn(*s, dtype=torch.bfloat16) * 0.2)(H, Dh, Dm) * (H * Dh) ** (-0.5)), 'seg_len': seg}
    _A_in = _A_setup()

    def _B_setup():
        B, S, Dm, Df = (1, 2048, 640, 1536)
        return {'x': _w((lambda *s: torch.randn(*s, dtype=torch.bfloat16) * 0.05)(B, S, Dm)), 'w_gate': _w((lambda *s: torch.randn(*s, dtype=torch.bfloat16) * 0.4)(Dm, Df) * Dm ** (-0.5)), 'w_up': _w((lambda *s: torch.randn(*s, dtype=torch.bfloat16) * 0.4)(Dm, Df) * Dm ** (-0.5)), 'w_down': _w((lambda *s: torch.randn(*s, dtype=torch.bfloat16) * 0.4)(Df, Dm) * Df ** (-0.5))}
    _B_in = _B_setup()
    return {'A_x': _A_in['x'], 'A_mem0': _A_in['mem0'], 'A_Wq': _A_in['Wq'], 'A_Wk': _A_in['Wk'], 'A_Wv': _A_in['Wv'], 'A_Wo': _A_in['Wo'], 'A_seg_len': _A_in['seg_len'], 'B_x': _B_in['x'], 'B_w_gate': _B_in['w_gate'], 'B_w_up': _B_in['w_up'], 'B_w_down': _B_in['w_down']}

def reference(A_x, A_mem0, A_Wq, A_Wk, A_Wv, A_Wo, A_seg_len, B_x, B_w_gate, B_w_up, B_w_down):

    def _A_ref(x, mem0, Wq, Wk, Wv, Wo, seg_len):
        B, S, Dm = x.shape
        H, Dh = (Wq.shape[1], Wq.shape[2])
        M = mem0.shape[1]
        scale = Dh ** (-0.5)
        n_seg = S // seg_len
        L = M + seg_len
        idx = torch.arange(L)
        mask = (idx[:, None] < M) | (idx[:, None] >= idx[None, :])
        mem = mem0
        outs = []
        for s in range(n_seg):
            xs = x[:, s * seg_len:(s + 1) * seg_len, :].clone()
            h = torch.concatenate([mem, xs], axis=1)
            q = torch.einsum('btd,dhe->bhte', h, Wq)
            k = torch.einsum('btd,dhe->bhte', h, Wk)
            v = torch.einsum('btd,dhe->bhte', h, Wv)
            scores = torch.einsum('bhqe,bhke->bhqk', q, k) * scale
            scores = torch.where(mask[None, None], scores, -1000000000.0)
            p = _softmax(scores, axis=-1)
            o = torch.einsum('bhqk,bhke->bhqe', p, v)
            o = torch.einsum('bhte,hed->btd', o, Wo)
            mem = o[:, :M, :].clone()
            outs.append(o[:, M:, :])
        return torch.concatenate(outs, axis=1)

    def _B_ref(x, w_gate, w_up, w_down):
        g = torch.einsum('bsd,df->bsf', x, w_gate)
        u = torch.einsum('bsd,df->bsf', x, w_up)
        h = _gelu(g) * u
        return torch.einsum('bsf,fd->bsd', h, w_down)
    x = A_x
    h = x + _A_ref(_layernorm(x, axis=-1), A_mem0, A_Wq, A_Wk, A_Wv, A_Wo, A_seg_len)
    h2 = h + _B_ref(_layernorm(h, axis=-1), B_w_gate, B_w_up, B_w_down)
    return h2
```

```asm
; @launch kernel=prep_kernel grid=(5213,1,1) block=(256,1,1) lds=8448
; @launch kernel=chain_kernel grid=(256,1,1) block=(512,1,1) lds=147456
; @launch kernel=p3_kernel grid=(512,1,1) block=(256,1,1) lds=0
; @launch kernel=p4_kernel grid=(240,1,1) block=(256,1,1) lds=131072
; @launch kernel=red_kernel grid=(512,1,1) block=(256,1,1) lds=0
; @launch kernel=p5_kernel grid=(384,1,1) block=(256,1,1) lds=65536
; @launch kernel=p6_kernel grid=(160,1,1) block=(256,1,1) lds=131072
.amdgcn_target "amdgcn-amd-amdhsa--gfx950"
.text
.globl prep_kernel
.p2align 8
.type prep_kernel,@function
prep_kernel:
    s_load_dwordx2 s[4:5], s[0:1], 104
    s_cmp_ge_u32 s2, 5213
    s_cbranch_scc1 prep_end
    v_and_b32 v1, 63, v0
    v_lshrrev_b32 v2, 6, v0
    s_nop 0
    v_readfirstlane_b32 s3, v2
    s_cmp_ge_u32 s2, 512
    s_cbranch_scc1 prep_not_ln
    s_load_dwordx2 s[6:7], s[0:1], 0
    s_waitcnt lgkmcnt(0)
    s_add_u32 s8, s6, 0x0
    s_addc_u32 s9, s7, 0
    s_and_b32 s9, s9, 0xffff
    s_mov_b32 s10, 0x280000
    s_mov_b32 s11, 0x20000
    s_add_u32 s12, s4, 0x0
    s_addc_u32 s13, s5, 0
    s_and_b32 s13, s13, 0xffff
    s_mov_b32 s14, 0x280000
    s_mov_b32 s15, 0x20000
    s_lshl_b32 s16, s2, 2
    s_add_u32 s16, s16, s3
    s_mul_i32 s16, s16, 1280
    v_lshlrev_b32 v3, 2, v1
    buffer_load_dword v10, v3, s[8:11], s16 offen offset:0
    buffer_load_dword v11, v3, s[8:11], s16 offen offset:256
    buffer_load_dword v12, v3, s[8:11], s16 offen offset:512
    buffer_load_dword v13, v3, s[8:11], s16 offen offset:768
    buffer_load_dword v14, v3, s[8:11], s16 offen offset:1024
    s_waitcnt vmcnt(0)
    v_lshlrev_b32 v20, 16, v10
    v_and_b32 v21, 0xffff0000, v10
    v_lshlrev_b32 v22, 16, v11
    v_and_b32 v23, 0xffff0000, v11
    v_lshlrev_b32 v24, 16, v12
    v_and_b32 v25, 0xffff0000, v12
    v_lshlrev_b32 v26, 16, v13
    v_and_b32 v27, 0xffff0000, v13
    v_lshlrev_b32 v28, 16, v14
    v_and_b32 v29, 0xffff0000, v14
    v_add_f32 v4, v20, v21
    v_add_f32 v4, v4, v22
    v_add_f32 v4, v4, v23
    v_add_f32 v4, v4, v24
    v_add_f32 v4, v4, v25
    v_add_f32 v4, v4, v26
    v_add_f32 v4, v4, v27
    v_add_f32 v4, v4, v28
    v_add_f32 v4, v4, v29
    ds_swizzle_b32 v5, v4 offset:0x41f
    s_waitcnt lgkmcnt(0)
    v_add_f32 v4, v4, v5
    ds_swizzle_b32 v5, v4 offset:0x81f
    s_waitcnt lgkmcnt(0)
    v_add_f32 v4, v4, v5
    ds_swizzle_b32 v5, v4 offset:0x101f
    s_waitcnt lgkmcnt(0)
    v_add_f32 v4, v4, v5
    ds_swizzle_b32 v5, v4 offset:0x201f
    s_waitcnt lgkmcnt(0)
    v_add_f32 v4, v4, v5
    ds_swizzle_b32 v5, v4 offset:0x401f
    s_waitcnt lgkmcnt(0)
    v_add_f32 v4, v4, v5
    s_nop 1
    v_readlane_b32 s20, v4, 0
    v_readlane_b32 s21, v4, 32
    s_nop 3
    v_mov_b32 v4, s20
    v_add_f32 v4, s21, v4
    v_mul_f32 v4, 0x3acccccd, v4
    v_sub_f32 v5, v20, v4
    v_mul_f32 v6, v5, v5
    v_sub_f32 v5, v21, v4
    v_fmac_f32 v6, v5, v5
    v_sub_f32 v5, v22, v4
    v_fmac_f32 v6, v5, v5
    v_sub_f32 v5, v23, v4
    v_fmac_f32 v6, v5, v5
    v_sub_f32 v5, v24, v4
    v_fmac_f32 v6, v5, v5
    v_sub_f32 v5, v25, v4
    v_fmac_f32 v6, v5, v5
    v_sub_f32 v5, v26, v4
    v_fmac_f32 v6, v5, v5
    v_sub_f32 v5, v27, v4
    v_fmac_f32 v6, v5, v5
    v_sub_f32 v5, v28, v4
    v_fmac_f32 v6, v5, v5
    v_sub_f32 v5, v29, v4
    v_fmac_f32 v6, v5, v5
    ds_swizzle_b32 v5, v6 offset:0x41f
    s_waitcnt lgkmcnt(0)
    v_add_f32 v6, v6, v5
    ds_swizzle_b32 v5, v6 offset:0x81f
    s_waitcnt lgkmcnt(0)
    v_add_f32 v6, v6, v5
    ds_swizzle_b32 v5, v6 offset:0x101f
    s_waitcnt lgkmcnt(0)
    v_add_f32 v6, v6, v5
    ds_swizzle_b32 v5, v6 offset:0x201f
    s_waitcnt lgkmcnt(0)
    v_add_f32 v6, v6, v5
    ds_swizzle_b32 v5, v6 offset:0x401f
    s_waitcnt lgkmcnt(0)
    v_add_f32 v6, v6, v5
    s_nop 1
    v_readlane_b32 s20, v6, 0
    v_readlane_b32 s21, v6, 32
    s_nop 3
    v_mov_b32 v6, s20
    v_add_f32 v6, s21, v6
    v_mul_f32 v6, 0x3acccccd, v6
    v_cvt_pk_bf16_f32 v5, v4, v4
    v_lshlrev_b32 v4, 16, v5
    v_cvt_pk_bf16_f32 v5, v6, v6
    v_lshlrev_b32 v6, 16, v5
    v_add_f32 v6, 0x3727c5ac, v6
    v_cvt_pk_bf16_f32 v5, v6, v6
    v_lshlrev_b32 v6, 16, v5
    v_sqrt_f32 v6, v6
    s_nop 0
    v_cvt_pk_bf16_f32 v5, v6, v6
    v_lshlrev_b32 v6, 16, v5
    v_rcp_f32 v7, v6
    s_nop 0
    v_sub_f32 v20, v20, v4
    v_cvt_pk_bf16_f32 v5, v20, v20
    v_lshlrev_b32 v20, 16, v5
    v_mul_f32 v5, v20, v7
    v_fma_f32 v20, -v5, v6, v20
    v_fmac_f32 v5, v20, v7
    v_mov_b32 v20, v5
    v_sub_f32 v21, v21, v4
    v_cvt_pk_bf16_f32 v5, v21, v21
    v_lshlrev_b32 v21, 16, v5
    v_mul_f32 v5, v21, v7
    v_fma_f32 v21, -v5, v6, v21
    v_fmac_f32 v5, v21, v7
    v_mov_b32 v21, v5
    v_sub_f32 v22, v22, v4
    v_cvt_pk_bf16_f32 v5, v22, v22
    v_lshlrev_b32 v22, 16, v5
    v_mul_f32 v5, v22, v7
    v_fma_f32 v22, -v5, v6, v22
    v_fmac_f32 v5, v22, v7
    v_mov_b32 v22, v5
    v_sub_f32 v23, v23, v4
    v_cvt_pk_bf16_f32 v5, v23, v23
    v_lshlrev_b32 v23, 16, v5
    v_mul_f32 v5, v23, v7
    v_fma_f32 v23, -v5, v6, v23
    v_fmac_f32 v5, v23, v7
    v_mov_b32 v23, v5
    v_sub_f32 v24, v24, v4
    v_cvt_pk_bf16_f32 v5, v24, v24
    v_lshlrev_b32 v24, 16, v5
    v_mul_f32 v5, v24, v7
    v_fma_f32 v24, -v5, v6, v24
    v_fmac_f32 v5, v24, v7
    v_mov_b32 v24, v5
    v_sub_f32 v25, v25, v4
    v_cvt_pk_bf16_f32 v5, v25, v25
    v_lshlrev_b32 v25, 16, v5
    v_mul_f32 v5, v25, v7
    v_fma_f32 v25, -v5, v6, v25
    v_fmac_f32 v5, v25, v7
    v_mov_b32 v25, v5
    v_sub_f32 v26, v26, v4
    v_cvt_pk_bf16_f32 v5, v26, v26
    v_lshlrev_b32 v26, 16, v5
    v_mul_f32 v5, v26, v7
    v_fma_f32 v26, -v5, v6, v26
    v_fmac_f32 v5, v26, v7
    v_mov_b32 v26, v5
    v_sub_f32 v27, v27, v4
    v_cvt_pk_bf16_f32 v5, v27, v27
    v_lshlrev_b32 v27, 16, v5
    v_mul_f32 v5, v27, v7
    v_fma_f32 v27, -v5, v6, v27
    v_fmac_f32 v5, v27, v7
    v_mov_b32 v27, v5
    v_sub_f32 v28, v28, v4
    v_cvt_pk_bf16_f32 v5, v28, v28
    v_lshlrev_b32 v28, 16, v5
    v_mul_f32 v5, v28, v7
    v_fma_f32 v28, -v5, v6, v28
    v_fmac_f32 v5, v28, v7
    v_mov_b32 v28, v5
    v_sub_f32 v29, v29, v4
    v_cvt_pk_bf16_f32 v5, v29, v29
    v_lshlrev_b32 v29, 16, v5
    v_mul_f32 v5, v29, v7
    v_fma_f32 v29, -v5, v6, v29
    v_fmac_f32 v5, v29, v7
    v_mov_b32 v29, v5
    s_lshl_b32 s16, s2, 2
    s_add_u32 s16, s16, s3
    s_lshr_b32 s17, s16, 4
    s_mul_i32 s17, s17, 20480
    s_and_b32 s16, s16, 15
    s_lshl_b32 s16, s16, 4
    s_add_u32 s16, s16, s17
    v_lshrrev_b32 v4, 4, v1
    v_lshlrev_b32 v4, 10, v4
    v_bfe_u32 v5, v1, 2, 2
    v_lshl_add_u32 v4, v5, 8, v4
    v_and_b32 v5, 3, v1
    v_lshl_add_u32 v4, v5, 2, v4
    v_cvt_pk_bf16_f32 v10, v20, v21
    buffer_store_dword v10, v4, s[12:15], s16 offen
    s_add_u32 s16, s16, 4096
    v_cvt_pk_bf16_f32 v11, v22, v23
    buffer_store_dword v11, v4, s[12:15], s16 offen
    s_add_u32 s16, s16, 4096
    v_cvt_pk_bf16_f32 v12, v24, v25
    buffer_store_dword v12, v4, s[12:15], s16 offen
    s_add_u32 s16, s16, 4096
    v_cvt_pk_bf16_f32 v13, v26, v27
    buffer_store_dword v13, v4, s[12:15], s16 offen
    s_add_u32 s16, s16, 4096
    v_cvt_pk_bf16_f32 v14, v28, v29
    buffer_store_dword v14, v4, s[12:15], s16 offen
    s_add_u32 s16, s16, 4096
    s_branch prep_end
prep_not_ln:
    s_sub_u32 s16, s2, 512
    s_cmp_ge_u32 s16, 4560
    s_cbranch_scc1 prep_not_tr
    s_cmp_ge_u32 s16, 2880
    s_cbranch_scc1 prep_tr_wo
    s_mov_b32 s25, 0x444445
    s_mul_hi_u32 s26, s16, s25
    s_mul_i32 s27, s26, 960
    s_sub_u32 s16, s16, s27
    s_lshl_b32 s27, s26, 3
    s_add_u32 s27, s27, 16
    s_load_dwordx2 s[6:7], s[0:1], s27
    s_mov_b32 s25, 0x2aaaaab
    s_mul_hi_u32 s20, s16, s25
    s_mul_i32 s27, s20, 96
    s_sub_u32 s21, s16, s27
    s_mov_b32 s17, 7864320
    s_mov_b32 s18, 12288
    s_mov_b32 s19, 1280
    s_mul_i32 s22, s26, 7864320
    s_add_u32 s22, s22, 2621440
    s_mov_b32 s23, 7864320
    s_mov_b32 s24, 0
    s_branch prep_tr_go
prep_tr_wo:
    s_cmp_ge_u32 s16, 3840
    s_cbranch_scc1 prep_tr_gu
    s_sub_u32 s16, s16, 2880
    s_load_dwordx2 s[6:7], s[0:1], 40
    s_mov_b32 s25, 0x1999999a
    s_mul_hi_u32 s20, s16, s25
    s_mul_i32 s27, s20, 10
    s_sub_u32 s21, s16, s27
    s_mov_b32 s17, 7864320
    s_mov_b32 s18, 1280
    s_mov_b32 s19, 12288
    s_mov_b32 s22, 26214400
    s_mov_b32 s23, 7864320
    s_mov_b32 s24, 0
    s_branch prep_tr_go
prep_tr_gu:
    s_cmp_ge_u32 s16, 4320
    s_cbranch_scc1 prep_tr_wd
    s_sub_u32 s16, s16, 3840
    s_mov_b32 s24, 1
    s_mov_b32 s27, 64
    s_cmp_ge_u32 s16, 240
    s_cselect_b32 s24, 2, 1
    s_cselect_b32 s27, 72, 64
    s_cselect_b32 s26, 240, 0
    s_sub_u32 s16, s16, s26
    s_load_dwordx2 s[6:7], s[0:1], s27
    s_mov_b32 s25, 0xaaaaaab
    s_mul_hi_u32 s20, s16, s25
    s_mul_i32 s27, s20, 24
    s_sub_u32 s21, s16, s27
    s_mov_b32 s17, 1966080
    s_mov_b32 s18, 3072
    s_mov_b32 s19, 1280
    s_mov_b32 s22, 34078720
    s_mov_b32 s23, 3932160
    s_branch prep_tr_go
prep_tr_wd:
    s_sub_u32 s16, s16, 4320
    s_load_dwordx2 s[6:7], s[0:1], 80
    s_mov_b32 s25, 0x1999999a
    s_mul_hi_u32 s20, s16, s25
    s_mul_i32 s27, s20, 10
    s_sub_u32 s21, s16, s27
    s_mov_b32 s17, 1966080
    s_mov_b32 s18, 1280
    s_mov_b32 s19, 3072
    s_mov_b32 s22, 38010880
    s_mov_b32 s23, 1966080
    s_mov_b32 s24, 0
prep_tr_go:
    s_waitcnt lgkmcnt(0)
    s_mov_b32 s8, s6
    s_and_b32 s9, s7, 0xffff
    s_mov_b32 s10, s17
    s_mov_b32 s11, 0x20000
    s_add_u32 s12, s4, s22
    s_addc_u32 s13, s5, 0
    s_and_b32 s13, s13, 0xffff
    s_mov_b32 s14, s23
    s_mov_b32 s15, 0x20000
    v_lshrrev_b32 v2, 2, v0
    v_and_b32 v3, 3, v0
    s_lshl_b32 s25, s20, 6
    v_add_u32 v4, s25, v2
    v_mul_lo_u32 v4, v4, s18
    s_lshl_b32 s26, s21, 7
    v_lshlrev_b32 v5, 5, v3
    v_add3_u32 v4, v4, v5, s26
    buffer_load_dwordx4 v[8:11], v4, s[8:11], 0 offen
    buffer_load_dwordx4 v[12:15], v4, s[8:11], 0 offen offset:16
    v_mul_u32_u24 v6, 132, v2
    v_add_u32 v6, v6, v5
    s_waitcnt vmcnt(0)
    ds_write_b32 v6, v8 offset:0
    ds_write_b32 v6, v9 offset:4
    ds_write_b32 v6, v10 offset:8
    ds_write_b32 v6, v11 offset:12
    ds_write_b32 v6, v12 offset:16
    ds_write_b32 v6, v13 offset:20
    ds_write_b32 v6, v14 offset:24
    ds_write_b32 v6, v15 offset:28
    s_waitcnt lgkmcnt(0)
    s_barrier
    v_mul_u32_u24 v6, 2112, v3
    v_lshl_add_u32 v6, v2, 1, v6
    ds_read_u16 v16, v6 offset:0
    ds_read_u16 v24, v6 offset:132
    ds_read_u16 v17, v6 offset:264
    ds_read_u16 v25, v6 offset:396
    ds_read_u16 v18, v6 offset:528
    ds_read_u16 v26, v6 offset:660
    ds_read_u16 v19, v6 offset:792
    ds_read_u16 v27, v6 offset:924
    ds_read_u16 v20, v6 offset:1056
    ds_read_u16 v28, v6 offset:1188
    ds_read_u16 v21, v6 offset:1320
    ds_read_u16 v29, v6 offset:1452
    ds_read_u16 v22, v6 offset:1584
    ds_read_u16 v30, v6 offset:1716
    ds_read_u16 v23, v6 offset:1848
    ds_read_u16 v31, v6 offset:1980
    s_lshl_b32 s26, s21, 6
    v_add_u32 v7, s26, v2
    s_cmp_eq_u32 s24, 0
    s_cbranch_scc1 prep_tr_noremap
    v_lshrrev_b32 v4, 4, v7
    v_lshlrev_b32 v4, 5, v4
    v_and_b32 v7, 15, v7
    v_add_u32 v7, v7, v4
    s_sub_u32 s26, s24, 1
    s_lshl_b32 s26, s26, 4
    v_add_u32 v7, s26, v7
prep_tr_noremap:
    v_mul_lo_u32 v7, v7, s19
    s_lshl_b32 s25, s20, 7
    v_lshlrev_b32 v5, 5, v3
    v_add3_u32 v7, v7, v5, s25
    s_waitcnt lgkmcnt(0)
    v_lshl_or_b32 v16, v24, 16, v16
    v_lshl_or_b32 v17, v25, 16, v17
    v_lshl_or_b32 v18, v26, 16, v18
    v_lshl_or_b32 v19, v27, 16, v19
    v_lshl_or_b32 v20, v28, 16, v20
    v_lshl_or_b32 v21, v29, 16, v21
    v_lshl_or_b32 v22, v30, 16, v22
    v_lshl_or_b32 v23, v31, 16, v23
    buffer_store_dwordx4 v[16:19], v7, s[12:15], 0 offen
    buffer_store_dwordx4 v[20:23], v7, s[12:15], 0 offen offset:16
    s_branch prep_end
prep_not_tr:
    s_sub_u32 s16, s16, 4560
    s_cmp_ge_u32 s16, 133
    s_cbranch_scc1 prep_mem0
    s_waitcnt lgkmcnt(0)
    s_add_u32 s12, s4, 0xd534000
    s_addc_u32 s13, s5, 0
    s_and_b32 s13, s13, 0xffff
    s_mov_b32 s14, 0x214000
    s_mov_b32 s15, 0x20000
    s_lshl_b32 s16, s16, 14
    v_lshlrev_b32 v3, 4, v0
    v_mov_b32 v8, -1
    v_mov_b32 v9, -1
    v_mov_b32 v10, -1
    v_mov_b32 v11, -1
    buffer_store_dwordx4 v[8:11], v3, s[12:15], s16 offen offset:0
    v_add_u32 v3, 0x1000, v3
    buffer_store_dwordx4 v[8:11], v3, s[12:15], s16 offen
    v_add_u32 v3, 0x1000, v3
    buffer_store_dwordx4 v[8:11], v3, s[12:15], s16 offen
    v_add_u32 v3, 0x1000, v3
    buffer_store_dwordx4 v[8:11], v3, s[12:15], s16 offen
    s_branch prep_end
prep_mem0:
    s_sub_u32 s16, s16, 133
    s_load_dwordx2 s[6:7], s[0:1], 8
    s_waitcnt lgkmcnt(0)
    s_add_u32 s8, s6, 0x0
    s_addc_u32 s9, s7, 0
    s_and_b32 s9, s9, 0xffff
    s_mov_b32 s10, 0x2800
    s_mov_b32 s11, 0x20000
    s_mul_i32 s16, s16, 10240
    s_add_u32 s16, s16, 223477760
    s_add_u32 s12, s4, s16
    s_addc_u32 s13, s5, 0
    s_and_b32 s13, s13, 0xffff
    s_mov_b32 s14, 10240
    s_mov_b32 s15, 0x20000
    s_mov_b32 s17, 0xfffffffe
    v_mov_b32 v4, v0
    v_and_b32 v5, 7, v4
    v_mul_u32_u24 v5, 1280, v5
    v_lshrrev_b32 v6, 3, v4
    v_lshl_add_u32 v5, v6, 4, v5
    v_lshlrev_b32 v3, 4, v4
    v_cmp_gt_u32 vcc, 640, v4
    s_and_saveexec_b64 s[20:21], vcc
    s_cbranch_execz prep_m0skip0
    buffer_load_dwordx4 v[8:11], v5, s[8:11], 0 offen
    s_waitcnt vmcnt(0)
    v_min_u32 v8, s17, v8
    v_min_u32 v9, s17, v9
    v_min_u32 v10, s17, v10
    v_min_u32 v11, s17, v11
    buffer_store_dwordx4 v[8:11], v3, s[12:15], 0 offen
prep_m0skip0:
    s_mov_b64 exec, s[20:21]
    s_nop 1
    v_add_u32 v4, 0x100, v4
    v_and_b32 v5, 7, v4
    v_mul_u32_u24 v5, 1280, v5
    v_lshrrev_b32 v6, 3, v4
    v_lshl_add_u32 v5, v6, 4, v5
    v_lshlrev_b32 v3, 4, v4
    v_cmp_gt_u32 vcc, 640, v4
    s_and_saveexec_b64 s[20:21], vcc
    s_cbranch_execz prep_m0skip1
    buffer_load_dwordx4 v[8:11], v5, s[8:11], 0 offen
    s_waitcnt vmcnt(0)
    v_min_u32 v8, s17, v8
    v_min_u32 v9, s17, v9
    v_min_u32 v10, s17, v10
    v_min_u32 v11, s17, v11
    buffer_store_dwordx4 v[8:11], v3, s[12:15], 0 offen
prep_m0skip1:
    s_mov_b64 exec, s[20:21]
    s_nop 1
    v_add_u32 v4, 0x100, v4
    v_and_b32 v5, 7, v4
    v_mul_u32_u24 v5, 1280, v5
    v_lshrrev_b32 v6, 3, v4
    v_lshl_add_u32 v5, v6, 4, v5
    v_lshlrev_b32 v3, 4, v4
    v_cmp_gt_u32 vcc, 640, v4
    s_and_saveexec_b64 s[20:21], vcc
    s_cbranch_execz prep_m0skip2
    buffer_load_dwordx4 v[8:11], v5, s[8:11], 0 offen
    s_waitcnt vmcnt(0)
    v_min_u32 v8, s17, v8
    v_min_u32 v9, s17, v9
    v_min_u32 v10, s17, v10
    v_min_u32 v11, s17, v11
    buffer_store_dwordx4 v[8:11], v3, s[12:15], 0 offen
prep_m0skip2:
    s_mov_b64 exec, s[20:21]
    s_nop 1
    v_add_u32 v4, 0x100, v4
prep_end:
    s_endpgm
.section .rodata,"a"
.p2align 6
.amdhsa_kernel prep_kernel
  .amdhsa_next_free_vgpr 32
  .amdhsa_next_free_sgpr 102
  .amdhsa_accum_offset 32
  .amdhsa_group_segment_fixed_size 0
  .amdhsa_kernarg_size 112
  .amdhsa_user_sgpr_count 2
  .amdhsa_user_sgpr_kernarg_segment_ptr 1
  .amdhsa_system_sgpr_workgroup_id_x 1
  .amdhsa_float_denorm_mode_32 3
.end_amdhsa_kernel
.text
.globl chain_kernel
.p2align 8
.type chain_kernel,@function
chain_kernel:
    s_load_dwordx2 s[4:5], s[0:1], 104
    s_load_dwordx2 s[6:7], s[0:1], 96
    s_getreg_b32 s28, hwreg(HW_REG_XCC_ID)
    s_mov_b32 s50, 0
    s_mov_b32 s51, 0
    s_and_b32 s28, s28, 7
    v_lshrrev_b32 v4, 6, v0
    v_and_b32 v0, 63, v0
    v_readfirstlane_b32 s29, v4
    v_and_b32 v1, 15, v0
    v_lshrrev_b32 v2, 4, v0
    s_waitcnt lgkmcnt(0)
    s_cmp_lg_u32 s29, 0
    s_cbranch_scc1 ch_noticket
    s_mov_b32 s8, s6
    s_and_b32 s9, s7, 0xffff
    s_mov_b32 s10, 256
    s_mov_b32 s11, 0x20000
    s_lshl_b32 s12, s28, 5
    v_mov_b32 v4, s12
    v_mov_b32 v5, 1
    s_mov_b64 exec, 1
    buffer_atomic_add v5, v4, s[8:11], 0 offen sc0 sc1
    s_waitcnt vmcnt(0)
    v_mov_b32 v4, 24592
    ds_write_b32 v4, v5
    v_mov_b32 v8, 0
    v_mov_b32 v9, 0
    v_mov_b32 v10, 0
    v_mov_b32 v11, 0
    v_mov_b32 v4, 24576
    ds_write_b128 v4, v[8:11]
    v_mov_b32 v4, 24600
    ds_write_b64 v4, v[8:9]
    v_mov_b32 v4, 24608
    ds_write_b128 v4, v[8:11]
    v_mov_b32 v4, 24624
    ds_write_b128 v4, v[8:11]
    v_mov_b32 v4, 24640
    ds_write_b128 v4, v[8:11]
    v_mov_b32 v4, 24656
    ds_write_b128 v4, v[8:11]
    s_waitcnt lgkmcnt(0)
    s_mov_b64 exec, -1
ch_noticket:
    s_barrier
    v_mov_b32 v4, 24592
    ds_read_b32 v5, v4
    s_waitcnt lgkmcnt(0)
    v_readfirstlane_b32 s30, v5
    s_nop 3
    s_cmp_ge_u32 s30, 32
    s_cbranch_scc1 ch_end
    s_lshr_b32 s31, s30, 3
    s_and_b32 s32, s30, 7
    s_lshl_b32 s33, s28, 2
    s_add_u32 s33, s33, s31
    s_mul_i32 s34, s33, 192
    s_mul_i32 s35, s32, 24
    s_add_u32 s34, s34, s35
    s_add_u32 s8, s4, 0xd520000
    s_addc_u32 s9, s5, 0
    s_and_b32 s9, s9, 0xffff
    s_mov_b32 s10, 0x228000
    s_mov_b32 s11, 0x20000
    s_mov_b32 s40, 0
    s_mov_b32 s44, 0xfffffffe
    s_cmp_ge_u32 s29, 4
    s_cbranch_scc1 ch_wo
    s_add_u32 s12, s4, 0x280000
    s_addc_u32 s13, s5, 0
    s_and_b32 s13, s13, 0xffff
    s_mov_b32 s14, 0x1680000
    s_mov_b32 s15, 0x20000
    v_mov_b32 v16, 0
    v_mov_b32 v17, 0
    v_mov_b32 v18, 0
    v_mov_b32 v19, 0
    v_mov_b32 v20, 0
    v_mov_b32 v21, 0
    v_mov_b32 v22, 0
    v_mov_b32 v23, 0
    v_mov_b32 v24, 0
    v_mov_b32 v25, 0
    v_mov_b32 v26, 0
    v_mov_b32 v27, 0
    v_mov_b32 v28, 0
    v_mov_b32 v29, 0
    v_mov_b32 v30, 0
    v_mov_b32 v31, 0
    v_mov_b32 v32, 0
    v_mov_b32 v33, 0
    v_mov_b32 v34, 0
    v_mov_b32 v35, 0
    v_mov_b32 v36, 0
    v_mov_b32 v37, 0
    v_mov_b32 v38, 0
    v_mov_b32 v39, 0
    v_mov_b32 v40, 0
    v_mov_b32 v41, 0
    v_mov_b32 v42, 0
    v_mov_b32 v43, 0
    v_mov_b32 v44, 0
    v_mov_b32 v45, 0
    v_mov_b32 v46, 0
    v_mov_b32 v47, 0
    v_mov_b32 v48, 0
    v_mov_b32 v49, 0
    v_mov_b32 v50, 0
    v_mov_b32 v51, 0
    v_mov_b32 v52, 0
    v_mov_b32 v53, 0
    v_mov_b32 v54, 0
    v_mov_b32 v55, 0
    v_mov_b32 v56, 0
    v_mov_b32 v57, 0
    v_mov_b32 v58, 0
    v_mov_b32 v59, 0
    v_mov_b32 v60, 0
    v_mov_b32 v61, 0
    v_mov_b32 v62, 0
    v_mov_b32 v63, 0
    v_mov_b32 v64, 0
    v_mov_b32 v65, 0
    v_mov_b32 v66, 0
    v_mov_b32 v67, 0
    v_mov_b32 v68, 0
    v_mov_b32 v69, 0
    v_mov_b32 v70, 0
    v_mov_b32 v71, 0
    v_mov_b32 v72, 0
    v_mov_b32 v73, 0
    v_mov_b32 v74, 0
    v_mov_b32 v75, 0
    v_mov_b32 v76, 0
    v_mov_b32 v77, 0
    v_mov_b32 v78, 0
    v_mov_b32 v79, 0
    v_mov_b32 v80, 0
    v_mov_b32 v81, 0
    v_mov_b32 v82, 0
    v_mov_b32 v83, 0
    v_mov_b32 v84, 0
    v_mov_b32 v85, 0
    v_mov_b32 v86, 0
    v_mov_b32 v87, 0
    v_mov_b32 v88, 0
    v_mov_b32 v89, 0
    v_mov_b32 v90, 0
    v_mov_b32 v91, 0
    v_mov_b32 v92, 0
    v_mov_b32 v93, 0
    v_mov_b32 v94, 0
    v_mov_b32 v95, 0
    v_mov_b32 v96, 0
    v_mov_b32 v97, 0
    v_mov_b32 v98, 0
    v_mov_b32 v99, 0
    v_mov_b32 v100, 0
    v_mov_b32 v101, 0
    v_mov_b32 v102, 0
    v_mov_b32 v103, 0
    v_mov_b32 v104, 0
    v_mov_b32 v105, 0
    v_mov_b32 v106, 0
    v_mov_b32 v107, 0
    v_mov_b32 v108, 0
    v_mov_b32 v109, 0
    v_mov_b32 v110, 0
    v_mov_b32 v111, 0
    v_mov_b32 v112, 0
    v_mov_b32 v113, 0
    v_mov_b32 v114, 0
    v_mov_b32 v115, 0
    v_mov_b32 v116, 0
    v_mov_b32 v117, 0
    v_mov_b32 v118, 0
    v_mov_b32 v119, 0
    v_mov_b32 v120, 0
    v_mov_b32 v121, 0
    v_mov_b32 v122, 0
    v_mov_b32 v123, 0
    v_mov_b32 v124, 0
    v_mov_b32 v125, 0
    v_mov_b32 v126, 0
    v_mov_b32 v127, 0
    v_mov_b32 v128, 0
    v_mov_b32 v129, 0
    v_mov_b32 v130, 0
    v_mov_b32 v131, 0
    v_mov_b32 v132, 0
    v_mov_b32 v133, 0
    v_mov_b32 v134, 0
    v_mov_b32 v135, 0
    v_mov_b32 v136, 0
    v_mov_b32 v137, 0
    v_mov_b32 v138, 0
    v_mov_b32 v139, 0
    v_mov_b32 v140, 0
    v_mov_b32 v141, 0
    v_mov_b32 v142, 0
    v_mov_b32 v143, 0
    v_mov_b32 v144, 0
    v_mov_b32 v145, 0
    v_mov_b32 v146, 0
    v_mov_b32 v147, 0
    v_mov_b32 v148, 0
    v_mov_b32 v149, 0
    v_mov_b32 v150, 0
    v_mov_b32 v151, 0
    v_mov_b32 v152, 0
    v_mov_b32 v153, 0
    v_mov_b32 v154, 0
    v_mov_b32 v155, 0
    v_add_u32 v4, s34, v1
    s_mov_b32 s36, 1280
    v_mul_lo_u32 v4, v4, s36
    v_lshl_add_u32 v4, v2, 4, v4
    s_mul_i32 s36, s29, 320
    v_add_u32 v4, s36, v4
    s_mov_b32 s36, 0
    buffer_load_dwordx4 v[16:19], v4, s[12:15], s36 offen offset:0
    buffer_load_dwordx4 v[20:23], v4, s[12:15], s36 offen offset:64
    buffer_load_dwordx4 v[24:27], v4, s[12:15], s36 offen offset:128
    buffer_load_dwordx4 v[28:31], v4, s[12:15], s36 offen offset:192
    buffer_load_dwordx4 v[32:35], v4, s[12:15], s36 offen offset:256
    s_mov_b32 exec_lo, 0xff00ff
    s_mov_b32 exec_hi, 0xff00ff
    s_mov_b32 s36, 20480
    buffer_load_dwordx4 v[36:39], v4, s[12:15], s36 offen offset:0
    buffer_load_dwordx4 v[40:43], v4, s[12:15], s36 offen offset:64
    buffer_load_dwordx4 v[44:47], v4, s[12:15], s36 offen offset:128
    buffer_load_dwordx4 v[48:51], v4, s[12:15], s36 offen offset:192
    buffer_load_dwordx4 v[52:55], v4, s[12:15], s36 offen offset:256
    s_mov_b64 exec, -1
    s_mov_b32 s36, 7864320
    buffer_load_dwordx4 v[56:59], v4, s[12:15], s36 offen offset:0
    buffer_load_dwordx4 v[60:63], v4, s[12:15], s36 offen offset:64
    buffer_load_dwordx4 v[64:67], v4, s[12:15], s36 offen offset:128
    buffer_load_dwordx4 v[68:71], v4, s[12:15], s36 offen offset:192
    buffer_load_dwordx4 v[72:75], v4, s[12:15], s36 offen offset:256
    s_mov_b32 exec_lo, 0xff00ff
    s_mov_b32 exec_hi, 0xff00ff
    s_mov_b32 s36, 7884800
    buffer_load_dwordx4 v[76:79], v4, s[12:15], s36 offen offset:0
    buffer_load_dwordx4 v[80:83], v4, s[12:15], s36 offen offset:64
    buffer_load_dwordx4 v[84:87], v4, s[12:15], s36 offen offset:128
    buffer_load_dwordx4 v[88:91], v4, s[12:15], s36 offen offset:192
    buffer_load_dwordx4 v[92:95], v4, s[12:15], s36 offen offset:256
    s_mov_b64 exec, -1
    s_mov_b32 s36, 15728640
    buffer_load_dwordx4 v[96:99], v4, s[12:15], s36 offen offset:0
    buffer_load_dwordx4 v[100:103], v4, s[12:15], s36 offen offset:64
    buffer_load_dwordx4 v[104:107], v4, s[12:15], s36 offen offset:128
    buffer_load_dwordx4 v[108:111], v4, s[12:15], s36 offen offset:192
    buffer_load_dwordx4 v[112:115], v4, s[12:15], s36 offen offset:256
    s_mov_b32 exec_lo, 0xff00ff
    s_mov_b32 exec_hi, 0xff00ff
    s_mov_b32 s36, 15749120
    buffer_load_dwordx4 v[116:119], v4, s[12:15], s36 offen offset:0
    buffer_load_dwordx4 v[120:123], v4, s[12:15], s36 offen offset:64
    buffer_load_dwordx4 v[124:127], v4, s[12:15], s36 offen offset:128
    buffer_load_dwordx4 v[128:131], v4, s[12:15], s36 offen offset:192
    buffer_load_dwordx4 v[132:135], v4, s[12:15], s36 offen offset:256
    s_mov_b64 exec, -1
    v_lshlrev_b32 v3, 4, v1
    v_lshl_add_u32 v3, v2, 7, v3
    s_mul_i32 s36, s29, 2560
    s_mul_i32 s37, s28, 10240
    s_add_u32 s36, s36, s37
    v_add_u32 v3, s36, v3
    s_mul_i32 s36, s29, 6144
    v_lshlrev_b32 v5, 4, v0
    v_add_u32 v5, s36, v5
    v_lshlrev_b32 v6, 4, v0
    s_lshl_b32 s36, s29, 2
    s_add_u32 s36, s36, 24576
    v_mov_b32 v7, s36
    s_add_u32 s64, s4, 0x0
    s_addc_u32 s65, s5, 0
    s_and_b32 s65, s65, 0xffff
    s_mov_b32 s66, 0x280000
    s_mov_b32 s67, 0x20000
    s_add_u32 s68, s4, 0x2620000
    s_addc_u32 s69, s5, 0
    s_and_b32 s69, s69, 0xffff
    s_mov_b32 s70, 0x6000000
    s_mov_b32 s71, 0x20000
    v_lshlrev_b32 v252, 4, v0
    s_mul_i32 s36, s29, 5120
    v_add_u32 v252, s36, v252
    s_mul_i32 s36, s29, 12288
    s_add_u32 s36, s36, 49152
    v_lshlrev_b32 v253, 4, v0
    v_add_u32 v253, s36, v253
    s_waitcnt vmcnt(0)
    s_cmp_eq_u32 s29, 0
    s_cbranch_scc1 ch_w0_setup
    s_mov_b32 s76, 0
    s_mul_i32 s77, s76, 40960
    s_add_u32 s78, s77, 20480
    buffer_load_dwordx4 v[180:183], v252, s[64:67], s77 offen offset:0
    buffer_load_dwordx4 v[184:187], v252, s[64:67], s77 offen offset:1024
    buffer_load_dwordx4 v[188:191], v252, s[64:67], s77 offen offset:2048
    buffer_load_dwordx4 v[192:195], v252, s[64:67], s77 offen offset:3072
    s_add_u32 s79, s77, 4096
    buffer_load_dwordx4 v[196:199], v252, s[64:67], s79 offen
    buffer_load_dwordx4 v[200:203], v252, s[64:67], s78 offen offset:0
    buffer_load_dwordx4 v[204:207], v252, s[64:67], s78 offen offset:1024
    buffer_load_dwordx4 v[208:211], v252, s[64:67], s78 offen offset:2048
    buffer_load_dwordx4 v[212:215], v252, s[64:67], s78 offen offset:3072
    s_add_u32 s79, s78, 4096
    buffer_load_dwordx4 v[216:219], v252, s[64:67], s79 offen
    s_waitcnt vmcnt(0)
    s_and_b32 s79, s76, 1
    s_mul_i32 s79, s79, 49152
    v_add_u32 v9, s79, v253
    v_mfma_f32_16x16x32_bf16 v[156:159], v[16:19], v[180:183], 0
    v_mfma_f32_16x16x32_bf16 v[160:163], v[36:39], v[180:183], 0
    v_mfma_f32_16x16x32_bf16 v[164:167], v[56:59], v[180:183], 0
    v_mfma_f32_16x16x32_bf16 v[168:171], v[76:79], v[180:183], 0
    v_mfma_f32_16x16x32_bf16 v[172:175], v[180:183], v[96:99], 0
    v_mfma_f32_16x16x32_bf16 v[176:179], v[180:183], v[116:119], 0
    v_mfma_f32_16x16x32_bf16 v[156:159], v[20:23], v[184:187], v[156:159]
    v_mfma_f32_16x16x32_bf16 v[160:163], v[40:43], v[184:187], v[160:163]
    v_mfma_f32_16x16x32_bf16 v[164:167], v[60:63], v[184:187], v[164:167]
    v_mfma_f32_16x16x32_bf16 v[168:171], v[80:83], v[184:187], v[168:171]
    v_mfma_f32_16x16x32_bf16 v[172:175], v[184:187], v[100:103], v[172:175]
    v_mfma_f32_16x16x32_bf16 v[176:179], v[184:187], v[120:123], v[176:179]
    v_mfma_f32_16x16x32_bf16 v[156:159], v[24:27], v[188:191], v[156:159]
    v_mfma_f32_16x16x32_bf16 v[160:163], v[44:47], v[188:191], v[160:163]
    v_mfma_f32_16x16x32_bf16 v[164:167], v[64:67], v[188:191], v[164:167]
    v_mfma_f32_16x16x32_bf16 v[168:171], v[84:87], v[188:191], v[168:171]
    v_mfma_f32_16x16x32_bf16 v[172:175], v[188:191], v[104:107], v[172:175]
    v_mfma_f32_16x16x32_bf16 v[176:179], v[188:191], v[124:127], v[176:179]
    v_mfma_f32_16x16x32_bf16 v[156:159], v[28:31], v[192:195], v[156:159]
    v_mfma_f32_16x16x32_bf16 v[160:163], v[48:51], v[192:195], v[160:163]
    v_mfma_f32_16x16x32_bf16 v[164:167], v[68:71], v[192:195], v[164:167]
    v_mfma_f32_16x16x32_bf16 v[168:171], v[88:91], v[192:195], v[168:171]
    v_mfma_f32_16x16x32_bf16 v[172:175], v[192:195], v[108:111], v[172:175]
    v_mfma_f32_16x16x32_bf16 v[176:179], v[192:195], v[128:131], v[176:179]
    v_mfma_f32_16x16x32_bf16 v[156:159], v[32:35], v[196:199], v[156:159]
    v_mfma_f32_16x16x32_bf16 v[160:163], v[52:55], v[196:199], v[160:163]
    v_mfma_f32_16x16x32_bf16 v[164:167], v[72:75], v[196:199], v[164:167]
    v_mfma_f32_16x16x32_bf16 v[168:171], v[92:95], v[196:199], v[168:171]
    v_mfma_f32_16x16x32_bf16 v[172:175], v[196:199], v[112:115], v[172:175]
    v_mfma_f32_16x16x32_bf16 v[176:179], v[196:199], v[132:135], v[176:179]
    v_mfma_f32_16x16x32_bf16 v[220:223], v[16:19], v[200:203], 0
    v_mfma_f32_16x16x32_bf16 v[224:227], v[36:39], v[200:203], 0
    v_mfma_f32_16x16x32_bf16 v[228:231], v[56:59], v[200:203], 0
    v_mfma_f32_16x16x32_bf16 v[232:235], v[76:79], v[200:203], 0
    v_mfma_f32_16x16x32_bf16 v[236:239], v[200:203], v[96:99], 0
    v_mfma_f32_16x16x32_bf16 v[240:243], v[200:203], v[116:119], 0
    v_mfma_f32_16x16x32_bf16 v[220:223], v[20:23], v[204:207], v[220:223]
    v_mfma_f32_16x16x32_bf16 v[224:227], v[40:43], v[204:207], v[224:227]
    v_mfma_f32_16x16x32_bf16 v[228:231], v[60:63], v[204:207], v[228:231]
    v_mfma_f32_16x16x32_bf16 v[232:235], v[80:83], v[204:207], v[232:235]
    v_mfma_f32_16x16x32_bf16 v[236:239], v[204:207], v[100:103], v[236:239]
    v_mfma_f32_16x16x32_bf16 v[240:243], v[204:207], v[120:123], v[240:243]
    v_mfma_f32_16x16x32_bf16 v[220:223], v[24:27], v[208:211], v[220:223]
    v_mfma_f32_16x16x32_bf16 v[224:227], v[44:47], v[208:211], v[224:227]
    v_mfma_f32_16x16x32_bf16 v[228:231], v[64:67], v[208:211], v[228:231]
    v_mfma_f32_16x16x32_bf16 v[232:235], v[84:87], v[208:211], v[232:235]
    v_mfma_f32_16x16x32_bf16 v[236:239], v[208:211], v[104:107], v[236:239]
    v_mfma_f32_16x16x32_bf16 v[240:243], v[208:211], v[124:127], v[240:243]
    v_mfma_f32_16x16x32_bf16 v[220:223], v[28:31], v[212:215], v[220:223]
    v_mfma_f32_16x16x32_bf16 v[224:227], v[48:51], v[212:215], v[224:227]
    v_mfma_f32_16x16x32_bf16 v[228:231], v[68:71], v[212:215], v[228:231]
    v_mfma_f32_16x16x32_bf16 v[232:235], v[88:91], v[212:215], v[232:235]
    v_mfma_f32_16x16x32_bf16 v[236:239], v[212:215], v[108:111], v[236:239]
    v_mfma_f32_16x16x32_bf16 v[240:243], v[212:215], v[128:131], v[240:243]
    v_mfma_f32_16x16x32_bf16 v[220:223], v[32:35], v[216:219], v[220:223]
    v_mfma_f32_16x16x32_bf16 v[224:227], v[52:55], v[216:219], v[224:227]
    v_mfma_f32_16x16x32_bf16 v[228:231], v[72:75], v[216:219], v[228:231]
    v_mfma_f32_16x16x32_bf16 v[232:235], v[92:95], v[216:219], v[232:235]
    v_mfma_f32_16x16x32_bf16 v[236:239], v[216:219], v[112:115], v[236:239]
    v_mfma_f32_16x16x32_bf16 v[240:243], v[216:219], v[132:135], v[240:243]
    s_nop 7
    ds_write_b128 v9, v[156:159] offset:0
    ds_write_b128 v9, v[160:163] offset:1024
    ds_write_b128 v9, v[164:167] offset:2048
    ds_write_b128 v9, v[168:171] offset:3072
    ds_write_b128 v9, v[172:175] offset:4096
    ds_write_b128 v9, v[176:179] offset:5120
    ds_write_b128 v9, v[220:223] offset:6144
    ds_write_b128 v9, v[224:227] offset:7168
    ds_write_b128 v9, v[228:231] offset:8192
    ds_write_b128 v9, v[232:235] offset:9216
    ds_write_b128 v9, v[236:239] offset:10240
    ds_write_b128 v9, v[240:243] offset:11264
    s_add_u32 s77, s76, 1
    s_lshl_b32 s78, s29, 2
    s_add_u32 s78, s78, 24624
    v_mov_b32 v8, s77
    v_mov_b32 v9, s78
    s_waitcnt lgkmcnt(0)
    ds_write_b32 v9, v8
    s_add_u32 s77, s76, 1
    v_mov_b32 v8, 24624
ch_xr_w1:
    ds_read_b128 v[244:247], v8
    s_waitcnt lgkmcnt(0)
    v_min_u32 v244, v244, v245
    v_min3_u32 v244, v244, v246, v247
    v_cmp_gt_u32 vcc, s77, v244
    s_add_u32 s50, s50, 1
    s_cmp_ge_u32 s50, 0x2000000
    s_cbranch_scc1 ch_end
    s_cbranch_vccnz ch_xr_w1
    v_mov_b32 v9, 24660
ch_xr_w7_1:
    ds_read_b32 v8, v9
    s_waitcnt lgkmcnt(0)
    v_cmp_gt_u32 vcc, s77, v8
    s_add_u32 s50, s50, 1
    s_cmp_ge_u32 s50, 0x2000000
    s_cbranch_scc1 ch_end
    s_cbranch_vccz ch_xr_w7_1_x
    s_sleep 2
    s_branch ch_xr_w7_1
ch_xr_w7_1_x:
    s_and_b32 s79, s76, 1
    s_mul_i32 s78, s79, 49152
    s_sub_u32 s80, s29, 1
    s_lshl_b32 s81, s80, 11
    s_add_u32 s78, s78, s81
    s_add_u32 s78, s78, 49152
    v_add_u32 v9, s78, v6
    ds_read_b128 v[136:139], v9 offset:0
    ds_read_b128 v[140:143], v9 offset:1024
    ds_read_b128 v[144:147], v9 offset:6144
    ds_read_b128 v[148:151], v9 offset:7168
    ds_read_b128 v[152:155], v9 offset:12288
    ds_read_b128 v[156:159], v9 offset:13312
    ds_read_b128 v[160:163], v9 offset:18432
    ds_read_b128 v[164:167], v9 offset:19456
    ds_read_b128 v[168:171], v9 offset:24576
    ds_read_b128 v[172:175], v9 offset:25600
    ds_read_b128 v[176:179], v9 offset:30720
    ds_read_b128 v[220:223], v9 offset:31744
    s_waitcnt lgkmcnt(8)
    ds_read_b128 v[224:227], v9 offset:36864
    ds_read_b128 v[228:231], v9 offset:37888
    ds_read_b128 v[232:235], v9 offset:43008
    ds_read_b128 v[236:239], v9 offset:44032
    s_waitcnt lgkmcnt(0)
    v_pk_add_f32 v[136:137], v[136:137], v[152:153]
    v_pk_add_f32 v[138:139], v[138:139], v[154:155]
    v_pk_add_f32 v[140:141], v[140:141], v[156:157]
    v_pk_add_f32 v[142:143], v[142:143], v[158:159]
    v_pk_add_f32 v[144:145], v[144:145], v[160:161]
    v_pk_add_f32 v[146:147], v[146:147], v[162:163]
    v_pk_add_f32 v[148:149], v[148:149], v[164:165]
    v_pk_add_f32 v[150:151], v[150:151], v[166:167]
    v_pk_add_f32 v[136:137], v[136:137], v[168:169]
    v_pk_add_f32 v[138:139], v[138:139], v[170:171]
    v_pk_add_f32 v[140:141], v[140:141], v[172:173]
    v_pk_add_f32 v[142:143], v[142:143], v[174:175]
    v_pk_add_f32 v[144:145], v[144:145], v[176:177]
    v_pk_add_f32 v[146:147], v[146:147], v[178:179]
    v_pk_add_f32 v[148:149], v[148:149], v[220:221]
    v_pk_add_f32 v[150:151], v[150:151], v[222:223]
    v_pk_add_f32 v[136:137], v[136:137], v[224:225]
    v_pk_add_f32 v[138:139], v[138:139], v[226:227]
    v_pk_add_f32 v[140:141], v[140:141], v[228:229]
    v_pk_add_f32 v[142:143], v[142:143], v[230:231]
    v_pk_add_f32 v[144:145], v[144:145], v[232:233]
    v_pk_add_f32 v[146:147], v[146:147], v[234:235]
    v_pk_add_f32 v[148:149], v[148:149], v[236:237]
    v_pk_add_f32 v[150:151], v[150:151], v[238:239]
    v_cvt_pk_bf16_f32 v240, v136, v137
    v_cvt_pk_bf16_f32 v241, v138, v139
    v_cvt_pk_bf16_f32 v242, v140, v141
    v_cvt_pk_bf16_f32 v243, v142, v143
    v_cvt_pk_bf16_f32 v244, v144, v145
    v_cvt_pk_bf16_f32 v245, v146, v147
    v_cvt_pk_bf16_f32 v246, v148, v149
    v_cvt_pk_bf16_f32 v247, v150, v151
    s_lshl_b32 s81, s76, 5
    s_add_u32 s81, s81, s33
    s_lshl_b32 s81, s81, 3
    s_add_u32 s81, s81, s32
    s_lshl_b32 s81, s81, 11
    s_mul_i32 s82, s80, 33554432
    s_add_u32 s81, s81, s82
    s_cmp_eq_u32 s80, 2
    s_cbranch_scc1 ch_xr_v1
    buffer_store_dwordx4 v[240:243], v6, s[68:71], s81 offen
    buffer_store_dwordx4 v[244:247], v6, s[68:71], s81 offen offset:1024
    s_cmp_eq_u32 s80, 0
    s_cbranch_scc1 ch_xr_done1
    s_lshl_b32 s81, s79, 11
    s_add_u32 s81, s81, 40960
    v_add_u32 v9, s81, v6
    ds_write_b128 v9, v[240:243]
    ds_write_b128 v9, v[244:247] offset:1024
    s_branch ch_xr_done1
ch_xr_v1:
    v_mov_b32 v160, v240
    v_mov_b32 v161, v241
    v_mov_b32 v162, v244
    v_mov_b32 v163, v245
    v_mov_b32 v164, v242
    v_mov_b32 v165, v243
    v_mov_b32 v166, v246
    v_mov_b32 v167, v247
    buffer_store_dwordx4 v[160:163], v6, s[68:71], s81 offen
    buffer_store_dwordx4 v[164:167], v6, s[68:71], s81 offen offset:1024
    s_lshl_b32 s81, s79, 11
    s_add_u32 s81, s81, 45056
    v_add_u32 v9, s81, v6
    ds_write_b128 v9, v[160:163]
    ds_write_b128 v9, v[164:167] offset:1024
ch_xr_done1:
    s_lshl_b32 s78, s29, 2
    s_add_u32 s78, s78, 24640
    v_mov_b32 v8, s77
    v_mov_b32 v9, s78
    s_waitcnt lgkmcnt(0)
    ds_write_b32 v9, v8
    s_mov_b32 s76, 1
    s_mul_i32 s77, s76, 40960
    s_add_u32 s78, s77, 20480
    buffer_load_dwordx4 v[180:183], v252, s[64:67], s77 offen offset:0
    buffer_load_dwordx4 v[184:187], v252, s[64:67], s77 offen offset:1024
    buffer_load_dwordx4 v[188:191], v252, s[64:67], s77 offen offset:2048
    buffer_load_dwordx4 v[192:195], v252, s[64:67], s77 offen offset:3072
    s_add_u32 s79, s77, 4096
    buffer_load_dwordx4 v[196:199], v252, s[64:67], s79 offen
    buffer_load_dwordx4 v[200:203], v252, s[64:67], s78 offen offset:0
    buffer_load_dwordx4 v[204:207], v252, s[64:67], s78 offen offset:1024
    buffer_load_dwordx4 v[208:211], v252, s[64:67], s78 offen offset:2048
    buffer_load_dwordx4 v[212:215], v252, s[64:67], s78 offen offset:3072
    s_add_u32 s79, s78, 4096
    buffer_load_dwordx4 v[216:219], v252, s[64:67], s79 offen
    s_waitcnt vmcnt(0)
    s_and_b32 s79, s76, 1
    s_mul_i32 s79, s79, 49152
    v_add_u32 v9, s79, v253
    v_mfma_f32_16x16x32_bf16 v[156:159], v[16:19], v[180:183], 0
    v_mfma_f32_16x16x32_bf16 v[160:163], v[36:39], v[180:183], 0
    v_mfma_f32_16x16x32_bf16 v[164:167], v[56:59], v[180:183], 0
    v_mfma_f32_16x16x32_bf16 v[168:171], v[76:79], v[180:183], 0
    v_mfma_f32_16x16x32_bf16 v[172:175], v[180:183], v[96:99], 0
    v_mfma_f32_16x16x32_bf16 v[176:179], v[180:183], v[116:119], 0
    v_mfma_f32_16x16x32_bf16 v[156:159], v[20:23], v[184:187], v[156:159]
    v_mfma_f32_16x16x32_bf16 v[160:163], v[40:43], v[184:187], v[160:163]
    v_mfma_f32_16x16x32_bf16 v[164:167], v[60:63], v[184:187], v[164:167]
    v_mfma_f32_16x16x32_bf16 v[168:171], v[80:83], v[184:187], v[168:171]
    v_mfma_f32_16x16x32_bf16 v[172:175], v[184:187], v[100:103], v[172:175]
    v_mfma_f32_16x16x32_bf16 v[176:179], v[184:187], v[120:123], v[176:179]
    v_mfma_f32_16x16x32_bf16 v[156:159], v[24:27], v[188:191], v[156:159]
    v_mfma_f32_16x16x32_bf16 v[160:163], v[44:47], v[188:191], v[160:163]
    v_mfma_f32_16x16x32_bf16 v[164:167], v[64:67], v[188:191], v[164:167]
    v_mfma_f32_16x16x32_bf16 v[168:171], v[84:87], v[188:191], v[168:171]
    v_mfma_f32_16x16x32_bf16 v[172:175], v[188:191], v[104:107], v[172:175]
    v_mfma_f32_16x16x32_bf16 v[176:179], v[188:191], v[124:127], v[176:179]
    v_mfma_f32_16x16x32_bf16 v[156:159], v[28:31], v[192:195], v[156:159]
    v_mfma_f32_16x16x32_bf16 v[160:163], v[48:51], v[192:195], v[160:163]
    v_mfma_f32_16x16x32_bf16 v[164:167], v[68:71], v[192:195], v[164:167]
    v_mfma_f32_16x16x32_bf16 v[168:171], v[88:91], v[192:195], v[168:171]
    v_mfma_f32_16x16x32_bf16 v[172:175], v[192:195], v[108:111], v[172:175]
    v_mfma_f32_16x16x32_bf16 v[176:179], v[192:195], v[128:131], v[176:179]
    v_mfma_f32_16x16x32_bf16 v[156:159], v[32:35], v[196:199], v[156:159]
    v_mfma_f32_16x16x32_bf16 v[160:163], v[52:55], v[196:199], v[160:163]
    v_mfma_f32_16x16x32_bf16 v[164:167], v[72:75], v[196:199], v[164:167]
    v_mfma_f32_16x16x32_bf16 v[168:171], v[92:95], v[196:199], v[168:171]
    v_mfma_f32_16x16x32_bf16 v[172:175], v[196:199], v[112:115], v[172:175]
    v_mfma_f32_16x16x32_bf16 v[176:179], v[196:199], v[132:135], v[176:179]
    v_mfma_f32_16x16x32_bf16 v[220:223], v[16:19], v[200:203], 0
    v_mfma_f32_16x16x32_bf16 v[224:227], v[36:39], v[200:203], 0
    v_mfma_f32_16x16x32_bf16 v[228:231], v[56:59], v[200:203], 0
    v_mfma_f32_16x16x32_bf16 v[232:235], v[76:79], v[200:203], 0
    v_mfma_f32_16x16x32_bf16 v[236:239], v[200:203], v[96:99], 0
    v_mfma_f32_16x16x32_bf16 v[240:243], v[200:203], v[116:119], 0
    v_mfma_f32_16x16x32_bf16 v[220:223], v[20:23], v[204:207], v[220:223]
    v_mfma_f32_16x16x32_bf16 v[224:227], v[40:43], v[204:207], v[224:227]
    v_mfma_f32_16x16x32_bf16 v[228:231], v[60:63], v[204:207], v[228:231]
    v_mfma_f32_16x16x32_bf16 v[232:235], v[80:83], v[204:207], v[232:235]
    v_mfma_f32_16x16x32_bf16 v[236:239], v[204:207], v[100:103], v[236:239]
    v_mfma_f32_16x16x32_bf16 v[240:243], v[204:207], v[120:123], v[240:243]
    v_mfma_f32_16x16x32_bf16 v[220:223], v[24:27], v[208:211], v[220:223]
    v_mfma_f32_16x16x32_bf16 v[224:227], v[44:47], v[208:211], v[224:227]
    v_mfma_f32_16x16x32_bf16 v[228:231], v[64:67], v[208:211], v[228:231]
    v_mfma_f32_16x16x32_bf16 v[232:235], v[84:87], v[208:211], v[232:235]
    v_mfma_f32_16x16x32_bf16 v[236:239], v[208:211], v[104:107], v[236:239]
    v_mfma_f32_16x16x32_bf16 v[240:243], v[208:211], v[124:127], v[240:243]
    v_mfma_f32_16x16x32_bf16 v[220:223], v[28:31], v[212:215], v[220:223]
    v_mfma_f32_16x16x32_bf16 v[224:227], v[48:51], v[212:215], v[224:227]
    v_mfma_f32_16x16x32_bf16 v[228:231], v[68:71], v[212:215], v[228:231]
    v_mfma_f32_16x16x32_bf16 v[232:235], v[88:91], v[212:215], v[232:235]
    v_mfma_f32_16x16x32_bf16 v[236:239], v[212:215], v[108:111], v[236:239]
    v_mfma_f32_16x16x32_bf16 v[240:243], v[212:215], v[128:131], v[240:243]
    v_mfma_f32_16x16x32_bf16 v[220:223], v[32:35], v[216:219], v[220:223]
    v_mfma_f32_16x16x32_bf16 v[224:227], v[52:55], v[216:219], v[224:227]
    v_mfma_f32_16x16x32_bf16 v[228:231], v[72:75], v[216:219], v[228:231]
    v_mfma_f32_16x16x32_bf16 v[232:235], v[92:95], v[216:219], v[232:235]
    v_mfma_f32_16x16x32_bf16 v[236:239], v[216:219], v[112:115], v[236:239]
    v_mfma_f32_16x16x32_bf16 v[240:243], v[216:219], v[132:135], v[240:243]
    s_nop 7
    ds_write_b128 v9, v[156:159] offset:0
    ds_write_b128 v9, v[160:163] offset:1024
    ds_write_b128 v9, v[164:167] offset:2048
    ds_write_b128 v9, v[168:171] offset:3072
    ds_write_b128 v9, v[172:175] offset:4096
    ds_write_b128 v9, v[176:179] offset:5120
    ds_write_b128 v9, v[220:223] offset:6144
    ds_write_b128 v9, v[224:227] offset:7168
    ds_write_b128 v9, v[228:231] offset:8192
    ds_write_b128 v9, v[232:235] offset:9216
    ds_write_b128 v9, v[236:239] offset:10240
    ds_write_b128 v9, v[240:243] offset:11264
    s_add_u32 s77, s76, 1
    s_lshl_b32 s78, s29, 2
    s_add_u32 s78, s78, 24624
    v_mov_b32 v8, s77
    v_mov_b32 v9, s78
    s_waitcnt lgkmcnt(0)
    ds_write_b32 v9, v8
    s_mov_b32 s76, 2
    s_mul_i32 s77, s76, 40960
    s_add_u32 s78, s77, 20480
    buffer_load_dwordx4 v[180:183], v252, s[64:67], s77 offen offset:0
    buffer_load_dwordx4 v[184:187], v252, s[64:67], s77 offen offset:1024
    buffer_load_dwordx4 v[188:191], v252, s[64:67], s77 offen offset:2048
    buffer_load_dwordx4 v[192:195], v252, s[64:67], s77 offen offset:3072
    s_add_u32 s79, s77, 4096
    buffer_load_dwordx4 v[196:199], v252, s[64:67], s79 offen
    buffer_load_dwordx4 v[200:203], v252, s[64:67], s78 offen offset:0
    buffer_load_dwordx4 v[204:207], v252, s[64:67], s78 offen offset:1024
    buffer_load_dwordx4 v[208:211], v252, s[64:67], s78 offen offset:2048
    buffer_load_dwordx4 v[212:215], v252, s[64:67], s78 offen offset:3072
    s_add_u32 s79, s78, 4096
    buffer_load_dwordx4 v[216:219], v252, s[64:67], s79 offen
    s_branch ch_w123_loop
ch_w123_loop:
    s_and_b32 s41, s40, 1
    s_mul_i32 s41, s41, 81920
    v_mov_b32 v9, 24604
ch_w123_lw:
    ds_read_b32 v8, v9
    s_waitcnt lgkmcnt(0)
    v_cmp_gt_u32 vcc, s40, v8
    s_add_u32 s50, s50, 1
    s_cmp_ge_u32 s50, 0x2000000
    s_cbranch_scc1 ch_end
    s_cbranch_vccz ch_w123_lw_x
    s_sleep 2
    s_branch ch_w123_lw
ch_w123_lw_x:
    s_mov_b32 exec_lo, 0xff00ff
    s_mov_b32 exec_hi, 0xff00ff
ch_w123_poll:
    buffer_load_dwordx4 v[136:139], v3, s[8:11], s41 offen offset:0 sc1
    buffer_load_dwordx4 v[140:143], v3, s[8:11], s41 offen offset:512 sc1
    buffer_load_dwordx4 v[144:147], v3, s[8:11], s41 offen offset:1024 sc1
    buffer_load_dwordx4 v[148:151], v3, s[8:11], s41 offen offset:1536 sc1
    buffer_load_dwordx4 v[152:155], v3, s[8:11], s41 offen offset:2048 sc1
    s_waitcnt vmcnt(0)
    v_max3_u32 v8, v136, v137, v138
    v_max3_u32 v8, v8, v139, v140
    v_max3_u32 v8, v8, v141, v142
    v_max3_u32 v8, v8, v143, v144
    v_max3_u32 v8, v8, v145, v146
    v_max3_u32 v8, v8, v147, v148
    v_max3_u32 v8, v8, v149, v150
    v_max3_u32 v8, v8, v151, v152
    v_max3_u32 v8, v8, v153, v154
    v_max_u32 v8, v8, v155
    v_cmp_eq_u32 vcc, -1, v8
    s_add_u32 s50, s50, 1
    s_cmp_ge_u32 s50, 0x2000000
    s_cbranch_scc1 ch_end
    s_cbranch_vccnz ch_w123_poll
    s_mov_b64 exec, -1
    v_mfma_f32_16x16x32_bf16 v[156:159], v[16:19], v[136:139], 0
    v_mfma_f32_16x16x32_bf16 v[160:163], v[36:39], v[136:139], 0
    v_mfma_f32_16x16x32_bf16 v[164:167], v[56:59], v[136:139], 0
    v_mfma_f32_16x16x32_bf16 v[168:171], v[76:79], v[136:139], 0
    v_mfma_f32_16x16x32_bf16 v[172:175], v[136:139], v[96:99], 0
    v_mfma_f32_16x16x32_bf16 v[176:179], v[136:139], v[116:119], 0
    v_mfma_f32_16x16x32_bf16 v[156:159], v[20:23], v[140:143], v[156:159]
    v_mfma_f32_16x16x32_bf16 v[160:163], v[40:43], v[140:143], v[160:163]
    v_mfma_f32_16x16x32_bf16 v[164:167], v[60:63], v[140:143], v[164:167]
    v_mfma_f32_16x16x32_bf16 v[168:171], v[80:83], v[140:143], v[168:171]
    v_mfma_f32_16x16x32_bf16 v[172:175], v[140:143], v[100:103], v[172:175]
    v_mfma_f32_16x16x32_bf16 v[176:179], v[140:143], v[120:123], v[176:179]
    v_mfma_f32_16x16x32_bf16 v[156:159], v[24:27], v[144:147], v[156:159]
    v_mfma_f32_16x16x32_bf16 v[160:163], v[44:47], v[144:147], v[160:163]
    v_mfma_f32_16x16x32_bf16 v[164:167], v[64:67], v[144:147], v[164:167]
    v_mfma_f32_16x16x32_bf16 v[168:171], v[84:87], v[144:147], v[168:171]
    v_mfma_f32_16x16x32_bf16 v[172:175], v[144:147], v[104:107], v[172:175]
    v_mfma_f32_16x16x32_bf16 v[176:179], v[144:147], v[124:127], v[176:179]
    v_mfma_f32_16x16x32_bf16 v[156:159], v[28:31], v[148:151], v[156:159]
    v_mfma_f32_16x16x32_bf16 v[160:163], v[48:51], v[148:151], v[160:163]
    v_mfma_f32_16x16x32_bf16 v[164:167], v[68:71], v[148:151], v[164:167]
    v_mfma_f32_16x16x32_bf16 v[168:171], v[88:91], v[148:151], v[168:171]
    v_mfma_f32_16x16x32_bf16 v[172:175], v[148:151], v[108:111], v[172:175]
    v_mfma_f32_16x16x32_bf16 v[176:179], v[148:151], v[128:131], v[176:179]
    v_mfma_f32_16x16x32_bf16 v[156:159], v[32:35], v[152:155], v[156:159]
    v_mfma_f32_16x16x32_bf16 v[160:163], v[52:55], v[152:155], v[160:163]
    v_mfma_f32_16x16x32_bf16 v[164:167], v[72:75], v[152:155], v[164:167]
    v_mfma_f32_16x16x32_bf16 v[168:171], v[92:95], v[152:155], v[168:171]
    v_mfma_f32_16x16x32_bf16 v[172:175], v[152:155], v[112:115], v[172:175]
    v_mfma_f32_16x16x32_bf16 v[176:179], v[152:155], v[132:135], v[176:179]
    s_add_u32 s40, s40, 1
    v_mov_b32 v9, s40
    s_nop 7
    ds_write_b128 v5, v[156:159] offset:0
    ds_write_b128 v5, v[160:163] offset:1024
    ds_write_b128 v5, v[164:167] offset:2048
    ds_write_b128 v5, v[168:171] offset:3072
    ds_write_b128 v5, v[172:175] offset:4096
    ds_write_b128 v5, v[176:179] offset:5120
    s_waitcnt lgkmcnt(0)
    ds_write_b32 v7, v9
    s_cmp_ge_u32 s40, 64
    s_cbranch_scc1 ch_end
    s_add_u32 s76, s40, 1
    s_cmp_ge_u32 s76, 64
    s_cbranch_scc1 ch_w123_nox
    v_mov_b32 v8, 24640
ch_w123_rw:
    ds_read_b128 v[244:247], v8
    s_waitcnt lgkmcnt(0)
    v_min3_u32 v244, v245, v246, v247
    v_cmp_gt_u32 vcc, s40, v244
    s_add_u32 s50, s50, 1
    s_cmp_ge_u32 s50, 0x2000000
    s_cbranch_scc1 ch_end
    s_cbranch_vccnz ch_w123_rw
    s_and_b32 s79, s76, 1
    s_mul_i32 s79, s79, 49152
    v_add_u32 v9, s79, v253
    v_mfma_f32_16x16x32_bf16 v[156:159], v[16:19], v[180:183], 0
    v_mfma_f32_16x16x32_bf16 v[160:163], v[36:39], v[180:183], 0
    v_mfma_f32_16x16x32_bf16 v[164:167], v[56:59], v[180:183], 0
    v_mfma_f32_16x16x32_bf16 v[168:171], v[76:79], v[180:183], 0
    v_mfma_f32_16x16x32_bf16 v[172:175], v[180:183], v[96:99], 0
    v_mfma_f32_16x16x32_bf16 v[176:179], v[180:183], v[116:119], 0
    v_mfma_f32_16x16x32_bf16 v[156:159], v[20:23], v[184:187], v[156:159]
    v_mfma_f32_16x16x32_bf16 v[160:163], v[40:43], v[184:187], v[160:163]
    v_mfma_f32_16x16x32_bf16 v[164:167], v[60:63], v[184:187], v[164:167]
    v_mfma_f32_16x16x32_bf16 v[168:171], v[80:83], v[184:187], v[168:171]
    v_mfma_f32_16x16x32_bf16 v[172:175], v[184:187], v[100:103], v[172:175]
    v_mfma_f32_16x16x32_bf16 v[176:179], v[184:187], v[120:123], v[176:179]
    v_mfma_f32_16x16x32_bf16 v[156:159], v[24:27], v[188:191], v[156:159]
    v_mfma_f32_16x16x32_bf16 v[160:163], v[44:47], v[188:191], v[160:163]
    v_mfma_f32_16x16x32_bf16 v[164:167], v[64:67], v[188:191], v[164:167]
    v_mfma_f32_16x16x32_bf16 v[168:171], v[84:87], v[188:191], v[168:171]
    v_mfma_f32_16x16x32_bf16 v[172:175], v[188:191], v[104:107], v[172:175]
    v_mfma_f32_16x16x32_bf16 v[176:179], v[188:191], v[124:127], v[176:179]
    v_mfma_f32_16x16x32_bf16 v[156:159], v[28:31], v[192:195], v[156:159]
    v_mfma_f32_16x16x32_bf16 v[160:163], v[48:51], v[192:195], v[160:163]
    v_mfma_f32_16x16x32_bf16 v[164:167], v[68:71], v[192:195], v[164:167]
    v_mfma_f32_16x16x32_bf16 v[168:171], v[88:91], v[192:195], v[168:171]
    v_mfma_f32_16x16x32_bf16 v[172:175], v[192:195], v[108:111], v[172:175]
    v_mfma_f32_16x16x32_bf16 v[176:179], v[192:195], v[128:131], v[176:179]
    v_mfma_f32_16x16x32_bf16 v[156:159], v[32:35], v[196:199], v[156:159]
    v_mfma_f32_16x16x32_bf16 v[160:163], v[52:55], v[196:199], v[160:163]
    v_mfma_f32_16x16x32_bf16 v[164:167], v[72:75], v[196:199], v[164:167]
    v_mfma_f32_16x16x32_bf16 v[168:171], v[92:95], v[196:199], v[168:171]
    v_mfma_f32_16x16x32_bf16 v[172:175], v[196:199], v[112:115], v[172:175]
    v_mfma_f32_16x16x32_bf16 v[176:179], v[196:199], v[132:135], v[176:179]
    v_mfma_f32_16x16x32_bf16 v[220:223], v[16:19], v[200:203], 0
    v_mfma_f32_16x16x32_bf16 v[224:227], v[36:39], v[200:203], 0
    v_mfma_f32_16x16x32_bf16 v[228:231], v[56:59], v[200:203], 0
    v_mfma_f32_16x16x32_bf16 v[232:235], v[76:79], v[200:203], 0
    v_mfma_f32_16x16x32_bf16 v[236:239], v[200:203], v[96:99], 0
    v_mfma_f32_16x16x32_bf16 v[240:243], v[200:203], v[116:119], 0
    v_mfma_f32_16x16x32_bf16 v[220:223], v[20:23], v[204:207], v[220:223]
    v_mfma_f32_16x16x32_bf16 v[224:227], v[40:43], v[204:207], v[224:227]
    v_mfma_f32_16x16x32_bf16 v[228:231], v[60:63], v[204:207], v[228:231]
    v_mfma_f32_16x16x32_bf16 v[232:235], v[80:83], v[204:207], v[232:235]
    v_mfma_f32_16x16x32_bf16 v[236:239], v[204:207], v[100:103], v[236:239]
    v_mfma_f32_16x16x32_bf16 v[240:243], v[204:207], v[120:123], v[240:243]
    v_mfma_f32_16x16x32_bf16 v[220:223], v[24:27], v[208:211], v[220:223]
    v_mfma_f32_16x16x32_bf16 v[224:227], v[44:47], v[208:211], v[224:227]
    v_mfma_f32_16x16x32_bf16 v[228:231], v[64:67], v[208:211], v[228:231]
    v_mfma_f32_16x16x32_bf16 v[232:235], v[84:87], v[208:211], v[232:235]
    v_mfma_f32_16x16x32_bf16 v[236:239], v[208:211], v[104:107], v[236:239]
    v_mfma_f32_16x16x32_bf16 v[240:243], v[208:211], v[124:127], v[240:243]
    v_mfma_f32_16x16x32_bf16 v[220:223], v[28:31], v[212:215], v[220:223]
    v_mfma_f32_16x16x32_bf16 v[224:227], v[48:51], v[212:215], v[224:227]
    v_mfma_f32_16x16x32_bf16 v[228:231], v[68:71], v[212:215], v[228:231]
    v_mfma_f32_16x16x32_bf16 v[232:235], v[88:91], v[212:215], v[232:235]
    v_mfma_f32_16x16x32_bf16 v[236:239], v[212:215], v[108:111], v[236:239]
    v_mfma_f32_16x16x32_bf16 v[240:243], v[212:215], v[128:131], v[240:243]
    v_mfma_f32_16x16x32_bf16 v[220:223], v[32:35], v[216:219], v[220:223]
    v_mfma_f32_16x16x32_bf16 v[224:227], v[52:55], v[216:219], v[224:227]
    v_mfma_f32_16x16x32_bf16 v[228:231], v[72:75], v[216:219], v[228:231]
    v_mfma_f32_16x16x32_bf16 v[232:235], v[92:95], v[216:219], v[232:235]
    v_mfma_f32_16x16x32_bf16 v[236:239], v[216:219], v[112:115], v[236:239]
    v_mfma_f32_16x16x32_bf16 v[240:243], v[216:219], v[132:135], v[240:243]
    s_nop 7
    ds_write_b128 v9, v[156:159] offset:0
    ds_write_b128 v9, v[160:163] offset:1024
    ds_write_b128 v9, v[164:167] offset:2048
    ds_write_b128 v9, v[168:171] offset:3072
    ds_write_b128 v9, v[172:175] offset:4096
    ds_write_b128 v9, v[176:179] offset:5120
    ds_write_b128 v9, v[220:223] offset:6144
    ds_write_b128 v9, v[224:227] offset:7168
    ds_write_b128 v9, v[228:231] offset:8192
    ds_write_b128 v9, v[232:235] offset:9216
    ds_write_b128 v9, v[236:239] offset:10240
    ds_write_b128 v9, v[240:243] offset:11264
    s_add_u32 s77, s76, 1
    s_lshl_b32 s78, s29, 2
    s_add_u32 s78, s78, 24624
    v_mov_b32 v8, s77
    v_mov_b32 v9, s78
    s_waitcnt lgkmcnt(0)
    ds_write_b32 v9, v8
ch_w123_nox:
    s_add_u32 s76, s40, 2
    s_cmp_ge_u32 s76, 64
    s_cbranch_scc1 ch_w123_nold
    v_mov_b32 v9, 24664
ch_w123_sw:
    ds_read_b32 v8, v9
    s_waitcnt lgkmcnt(0)
    v_cmp_gt_u32 vcc, s40, v8
    s_add_u32 s50, s50, 1
    s_cmp_ge_u32 s50, 0x2000000
    s_cbranch_scc1 ch_end
    s_cbranch_vccz ch_w123_sw_x
    s_sleep 2
    s_branch ch_w123_sw
ch_w123_sw_x:
    s_mul_i32 s77, s76, 40960
    s_add_u32 s78, s77, 20480
    buffer_load_dwordx4 v[180:183], v252, s[64:67], s77 offen offset:0
    buffer_load_dwordx4 v[184:187], v252, s[64:67], s77 offen offset:1024
    buffer_load_dwordx4 v[188:191], v252, s[64:67], s77 offen offset:2048
    buffer_load_dwordx4 v[192:195], v252, s[64:67], s77 offen offset:3072
    s_add_u32 s79, s77, 4096
    buffer_load_dwordx4 v[196:199], v252, s[64:67], s79 offen
    buffer_load_dwordx4 v[200:203], v252, s[64:67], s78 offen offset:0
    buffer_load_dwordx4 v[204:207], v252, s[64:67], s78 offen offset:1024
    buffer_load_dwordx4 v[208:211], v252, s[64:67], s78 offen offset:2048
    buffer_load_dwordx4 v[212:215], v252, s[64:67], s78 offen offset:3072
    s_add_u32 s79, s78, 4096
    buffer_load_dwordx4 v[216:219], v252, s[64:67], s79 offen
ch_w123_nold:
    v_mov_b32 v9, 24656
ch_w123_pw:
    ds_read_b32 v8, v9
    s_waitcnt lgkmcnt(0)
    v_cmp_gt_u32 vcc, s40, v8
    s_add_u32 s50, s50, 1
    s_cmp_ge_u32 s50, 0x2000000
    s_cbranch_scc1 ch_end
    s_cbranch_vccz ch_w123_pw_x
    s_sleep 2
    s_branch ch_w123_pw
ch_w123_pw_x:
    s_mov_b32 s76, s40
    s_add_u32 s77, s76, 1
    v_mov_b32 v8, 24624
ch_xr_w2:
    ds_read_b128 v[244:247], v8
    s_waitcnt lgkmcnt(0)
    v_min_u32 v244, v244, v245
    v_min3_u32 v244, v244, v246, v247
    v_cmp_gt_u32 vcc, s77, v244
    s_add_u32 s50, s50, 1
    s_cmp_ge_u32 s50, 0x2000000
    s_cbranch_scc1 ch_end
    s_cbranch_vccnz ch_xr_w2
    v_mov_b32 v9, 24660
ch_xr_w7_2:
    ds_read_b32 v8, v9
    s_waitcnt lgkmcnt(0)
    v_cmp_gt_u32 vcc, s77, v8
    s_add_u32 s50, s50, 1
    s_cmp_ge_u32 s50, 0x2000000
    s_cbranch_scc1 ch_end
    s_cbranch_vccz ch_xr_w7_2_x
    s_sleep 2
    s_branch ch_xr_w7_2
ch_xr_w7_2_x:
    s_and_b32 s79, s76, 1
    s_mul_i32 s78, s79, 49152
    s_sub_u32 s80, s29, 1
    s_lshl_b32 s81, s80, 11
    s_add_u32 s78, s78, s81
    s_add_u32 s78, s78, 49152
    v_add_u32 v9, s78, v6
    ds_read_b128 v[136:139], v9 offset:0
    ds_read_b128 v[140:143], v9 offset:1024
    ds_read_b128 v[144:147], v9 offset:6144
    ds_read_b128 v[148:151], v9 offset:7168
    ds_read_b128 v[152:155], v9 offset:12288
    ds_read_b128 v[156:159], v9 offset:13312
    ds_read_b128 v[160:163], v9 offset:18432
    ds_read_b128 v[164:167], v9 offset:19456
    ds_read_b128 v[168:171], v9 offset:24576
    ds_read_b128 v[172:175], v9 offset:25600
    ds_read_b128 v[176:179], v9 offset:30720
    ds_read_b128 v[220:223], v9 offset:31744
    s_waitcnt lgkmcnt(8)
    ds_read_b128 v[224:227], v9 offset:36864
    ds_read_b128 v[228:231], v9 offset:37888
    ds_read_b128 v[232:235], v9 offset:43008
    ds_read_b128 v[236:239], v9 offset:44032
    s_waitcnt lgkmcnt(0)
    v_pk_add_f32 v[136:137], v[136:137], v[152:153]
    v_pk_add_f32 v[138:139], v[138:139], v[154:155]
    v_pk_add_f32 v[140:141], v[140:141], v[156:157]
    v_pk_add_f32 v[142:143], v[142:143], v[158:159]
    v_pk_add_f32 v[144:145], v[144:145], v[160:161]
    v_pk_add_f32 v[146:147], v[146:147], v[162:163]
    v_pk_add_f32 v[148:149], v[148:149], v[164:165]
    v_pk_add_f32 v[150:151], v[150:151], v[166:167]
    v_pk_add_f32 v[136:137], v[136:137], v[168:169]
    v_pk_add_f32 v[138:139], v[138:139], v[170:171]
    v_pk_add_f32 v[140:141], v[140:141], v[172:173]
    v_pk_add_f32 v[142:143], v[142:143], v[174:175]
    v_pk_add_f32 v[144:145], v[144:145], v[176:177]
    v_pk_add_f32 v[146:147], v[146:147], v[178:179]
    v_pk_add_f32 v[148:149], v[148:149], v[220:221]
    v_pk_add_f32 v[150:151], v[150:151], v[222:223]
    v_pk_add_f32 v[136:137], v[136:137], v[224:225]
    v_pk_add_f32 v[138:139], v[138:139], v[226:227]
    v_pk_add_f32 v[140:141], v[140:141], v[228:229]
    v_pk_add_f32 v[142:143], v[142:143], v[230:231]
    v_pk_add_f32 v[144:145], v[144:145], v[232:233]
    v_pk_add_f32 v[146:147], v[146:147], v[234:235]
    v_pk_add_f32 v[148:149], v[148:149], v[236:237]
    v_pk_add_f32 v[150:151], v[150:151], v[238:239]
    v_cvt_pk_bf16_f32 v240, v136, v137
    v_cvt_pk_bf16_f32 v241, v138, v139
    v_cvt_pk_bf16_f32 v242, v140, v141
    v_cvt_pk_bf16_f32 v243, v142, v143
    v_cvt_pk_bf16_f32 v244, v144, v145
    v_cvt_pk_bf16_f32 v245, v146, v147
    v_cvt_pk_bf16_f32 v246, v148, v149
    v_cvt_pk_bf16_f32 v247, v150, v151
    s_lshl_b32 s81, s76, 5
    s_add_u32 s81, s81, s33
    s_lshl_b32 s81, s81, 3
    s_add_u32 s81, s81, s32
    s_lshl_b32 s81, s81, 11
    s_mul_i32 s82, s80, 33554432
    s_add_u32 s81, s81, s82
    s_cmp_eq_u32 s80, 2
    s_cbranch_scc1 ch_xr_v2
    buffer_store_dwordx4 v[240:243], v6, s[68:71], s81 offen
    buffer_store_dwordx4 v[244:247], v6, s[68:71], s81 offen offset:1024
    s_cmp_eq_u32 s80, 0
    s_cbranch_scc1 ch_xr_done2
    s_lshl_b32 s81, s79, 11
    s_add_u32 s81, s81, 40960
    v_add_u32 v9, s81, v6
    ds_write_b128 v9, v[240:243]
    ds_write_b128 v9, v[244:247] offset:1024
    s_branch ch_xr_done2
ch_xr_v2:
    v_mov_b32 v160, v240
    v_mov_b32 v161, v241
    v_mov_b32 v162, v244
    v_mov_b32 v163, v245
    v_mov_b32 v164, v242
    v_mov_b32 v165, v243
    v_mov_b32 v166, v246
    v_mov_b32 v167, v247
    buffer_store_dwordx4 v[160:163], v6, s[68:71], s81 offen
    buffer_store_dwordx4 v[164:167], v6, s[68:71], s81 offen offset:1024
    s_lshl_b32 s81, s79, 11
    s_add_u32 s81, s81, 45056
    v_add_u32 v9, s81, v6
    ds_write_b128 v9, v[160:163]
    ds_write_b128 v9, v[164:167] offset:1024
ch_xr_done2:
    s_lshl_b32 s78, s29, 2
    s_add_u32 s78, s78, 24640
    v_mov_b32 v8, s77
    v_mov_b32 v9, s78
    s_waitcnt lgkmcnt(0)
    ds_write_b32 v9, v8
    s_branch ch_w123_loop
ch_w0_setup:
    s_add_u32 s20, s4, 0x8620000
    s_addc_u32 s21, s5, 0
    s_and_b32 s21, s21, 0xffff
    s_mov_b32 s22, 0x1000000
    s_mov_b32 s23, 0x20000
    s_add_u32 s24, s4, 0x9620000
    s_addc_u32 s25, s5, 0
    s_and_b32 s25, s25, 0xffff
    s_mov_b32 s26, 0x800000
    s_mov_b32 s27, 0x20000
    v_mov_b32 v228, 0
    v_mov_b32 v229, 0
    v_mov_b32 v230, 0
    v_mov_b32 v231, 0
    v_mov_b32 v232, 0
    v_mov_b32 v233, 0
    v_mov_b32 v234, 0
    v_mov_b32 v235, 0
    v_mov_b32 v236, 0
    v_mov_b32 v237, 0
    v_mov_b32 v238, 0
    v_mov_b32 v239, 0
    v_mov_b32 v240, 0
    v_mov_b32 v241, 0
    v_mov_b32 v242, 0
    v_mov_b32 v243, 0
    s_mov_b32 s36, 24576
    v_mul_lo_u32 v10, v1, s36
    v_lshl_add_u32 v10, v2, 3, v10
    s_lshl_b32 s36, s34, 1
    s_add_u32 s36, s36, 12288
    v_add_u32 v10, s36, v10
    v_add_u32 v11, s34, v1
    v_lshlrev_b32 v11, 12, v11
    v_lshl_add_u32 v11, v2, 3, v11
    s_lshl_b32 s36, s33, 3
    s_add_u32 s36, s36, s32
    s_lshl_b32 s37, s36, 10
    v_add_u32 v12, s37, v6
    s_lshl_b32 s37, s36, 9
    v_lshlrev_b32 v13, 3, v0
    v_add_u32 v13, s37, v13
    v_and_b32 v14, 7, v1
    v_lshlrev_b32 v14, 4, v14
    v_lshl_add_u32 v14, v2, 7, v14
    v_mov_b32 v15, v14
    s_lshl_b32 s36, s28, 5
    s_add_u32 s36, s36, s30
    s_mul_i32 s37, s36, 1536
    s_add_u32 s37, s37, 163840
    v_add_u32 v14, s37, v14
    s_mul_i32 s37, s36, 512
    s_add_u32 s37, s37, 950272
    v_add_u32 v4, s37, v15
    v_lshrrev_b32 v9, 3, v1
    v_mul_u32_u24 v9, 6144, v9
    v_add_u32 v15, v15, v9
    s_lshl_b32 s36, s28, 5
    s_lshl_b32 s37, s31, 3
    s_add_u32 s36, s36, s37
    s_mul_i32 s37, s36, 1536
    s_add_u32 s37, s37, 163840
    v_add_u32 v15, s37, v15
    s_waitcnt vmcnt(0)
ch_w0_loop:
    s_add_u32 s47, s40, 1
    v_mov_b32 v8, 24640
ch_w0_rw:
    ds_read_b128 v[180:183], v8
    s_waitcnt lgkmcnt(0)
    v_min3_u32 v180, v181, v182, v183
    v_cmp_gt_u32 vcc, s47, v180
    s_add_u32 s50, s50, 1
    s_cmp_ge_u32 s50, 0x2000000
    s_cbranch_scc1 ch_end
    s_cbranch_vccnz ch_w0_rw
    s_and_b32 s42, s40, 1
    s_lshl_b32 s42, s42, 11
    v_add_u32 v9, s42, v6
    ds_read_b128 v[228:231], v9 offset:40960
    ds_read_b128 v[232:235], v9 offset:41984
    ds_read_b128 v[236:239], v9 offset:45056
    ds_read_b128 v[240:243], v9 offset:46080
    s_waitcnt lgkmcnt(0)
    s_and_b32 s41, s40, 1
    s_mul_i32 s41, s41, 81920
    v_mov_b32 v9, 24604
ch_w0_lw:
    ds_read_b32 v8, v9
    s_waitcnt lgkmcnt(0)
    v_cmp_gt_u32 vcc, s40, v8
    s_add_u32 s50, s50, 1
    s_cmp_ge_u32 s50, 0x2000000
    s_cbranch_scc1 ch_end
    s_cbranch_vccz ch_w0_lw_x
    s_sleep 2
    s_branch ch_w0_lw
ch_w0_lw_x:
    s_mov_b32 exec_lo, 0xff00ff
    s_mov_b32 exec_hi, 0xff00ff
ch_w0_poll:
    buffer_load_dwordx4 v[136:139], v3, s[8:11], s41 offen offset:0 sc1
    buffer_load_dwordx4 v[140:143], v3, s[8:11], s41 offen offset:512 sc1
    buffer_load_dwordx4 v[144:147], v3, s[8:11], s41 offen offset:1024 sc1
    buffer_load_dwordx4 v[148:151], v3, s[8:11], s41 offen offset:1536 sc1
    buffer_load_dwordx4 v[152:155], v3, s[8:11], s41 offen offset:2048 sc1
    s_waitcnt vmcnt(0)
    v_max3_u32 v8, v136, v137, v138
    v_max3_u32 v8, v8, v139, v140
    v_max3_u32 v8, v8, v141, v142
    v_max3_u32 v8, v8, v143, v144
    v_max3_u32 v8, v8, v145, v146
    v_max3_u32 v8, v8, v147, v148
    v_max3_u32 v8, v8, v149, v150
    v_max3_u32 v8, v8, v151, v152
    v_max3_u32 v8, v8, v153, v154
    v_max_u32 v8, v8, v155
    v_cmp_eq_u32 vcc, -1, v8
    s_add_u32 s50, s50, 1
    s_cmp_ge_u32 s50, 0x2000000
    s_cbranch_scc1 ch_end
    s_cbranch_vccnz ch_w0_poll
    s_mov_b64 exec, -1
    v_mfma_f32_16x16x32_bf16 v[156:159], v[16:19], v[136:139], 0
    v_mfma_f32_16x16x32_bf16 v[160:163], v[36:39], v[136:139], 0
    v_mfma_f32_16x16x32_bf16 v[164:167], v[56:59], v[136:139], 0
    v_mfma_f32_16x16x32_bf16 v[168:171], v[76:79], v[136:139], 0
    v_mfma_f32_16x16x32_bf16 v[172:175], v[136:139], v[96:99], 0
    v_mfma_f32_16x16x32_bf16 v[176:179], v[136:139], v[116:119], 0
    v_mfma_f32_16x16x32_bf16 v[156:159], v[20:23], v[140:143], v[156:159]
    v_mfma_f32_16x16x32_bf16 v[160:163], v[40:43], v[140:143], v[160:163]
    v_mfma_f32_16x16x32_bf16 v[164:167], v[60:63], v[140:143], v[164:167]
    v_mfma_f32_16x16x32_bf16 v[168:171], v[80:83], v[140:143], v[168:171]
    v_mfma_f32_16x16x32_bf16 v[172:175], v[140:143], v[100:103], v[172:175]
    v_mfma_f32_16x16x32_bf16 v[176:179], v[140:143], v[120:123], v[176:179]
    v_mfma_f32_16x16x32_bf16 v[156:159], v[24:27], v[144:147], v[156:159]
    v_mfma_f32_16x16x32_bf16 v[160:163], v[44:47], v[144:147], v[160:163]
    v_mfma_f32_16x16x32_bf16 v[164:167], v[64:67], v[144:147], v[164:167]
    v_mfma_f32_16x16x32_bf16 v[168:171], v[84:87], v[144:147], v[168:171]
    v_mfma_f32_16x16x32_bf16 v[172:175], v[144:147], v[104:107], v[172:175]
    v_mfma_f32_16x16x32_bf16 v[176:179], v[144:147], v[124:127], v[176:179]
    v_mfma_f32_16x16x32_bf16 v[156:159], v[28:31], v[148:151], v[156:159]
    v_mfma_f32_16x16x32_bf16 v[160:163], v[48:51], v[148:151], v[160:163]
    v_mfma_f32_16x16x32_bf16 v[164:167], v[68:71], v[148:151], v[164:167]
    v_mfma_f32_16x16x32_bf16 v[168:171], v[88:91], v[148:151], v[168:171]
    v_mfma_f32_16x16x32_bf16 v[172:175], v[148:151], v[108:111], v[172:175]
    v_mfma_f32_16x16x32_bf16 v[176:179], v[148:151], v[128:131], v[176:179]
    v_mfma_f32_16x16x32_bf16 v[156:159], v[32:35], v[152:155], v[156:159]
    v_mfma_f32_16x16x32_bf16 v[160:163], v[52:55], v[152:155], v[160:163]
    v_mfma_f32_16x16x32_bf16 v[164:167], v[72:75], v[152:155], v[164:167]
    v_mfma_f32_16x16x32_bf16 v[168:171], v[92:95], v[152:155], v[168:171]
    v_mfma_f32_16x16x32_bf16 v[172:175], v[152:155], v[112:115], v[172:175]
    v_mfma_f32_16x16x32_bf16 v[176:179], v[152:155], v[132:135], v[176:179]
    s_add_u32 s42, s40, 1
    s_and_b32 s42, s42, 1
    s_mul_i32 s43, s42, 393216
    s_mul_i32 s46, s42, 131072
    v_mov_b32 v224, -1
    v_mov_b32 v225, -1
    v_mov_b32 v226, -1
    v_mov_b32 v227, -1
    s_mov_b32 exec_lo, 0xff00ff
    s_mov_b32 exec_hi, 0xff00ff
    buffer_store_dwordx4 v[224:227], v14, s[8:11], s43 offen offset:0
    buffer_store_dwordx4 v[224:227], v14, s[8:11], s43 offen offset:512
    buffer_store_dwordx4 v[224:227], v14, s[8:11], s43 offen offset:1024
    s_mov_b64 exec, -1
    s_add_u32 s47, s40, 1
    v_mov_b32 v8, 24576
ch_w0_fl:
    ds_read_b128 v[180:183], v8
    s_waitcnt lgkmcnt(0)
    v_min3_u32 v180, v181, v182, v183
    v_cmp_gt_u32 vcc, s47, v180
    s_add_u32 s50, s50, 1
    s_cmp_ge_u32 s50, 0x2000000
    s_cbranch_scc1 ch_end
    s_cbranch_vccnz ch_w0_fl
    ds_read_b128 v[180:183], v6 offset:6144
    ds_read_b128 v[184:187], v6 offset:7168
    ds_read_b128 v[188:191], v6 offset:8192
    ds_read_b128 v[192:195], v6 offset:9216
    ds_read_b128 v[196:199], v6 offset:12288
    ds_read_b128 v[200:203], v6 offset:13312
    ds_read_b128 v[204:207], v6 offset:14336
    ds_read_b128 v[208:211], v6 offset:15360
    ds_read_b128 v[212:215], v6 offset:18432
    ds_read_b128 v[216:219], v6 offset:19456
    ds_read_b128 v[220:223], v6 offset:20480
    ds_read_b128 v[244:247], v6 offset:21504
    s_mov_b32 exec_lo, 0xff00ff
    s_mov_b32 exec_hi, 0xff00ff
    buffer_store_dwordx4 v[224:227], v4, s[8:11], s46 offen
    s_mov_b64 exec, -1
    s_waitcnt lgkmcnt(0)
    v_pk_add_f32 v[156:157], v[156:157], v[180:181]
    v_pk_add_f32 v[158:159], v[158:159], v[182:183]
    v_pk_add_f32 v[160:161], v[160:161], v[184:185]
    v_pk_add_f32 v[162:163], v[162:163], v[186:187]
    v_pk_add_f32 v[164:165], v[164:165], v[188:189]
    v_pk_add_f32 v[166:167], v[166:167], v[190:191]
    v_pk_add_f32 v[168:169], v[168:169], v[192:193]
    v_pk_add_f32 v[170:171], v[170:171], v[194:195]
    v_pk_add_f32 v[156:157], v[156:157], v[196:197]
    v_pk_add_f32 v[158:159], v[158:159], v[198:199]
    v_pk_add_f32 v[160:161], v[160:161], v[200:201]
    v_pk_add_f32 v[162:163], v[162:163], v[202:203]
    v_pk_add_f32 v[164:165], v[164:165], v[204:205]
    v_pk_add_f32 v[166:167], v[166:167], v[206:207]
    v_pk_add_f32 v[168:169], v[168:169], v[208:209]
    v_pk_add_f32 v[170:171], v[170:171], v[210:211]
    v_pk_add_f32 v[156:157], v[156:157], v[212:213]
    v_pk_add_f32 v[158:159], v[158:159], v[214:215]
    v_pk_add_f32 v[160:161], v[160:161], v[216:217]
    v_pk_add_f32 v[162:163], v[162:163], v[218:219]
    v_pk_add_f32 v[164:165], v[164:165], v[220:221]
    v_pk_add_f32 v[166:167], v[166:167], v[222:223]
    v_pk_add_f32 v[168:169], v[168:169], v[244:245]
    v_pk_add_f32 v[170:171], v[170:171], v[246:247]
    ds_read_b128 v[180:183], v6 offset:10240
    ds_read_b128 v[184:187], v6 offset:11264
    ds_read_b128 v[188:191], v6 offset:16384
    ds_read_b128 v[192:195], v6 offset:17408
    ds_read_b128 v[196:199], v6 offset:22528
    ds_read_b128 v[200:203], v6 offset:23552
    v_cvt_pk_bf16_f32 v244, v156, v157
    v_cvt_pk_bf16_f32 v245, v158, v159
    v_cvt_pk_bf16_f32 v248, v164, v165
    v_cvt_pk_bf16_f32 v249, v166, v167
    v_cvt_pk_bf16_f32 v246, v160, v161
    v_cvt_pk_bf16_f32 v247, v162, v163
    v_cvt_pk_bf16_f32 v250, v168, v169
    v_cvt_pk_bf16_f32 v251, v170, v171
    s_nop 1
    v_mfma_f32_16x16x32_bf16 v[156:159], v[228:231], v[244:247], 0
    v_mfma_f32_16x16x32_bf16 v[160:163], v[232:235], v[244:247], 0
    v_mfma_f32_16x16x32_bf16 v[164:167], v[248:251], v[244:247], 0
    s_lshl_b32 s42, s40, 18
    s_lshl_b32 s48, s40, 17
    s_and_b32 s41, s40, 1
    s_mul_i32 s43, s41, 393216
    s_mul_i32 s46, s41, 131072
    s_mov_b32 exec_lo, 0xff00ff
    s_mov_b32 exec_hi, 0xff00ff
    s_nop 3
    v_min_u32 v156, s44, v156
    v_min_u32 v157, s44, v157
    v_min_u32 v158, s44, v158
    v_min_u32 v159, s44, v159
    v_min_u32 v160, s44, v160
    v_min_u32 v161, s44, v161
    v_min_u32 v162, s44, v162
    v_min_u32 v163, s44, v163
    v_min_u32 v164, s44, v164
    v_min_u32 v165, s44, v165
    v_min_u32 v166, s44, v166
    v_min_u32 v167, s44, v167
    buffer_store_dwordx4 v[156:159], v14, s[8:11], s43 offen offset:0
    buffer_store_dwordx4 v[160:163], v14, s[8:11], s43 offen offset:512
    buffer_store_dwordx4 v[164:167], v14, s[8:11], s43 offen offset:1024
    s_mov_b64 exec, -1
    buffer_store_dwordx4 v[248:251], v12, s[20:23], s42 offen
    s_waitcnt lgkmcnt(0)
    v_pk_add_f32 v[172:173], v[172:173], v[180:181]
    v_pk_add_f32 v[174:175], v[174:175], v[182:183]
    v_pk_add_f32 v[176:177], v[176:177], v[184:185]
    v_pk_add_f32 v[178:179], v[178:179], v[186:187]
    v_pk_add_f32 v[172:173], v[172:173], v[188:189]
    v_pk_add_f32 v[174:175], v[174:175], v[190:191]
    v_pk_add_f32 v[176:177], v[176:177], v[192:193]
    v_pk_add_f32 v[178:179], v[178:179], v[194:195]
    v_pk_add_f32 v[172:173], v[172:173], v[196:197]
    v_pk_add_f32 v[174:175], v[174:175], v[198:199]
    v_pk_add_f32 v[176:177], v[176:177], v[200:201]
    v_pk_add_f32 v[178:179], v[178:179], v[202:203]
    v_cvt_pk_bf16_f32 v172, v172, v173
    v_cvt_pk_bf16_f32 v173, v174, v175
    v_mov_b32 v174, 0
    v_mov_b32 v175, 0
    v_cvt_pk_bf16_f32 v176, v176, v177
    v_cvt_pk_bf16_f32 v177, v178, v179
    v_mov_b32 v178, 0
    v_mov_b32 v179, 0
    s_mov_b32 exec_lo, 0x0
    s_mov_b32 exec_hi, 0xffffffff
    v_mov_b32 v172, 0
    v_mov_b32 v173, 0
    v_mov_b32 v176, 0
    v_mov_b32 v177, 0
    s_mov_b32 exec_lo, 0xffffffff
    s_mov_b32 exec_hi, 0x0
    buffer_store_dwordx2 v[172:173], v13, s[24:27], s48 offen
    buffer_store_dwordx2 v[176:177], v13, s[24:27], s48 offen offset:256
    s_mov_b64 exec, -1
    s_cmp_eq_u32 s40, 63
    s_cbranch_scc1 ch_end
ch_w0_sg:
    s_add_u32 s47, s43, 0
    buffer_load_dwordx4 v[180:183], v15, s[8:11], s47 offen offset:0 sc1
    buffer_load_dwordx4 v[184:187], v15, s[8:11], s47 offen offset:512 sc1
    buffer_load_dwordx4 v[188:191], v15, s[8:11], s47 offen offset:1024 sc1
    s_add_u32 s47, s43, 1536
    buffer_load_dwordx4 v[192:195], v15, s[8:11], s47 offen offset:0 sc1
    buffer_load_dwordx4 v[196:199], v15, s[8:11], s47 offen offset:512 sc1
    buffer_load_dwordx4 v[200:203], v15, s[8:11], s47 offen offset:1024 sc1
    s_add_u32 s47, s43, 3072
    buffer_load_dwordx4 v[204:207], v15, s[8:11], s47 offen offset:0 sc1
    buffer_load_dwordx4 v[208:211], v15, s[8:11], s47 offen offset:512 sc1
    buffer_load_dwordx4 v[212:215], v15, s[8:11], s47 offen offset:1024 sc1
    s_add_u32 s47, s43, 4608
    buffer_load_dwordx4 v[216:219], v15, s[8:11], s47 offen offset:0 sc1
    buffer_load_dwordx4 v[220:223], v15, s[8:11], s47 offen offset:512 sc1
    buffer_load_dwordx4 v[224:227], v15, s[8:11], s47 offen offset:1024 sc1
    s_waitcnt vmcnt(0)
    v_max3_u32 v8, v180, v181, v182
    v_max3_u32 v8, v8, v183, v184
    v_max3_u32 v8, v8, v185, v186
    v_max3_u32 v8, v8, v187, v188
    v_max3_u32 v8, v8, v189, v190
    v_max3_u32 v8, v8, v191, v192
    v_max3_u32 v8, v8, v193, v194
    v_max3_u32 v8, v8, v195, v196
    v_max3_u32 v8, v8, v197, v198
    v_max3_u32 v8, v8, v199, v200
    v_max3_u32 v8, v8, v201, v202
    v_max3_u32 v8, v8, v203, v204
    v_max3_u32 v8, v8, v205, v206
    v_max3_u32 v8, v8, v207, v208
    v_max3_u32 v8, v8, v209, v210
    v_max3_u32 v8, v8, v211, v212
    v_max3_u32 v8, v8, v213, v214
    v_max3_u32 v8, v8, v215, v216
    v_max3_u32 v8, v8, v217, v218
    v_max3_u32 v8, v8, v219, v220
    v_max3_u32 v8, v8, v221, v222
    v_max3_u32 v8, v8, v223, v224
    v_max3_u32 v8, v8, v225, v226
    v_max_u32 v8, v8, v227
    v_cmp_eq_u32 vcc, -1, v8
    s_add_u32 s50, s50, 1
    s_cmp_ge_u32 s50, 0x2000000
    s_cbranch_scc1 ch_end
    s_cbranch_vccnz ch_w0_sg
    s_add_u32 s47, s40, 1
    v_mov_b32 v9, 24664
    v_mov_b32 v8, s47
    ds_write_b32 v9, v8
    v_pk_add_f32 v[156:157], v[180:181], v[192:193]
    v_pk_add_f32 v[204:205], v[204:205], v[216:217]
    v_pk_add_f32 v[158:159], v[182:183], v[194:195]
    v_pk_add_f32 v[206:207], v[206:207], v[218:219]
    v_pk_add_f32 v[160:161], v[184:185], v[196:197]
    v_pk_add_f32 v[208:209], v[208:209], v[220:221]
    v_pk_add_f32 v[162:163], v[186:187], v[198:199]
    v_pk_add_f32 v[210:211], v[210:211], v[222:223]
    v_pk_add_f32 v[164:165], v[188:189], v[200:201]
    v_pk_add_f32 v[212:213], v[212:213], v[224:225]
    v_pk_add_f32 v[166:167], v[190:191], v[202:203]
    v_pk_add_f32 v[214:215], v[214:215], v[226:227]
    v_pk_add_f32 v[156:157], v[156:157], v[204:205]
    v_pk_add_f32 v[158:159], v[158:159], v[206:207]
    v_pk_add_f32 v[160:161], v[160:161], v[208:209]
    v_pk_add_f32 v[162:163], v[162:163], v[210:211]
    v_pk_add_f32 v[164:165], v[164:165], v[212:213]
    v_pk_add_f32 v[166:167], v[166:167], v[214:215]
    s_nop 1
    v_mov_b32_dpp v180, v156 row_ror:8 row_mask:0xf bank_mask:0xf
    v_mov_b32_dpp v181, v157 row_ror:8 row_mask:0xf bank_mask:0xf
    v_mov_b32_dpp v182, v158 row_ror:8 row_mask:0xf bank_mask:0xf
    v_mov_b32_dpp v183, v159 row_ror:8 row_mask:0xf bank_mask:0xf
    v_mov_b32_dpp v184, v160 row_ror:8 row_mask:0xf bank_mask:0xf
    v_mov_b32_dpp v185, v161 row_ror:8 row_mask:0xf bank_mask:0xf
    v_mov_b32_dpp v186, v162 row_ror:8 row_mask:0xf bank_mask:0xf
    v_mov_b32_dpp v187, v163 row_ror:8 row_mask:0xf bank_mask:0xf
    v_mov_b32_dpp v188, v164 row_ror:8 row_mask:0xf bank_mask:0xf
    v_mov_b32_dpp v189, v165 row_ror:8 row_mask:0xf bank_mask:0xf
    v_mov_b32_dpp v190, v166 row_ror:8 row_mask:0xf bank_mask:0xf
    v_mov_b32_dpp v191, v167 row_ror:8 row_mask:0xf bank_mask:0xf
    s_nop 1
    v_pk_add_f32 v[156:157], v[156:157], v[180:181]
    v_pk_add_f32 v[158:159], v[158:159], v[182:183]
    v_pk_add_f32 v[160:161], v[160:161], v[184:185]
    v_pk_add_f32 v[162:163], v[162:163], v[186:187]
    v_pk_add_f32 v[164:165], v[164:165], v[188:189]
    v_pk_add_f32 v[166:167], v[166:167], v[190:191]
    s_mov_b32 s45, 0x3d93cd3a
    s_mov_b32 s47, 0xffff0000
    v_cvt_pk_bf16_f32 v180, v156, v157
    v_cvt_pk_bf16_f32 v182, v158, v159
    v_cvt_pk_bf16_f32 v184, v160, v161
    v_cvt_pk_bf16_f32 v186, v162, v163
    v_cvt_pk_bf16_f32 v188, v164, v165
    v_cvt_pk_bf16_f32 v190, v166, v167
    v_lshlrev_b32 v156, 16, v180
    v_and_b32 v157, s47, v180
    v_lshlrev_b32 v158, 16, v182
    v_and_b32 v159, s47, v182
    v_lshlrev_b32 v160, 16, v184
    v_and_b32 v161, s47, v184
    v_lshlrev_b32 v162, 16, v186
    v_and_b32 v163, s47, v186
    v_lshlrev_b32 v164, 16, v188
    v_and_b32 v165, s47, v188
    v_lshlrev_b32 v166, 16, v190
    v_and_b32 v167, s47, v190
    v_mul_f32 v156, s45, v156
    v_mul_f32 v157, s45, v157
    v_mul_f32 v158, s45, v158
    v_mul_f32 v159, s45, v159
    v_mul_f32 v160, s45, v160
    v_mul_f32 v161, s45, v161
    v_mul_f32 v162, s45, v162
    v_mul_f32 v163, s45, v163
    v_mul_f32 v164, s45, v164
    v_mul_f32 v165, s45, v165
    v_mul_f32 v166, s45, v166
    v_mul_f32 v167, s45, v167
    v_cvt_pk_bf16_f32 v180, v156, v157
    v_cvt_pk_bf16_f32 v182, v158, v159
    v_cvt_pk_bf16_f32 v184, v160, v161
    v_cvt_pk_bf16_f32 v186, v162, v163
    v_cvt_pk_bf16_f32 v188, v164, v165
    v_cvt_pk_bf16_f32 v190, v166, v167
    v_lshlrev_b32 v156, 16, v180
    v_and_b32 v157, s47, v180
    v_lshlrev_b32 v158, 16, v182
    v_and_b32 v159, s47, v182
    v_lshlrev_b32 v160, 16, v184
    v_and_b32 v161, s47, v184
    v_lshlrev_b32 v162, 16, v186
    v_and_b32 v163, s47, v186
    v_lshlrev_b32 v164, 16, v188
    v_and_b32 v165, s47, v188
    v_lshlrev_b32 v166, 16, v190
    v_and_b32 v167, s47, v190
    s_mov_b32 exec_lo, 0x0
    s_mov_b32 exec_hi, 0xffffffff
    v_mov_b32 v164, 0xff800000
    v_mov_b32 v165, 0xff800000
    v_mov_b32 v166, 0xff800000
    v_mov_b32 v167, 0xff800000
    s_mov_b64 exec, -1
    v_max3_f32 v8, v156, v157, v158
    v_max3_f32 v9, v159, v160, v161
    v_max3_f32 v8, v8, v162, v163
    v_max3_f32 v9, v9, v164, v165
    v_max3_f32 v8, v8, v166, v167
    v_max_f32 v8, v8, v9
    v_mov_b32 v180, v8
    v_mov_b32 v181, v8
    s_nop 1
    v_permlane32_swap_b32 v180, v181
    s_nop 1
    v_max_f32 v8, v180, v181
    v_mov_b32 v180, v8
    v_mov_b32 v181, v8
    s_nop 1
    v_permlane16_swap_b32 v180, v181
    s_nop 1
    v_max_f32 v8, v180, v181
    v_mul_f32 v9, 0x3fb8aa3b, v8
    s_mov_b32 s45, 0x3fb8aa3b
    v_fma_f32 v156, v156, s45, -v9
    v_fma_f32 v157, v157, s45, -v9
    v_fma_f32 v158, v158, s45, -v9
    v_fma_f32 v159, v159, s45, -v9
    v_fma_f32 v160, v160, s45, -v9
    v_fma_f32 v161, v161, s45, -v9
    v_fma_f32 v162, v162, s45, -v9
    v_fma_f32 v163, v163, s45, -v9
    v_fma_f32 v164, v164, s45, -v9
    v_fma_f32 v165, v165, s45, -v9
    v_fma_f32 v166, v166, s45, -v9
    v_fma_f32 v167, v167, s45, -v9
    v_exp_f32 v156, v156
    v_exp_f32 v157, v157
    v_exp_f32 v158, v158
    v_exp_f32 v159, v159
    v_exp_f32 v160, v160
    v_exp_f32 v161, v161
    v_exp_f32 v162, v162
    v_exp_f32 v163, v163
    v_exp_f32 v164, v164
    v_exp_f32 v165, v165
    v_exp_f32 v166, v166
    v_exp_f32 v167, v167
    s_nop 0
    v_pk_add_f32 v[182:183], v[156:157], v[158:159]
    v_pk_add_f32 v[184:185], v[160:161], v[162:163]
    v_pk_add_f32 v[186:187], v[164:165], v[166:167]
    v_pk_add_f32 v[182:183], v[182:183], v[184:185]
    v_pk_add_f32 v[182:183], v[182:183], v[186:187]
    v_add_f32 v8, v182, v183
    v_mov_b32 v180, v8
    v_mov_b32 v181, v8
    s_nop 1
    v_permlane32_swap_b32 v180, v181
    s_nop 1
    v_add_f32 v8, v180, v181
    v_mov_b32 v180, v8
    v_mov_b32 v181, v8
    s_nop 1
    v_permlane16_swap_b32 v180, v181
    s_nop 1
    v_add_f32 v8, v180, v181
    v_rcp_f32 v8, v8
    s_nop 0
    v_mul_f32 v156, v156, v8
    v_mul_f32 v157, v157, v8
    v_mul_f32 v158, v158, v8
    v_mul_f32 v159, v159, v8
    v_mul_f32 v160, v160, v8
    v_mul_f32 v161, v161, v8
    v_mul_f32 v162, v162, v8
    v_mul_f32 v163, v163, v8
    v_mul_f32 v164, v164, v8
    v_mul_f32 v165, v165, v8
    v_mul_f32 v166, v166, v8
    v_mul_f32 v167, v167, v8
    v_cvt_pk_bf16_f32 v196, v156, v157
    v_cvt_pk_bf16_f32 v197, v158, v159
    v_cvt_pk_bf16_f32 v198, v160, v161
    v_cvt_pk_bf16_f32 v199, v162, v163
    v_cvt_pk_bf16_f32 v200, v164, v165
    v_cvt_pk_bf16_f32 v201, v166, v167
    v_mov_b32 v202, 0
    v_mov_b32 v203, 0
    s_nop 1
    v_mfma_f32_16x16x32_bf16 v[188:191], v[236:239], v[196:199], 0
    v_mfma_f32_16x16x32_bf16 v[192:195], v[240:243], v[196:199], 0
    v_mfma_f32_16x16x32_bf16 v[188:191], v[172:175], v[200:203], v[188:191]
    v_mfma_f32_16x16x32_bf16 v[192:195], v[176:179], v[200:203], v[192:195]
    s_add_u32 s47, s40, 1
    v_mov_b32 v9, 24600
    v_mov_b32 v8, s47
    s_nop 5
    v_cvt_pk_bf16_f32 v180, v188, v189
    v_cvt_pk_bf16_f32 v181, v190, v191
    v_cvt_pk_bf16_f32 v182, v192, v193
    v_cvt_pk_bf16_f32 v183, v194, v195
    s_mov_b32 exec_lo, 0x0
    s_mov_b32 exec_hi, 0xffffffff
    v_mov_b32 v182, 0
    v_mov_b32 v183, 0
    s_mov_b32 exec_lo, 0xff00ff
    s_mov_b32 exec_hi, 0xff00ff
    v_min_u32 v180, s44, v180
    v_min_u32 v181, s44, v181
    v_min_u32 v182, s44, v182
    v_min_u32 v183, s44, v183
    buffer_store_dwordx4 v[180:183], v4, s[8:11], s46 offen
    s_mov_b64 exec, -1
    ds_write_b32 v9, v8
    s_add_u32 s40, s40, 1
    s_branch ch_w0_loop
ch_wo:
    s_sub_u32 s38, s29, 4
    s_add_u32 s12, s4, 0x1900000
    s_addc_u32 s13, s5, 0
    s_and_b32 s13, s13, 0xffff
    s_mov_b32 s14, 0x780000
    s_mov_b32 s15, 0x20000
    v_mov_b32 v16, 0
    v_mov_b32 v17, 0
    v_mov_b32 v18, 0
    v_mov_b32 v19, 0
    v_mov_b32 v20, 0
    v_mov_b32 v21, 0
    v_mov_b32 v22, 0
    v_mov_b32 v23, 0
    v_mov_b32 v24, 0
    v_mov_b32 v25, 0
    v_mov_b32 v26, 0
    v_mov_b32 v27, 0
    v_mov_b32 v28, 0
    v_mov_b32 v29, 0
    v_mov_b32 v30, 0
    v_mov_b32 v31, 0
    v_mov_b32 v32, 0
    v_mov_b32 v33, 0
    v_mov_b32 v34, 0
    v_mov_b32 v35, 0
    v_mov_b32 v36, 0
    v_mov_b32 v37, 0
    v_mov_b32 v38, 0
    v_mov_b32 v39, 0
    v_mov_b32 v40, 0
    v_mov_b32 v41, 0
    v_mov_b32 v42, 0
    v_mov_b32 v43, 0
    v_mov_b32 v44, 0
    v_mov_b32 v45, 0
    v_mov_b32 v46, 0
    v_mov_b32 v47, 0
    v_mov_b32 v48, 0
    v_mov_b32 v49, 0
    v_mov_b32 v50, 0
    v_mov_b32 v51, 0
    v_mov_b32 v52, 0
    v_mov_b32 v53, 0
    v_mov_b32 v54, 0
    v_mov_b32 v55, 0
    v_mov_b32 v56, 0
    v_mov_b32 v57, 0
    v_mov_b32 v58, 0
    v_mov_b32 v59, 0
    v_mov_b32 v60, 0
    v_mov_b32 v61, 0
    v_mov_b32 v62, 0
    v_mov_b32 v63, 0
    v_mov_b32 v64, 0
    v_mov_b32 v65, 0
    v_mov_b32 v66, 0
    v_mov_b32 v67, 0
    v_mov_b32 v68, 0
    v_mov_b32 v69, 0
    v_mov_b32 v70, 0
    v_mov_b32 v71, 0
    v_mov_b32 v72, 0
    v_mov_b32 v73, 0
    v_mov_b32 v74, 0
    v_mov_b32 v75, 0
    v_mov_b32 v76, 0
    v_mov_b32 v77, 0
    v_mov_b32 v78, 0
    v_mov_b32 v79, 0
    v_mov_b32 v80, 0
    v_mov_b32 v81, 0
    v_mov_b32 v82, 0
    v_mov_b32 v83, 0
    v_mov_b32 v84, 0
    v_mov_b32 v85, 0
    v_mov_b32 v86, 0
    v_mov_b32 v87, 0
    v_mov_b32 v88, 0
    v_mov_b32 v89, 0
    v_mov_b32 v90, 0
    v_mov_b32 v91, 0
    v_mov_b32 v92, 0
    v_mov_b32 v93, 0
    v_mov_b32 v94, 0
    v_mov_b32 v95, 0
    v_mov_b32 v96, 0
    v_mov_b32 v97, 0
    v_mov_b32 v98, 0
    v_mov_b32 v99, 0
    v_mov_b32 v100, 0
    v_mov_b32 v101, 0
    v_mov_b32 v102, 0
    v_mov_b32 v103, 0
    v_mov_b32 v104, 0
    v_mov_b32 v105, 0
    v_mov_b32 v106, 0
    v_mov_b32 v107, 0
    v_mov_b32 v108, 0
    v_mov_b32 v109, 0
    v_mov_b32 v110, 0
    v_mov_b32 v111, 0
    s_mul_i32 s39, s30, 20
    v_add_u32 v4, s39, v1
    s_mov_b32 s41, 12288
    v_mul_lo_u32 v4, v4, s41
    v_lshl_add_u32 v4, v2, 3, v4
    s_mul_i32 s41, s28, 1536
    s_mul_i32 s42, s38, 384
    s_add_u32 s41, s41, s42
    v_add_u32 v4, s41, v4
    s_mov_b32 s43, 196608
    buffer_load_dwordx2 v[16:17], v4, s[12:15], 0 offen offset:0
    buffer_load_dwordx2 v[20:21], v4, s[12:15], 0 offen offset:48
    buffer_load_dwordx2 v[24:25], v4, s[12:15], 0 offen offset:96
    buffer_load_dwordx2 v[28:29], v4, s[12:15], 0 offen offset:144
    buffer_load_dwordx2 v[32:33], v4, s[12:15], 0 offen offset:192
    buffer_load_dwordx2 v[36:37], v4, s[12:15], 0 offen offset:240
    buffer_load_dwordx2 v[40:41], v4, s[12:15], 0 offen offset:288
    buffer_load_dwordx2 v[44:45], v4, s[12:15], 0 offen offset:336
    s_mov_b32 exec_lo, 0xffffffff
    s_mov_b32 exec_hi, 0x0
    buffer_load_dwordx2 v[18:19], v4, s[12:15], 0 offen offset:32
    buffer_load_dwordx2 v[22:23], v4, s[12:15], 0 offen offset:80
    buffer_load_dwordx2 v[26:27], v4, s[12:15], 0 offen offset:128
    buffer_load_dwordx2 v[30:31], v4, s[12:15], 0 offen offset:176
    buffer_load_dwordx2 v[34:35], v4, s[12:15], 0 offen offset:224
    buffer_load_dwordx2 v[38:39], v4, s[12:15], 0 offen offset:272
    buffer_load_dwordx2 v[42:43], v4, s[12:15], 0 offen offset:320
    buffer_load_dwordx2 v[46:47], v4, s[12:15], 0 offen offset:368
    s_mov_b64 exec, -1
    s_mov_b32 exec_lo, 0xf000f
    s_mov_b32 exec_hi, 0xf000f
    buffer_load_dwordx2 v[48:49], v4, s[12:15], s43 offen offset:0
    buffer_load_dwordx2 v[52:53], v4, s[12:15], s43 offen offset:48
    buffer_load_dwordx2 v[56:57], v4, s[12:15], s43 offen offset:96
    buffer_load_dwordx2 v[60:61], v4, s[12:15], s43 offen offset:144
    buffer_load_dwordx2 v[64:65], v4, s[12:15], s43 offen offset:192
    buffer_load_dwordx2 v[68:69], v4, s[12:15], s43 offen offset:240
    buffer_load_dwordx2 v[72:73], v4, s[12:15], s43 offen offset:288
    buffer_load_dwordx2 v[76:77], v4, s[12:15], s43 offen offset:336
    s_mov_b32 exec_lo, 0xf000f
    s_mov_b32 exec_hi, 0x0
    buffer_load_dwordx2 v[50:51], v4, s[12:15], s43 offen offset:32
    buffer_load_dwordx2 v[54:55], v4, s[12:15], s43 offen offset:80
    buffer_load_dwordx2 v[58:59], v4, s[12:15], s43 offen offset:128
    buffer_load_dwordx2 v[62:63], v4, s[12:15], s43 offen offset:176
    buffer_load_dwordx2 v[66:67], v4, s[12:15], s43 offen offset:224
    buffer_load_dwordx2 v[70:71], v4, s[12:15], s43 offen offset:272
    buffer_load_dwordx2 v[74:75], v4, s[12:15], s43 offen offset:320
    buffer_load_dwordx2 v[78:79], v4, s[12:15], s43 offen offset:368
    s_mov_b64 exec, -1
    v_and_b32 v5, 7, v1
    v_lshlrev_b32 v5, 4, v5
    v_lshl_add_u32 v5, v2, 7, v5
    s_lshl_b32 s41, s28, 5
    s_lshl_b32 s42, s38, 3
    s_add_u32 s41, s41, s42
    s_mul_i32 s41, s41, 512
    s_add_u32 s41, s41, 950272
    v_add_u32 v3, s41, v5
    s_lshl_b32 s41, s30, 1
    s_add_u32 s41, s41, s38
    s_lshl_b32 s41, s41, 3
    s_mul_i32 s42, s41, 512
    s_add_u32 s42, s42, 1212416
    v_add_u32 v7, s42, v5
    s_mul_i32 s43, s28, 512
    s_add_u32 s42, s42, s43
    v_add_u32 v6, s42, v5
    s_lshl_b32 s41, s38, 4
    s_add_u32 s41, s41, s39
    v_lshlrev_b32 v10, 2, v2
    v_add_u32 v10, s41, v10
    v_lshrrev_b32 v11, 3, v10
    v_lshlrev_b32 v11, 7, v11
    v_and_b32 v10, 4, v10
    v_lshl_add_u32 v10, v10, 1, v11
    v_lshl_add_u32 v10, v1, 4, v10
    s_mul_i32 s42, s28, 10240
    v_add_u32 v10, s42, v10
    s_cmp_eq_u32 s38, 0
    s_mov_b32 s47, 0xff
    s_cselect_b32 s48, 0x00ff00ff, s47
    s_cselect_b32 s49, 0x00ff00ff, 0
    s_lshl_b32 s41, s38, 11
    s_add_u32 s41, s41, 32768
    v_lshlrev_b32 v11, 4, v0
    v_add_u32 v9, s41, v11
    s_lshl_b32 s41, s38, 10
    s_add_u32 s41, s41, 32768
    v_add_u32 v11, s41, v11
    s_lshl_b32 s41, s38, 2
    s_add_u32 s41, s41, 24608
    v_mov_b32 v120, s41
    v_mov_b32 v12, -1
    v_mov_b32 v13, -1
    v_mov_b32 v14, -1
    v_mov_b32 v15, -1
    s_add_u32 s64, s4, 0x0
    s_addc_u32 s65, s5, 0
    s_and_b32 s65, s65, 0xffff
    s_mov_b32 s66, 0x280000
    s_mov_b32 s67, 0x20000
    s_add_u32 s68, s4, 0x280000
    s_addc_u32 s69, s5, 0
    s_and_b32 s69, s69, 0xffff
    s_mov_b32 s70, 0x1680000
    s_mov_b32 s71, 0x20000
    v_lshlrev_b32 v122, 4, v0
    v_lshlrev_b32 v123, 4, v0
    v_add_u32 v123, 49152, v123
    s_cmp_lt_u32 s38, 2
    s_cbranch_scc0 ch_wo_nopf
    s_mul_i32 s41, s30, 81920
    s_mul_i32 s42, s38, 40960
    s_add_u32 s41, s41, s42
    v_lshlrev_b32 v8, 4, v0
    buffer_load_dwordx4 v[160:163], v8, s[64:67], s41 offen
    s_add_u32 s41, s41, 1024
    buffer_load_dwordx4 v[164:167], v8, s[64:67], s41 offen
    s_add_u32 s41, s41, 1024
    buffer_load_dwordx4 v[168:171], v8, s[64:67], s41 offen
    s_add_u32 s41, s41, 1024
    buffer_load_dwordx4 v[172:175], v8, s[64:67], s41 offen
    s_add_u32 s41, s41, 1024
    buffer_load_dwordx4 v[176:179], v8, s[64:67], s41 offen
    s_add_u32 s41, s41, 1024
    buffer_load_dwordx4 v[180:183], v8, s[64:67], s41 offen
    s_add_u32 s41, s41, 1024
    buffer_load_dwordx4 v[184:187], v8, s[64:67], s41 offen
    s_add_u32 s41, s41, 1024
    buffer_load_dwordx4 v[188:191], v8, s[64:67], s41 offen
    s_add_u32 s41, s41, 1024
    buffer_load_dwordx4 v[192:195], v8, s[64:67], s41 offen
    s_add_u32 s41, s41, 1024
    buffer_load_dwordx4 v[196:199], v8, s[64:67], s41 offen
    s_add_u32 s41, s41, 1024
    buffer_load_dwordx4 v[200:203], v8, s[64:67], s41 offen
    s_add_u32 s41, s41, 1024
    buffer_load_dwordx4 v[204:207], v8, s[64:67], s41 offen
    s_add_u32 s41, s41, 1024
    buffer_load_dwordx4 v[208:211], v8, s[64:67], s41 offen
    s_add_u32 s41, s41, 1024
    buffer_load_dwordx4 v[212:215], v8, s[64:67], s41 offen
    s_add_u32 s41, s41, 1024
    buffer_load_dwordx4 v[216:219], v8, s[64:67], s41 offen
    s_add_u32 s41, s41, 1024
    buffer_load_dwordx4 v[220:223], v8, s[64:67], s41 offen
    s_add_u32 s41, s41, 1024
    buffer_load_dwordx4 v[160:163], v8, s[64:67], s41 offen
    s_add_u32 s41, s41, 1024
    buffer_load_dwordx4 v[164:167], v8, s[64:67], s41 offen
    s_add_u32 s41, s41, 1024
    buffer_load_dwordx4 v[168:171], v8, s[64:67], s41 offen
    s_add_u32 s41, s41, 1024
    buffer_load_dwordx4 v[172:175], v8, s[64:67], s41 offen
    s_add_u32 s41, s41, 1024
    buffer_load_dwordx4 v[176:179], v8, s[64:67], s41 offen
    s_add_u32 s41, s41, 1024
    buffer_load_dwordx4 v[180:183], v8, s[64:67], s41 offen
    s_add_u32 s41, s41, 1024
    buffer_load_dwordx4 v[184:187], v8, s[64:67], s41 offen
    s_add_u32 s41, s41, 1024
    buffer_load_dwordx4 v[188:191], v8, s[64:67], s41 offen
    s_add_u32 s41, s41, 1024
    buffer_load_dwordx4 v[192:195], v8, s[64:67], s41 offen
    s_add_u32 s41, s41, 1024
    buffer_load_dwordx4 v[196:199], v8, s[64:67], s41 offen
    s_add_u32 s41, s41, 1024
    buffer_load_dwordx4 v[200:203], v8, s[64:67], s41 offen
    s_add_u32 s41, s41, 1024
    buffer_load_dwordx4 v[204:207], v8, s[64:67], s41 offen
    s_add_u32 s41, s41, 1024
    buffer_load_dwordx4 v[208:211], v8, s[64:67], s41 offen
    s_add_u32 s41, s41, 1024
    buffer_load_dwordx4 v[212:215], v8, s[64:67], s41 offen
    s_add_u32 s41, s41, 1024
    buffer_load_dwordx4 v[216:219], v8, s[64:67], s41 offen
    s_add_u32 s41, s41, 1024
    buffer_load_dwordx4 v[220:223], v8, s[64:67], s41 offen
    s_add_u32 s41, s41, 1024
    buffer_load_dwordx4 v[160:163], v8, s[64:67], s41 offen
    s_add_u32 s41, s41, 1024
    buffer_load_dwordx4 v[164:167], v8, s[64:67], s41 offen
    s_add_u32 s41, s41, 1024
    buffer_load_dwordx4 v[168:171], v8, s[64:67], s41 offen
    s_add_u32 s41, s41, 1024
    buffer_load_dwordx4 v[172:175], v8, s[64:67], s41 offen
    s_add_u32 s41, s41, 1024
    buffer_load_dwordx4 v[176:179], v8, s[64:67], s41 offen
    s_add_u32 s41, s41, 1024
    buffer_load_dwordx4 v[180:183], v8, s[64:67], s41 offen
    s_add_u32 s41, s41, 1024
    buffer_load_dwordx4 v[184:187], v8, s[64:67], s41 offen
    s_add_u32 s41, s41, 1024
    buffer_load_dwordx4 v[188:191], v8, s[64:67], s41 offen
    s_add_u32 s41, s41, 1024
    s_branch ch_wo_start
ch_wo_nopf:
    v_mov_b32 v160, 0
    v_mov_b32 v161, 0
    v_mov_b32 v162, 0
    v_mov_b32 v163, 0
    v_mov_b32 v164, 0
    v_mov_b32 v165, 0
    v_mov_b32 v166, 0
    v_mov_b32 v167, 0
    v_mov_b32 v168, 0
    v_mov_b32 v169, 0
    v_mov_b32 v170, 0
    v_mov_b32 v171, 0
    v_mov_b32 v172, 0
    v_mov_b32 v173, 0
    v_mov_b32 v174, 0
    v_mov_b32 v175, 0
    v_mov_b32 v176, 0
    v_mov_b32 v177, 0
    v_mov_b32 v178, 0
    v_mov_b32 v179, 0
    v_mov_b32 v180, 0
    v_mov_b32 v181, 0
    v_mov_b32 v182, 0
    v_mov_b32 v183, 0
    v_mov_b32 v184, 0
    v_mov_b32 v185, 0
    v_mov_b32 v186, 0
    v_mov_b32 v187, 0
    v_mov_b32 v188, 0
    v_mov_b32 v189, 0
    v_mov_b32 v190, 0
    v_mov_b32 v191, 0
    v_mov_b32 v192, 0
    v_mov_b32 v193, 0
    v_mov_b32 v194, 0
    v_mov_b32 v195, 0
    v_mov_b32 v196, 0
    v_mov_b32 v197, 0
    v_mov_b32 v198, 0
    v_mov_b32 v199, 0
    v_mov_b32 v200, 0
    v_mov_b32 v201, 0
    v_mov_b32 v202, 0
    v_mov_b32 v203, 0
    v_mov_b32 v204, 0
    v_mov_b32 v205, 0
    v_mov_b32 v206, 0
    v_mov_b32 v207, 0
    v_mov_b32 v208, 0
    v_mov_b32 v209, 0
    v_mov_b32 v210, 0
    v_mov_b32 v211, 0
    v_mov_b32 v212, 0
    v_mov_b32 v213, 0
    v_mov_b32 v214, 0
    v_mov_b32 v215, 0
    v_mov_b32 v216, 0
    v_mov_b32 v217, 0
    v_mov_b32 v218, 0
    v_mov_b32 v219, 0
    v_add_u32 v8, s34, v1
    s_mov_b32 s41, 1280
    v_mul_lo_u32 v8, v8, s41
    v_lshl_add_u32 v8, v2, 4, v8
    s_cmp_lg_u32 s38, 2
    s_cbranch_scc1 ch_wo_xw2
    s_mov_b32 s41, 0
    buffer_load_dwordx4 v[160:163], v8, s[68:71], s41 offen offset:0
    buffer_load_dwordx4 v[164:167], v8, s[68:71], s41 offen offset:64
    buffer_load_dwordx4 v[168:171], v8, s[68:71], s41 offen offset:128
    buffer_load_dwordx4 v[172:175], v8, s[68:71], s41 offen offset:192
    buffer_load_dwordx4 v[176:179], v8, s[68:71], s41 offen offset:256
    s_mov_b32 exec_lo, 0xff00ff
    s_mov_b32 exec_hi, 0xff00ff
    s_mov_b32 s41, 20480
    buffer_load_dwordx4 v[180:183], v8, s[68:71], s41 offen offset:0
    buffer_load_dwordx4 v[184:187], v8, s[68:71], s41 offen offset:64
    buffer_load_dwordx4 v[188:191], v8, s[68:71], s41 offen offset:128
    buffer_load_dwordx4 v[192:195], v8, s[68:71], s41 offen offset:192
    buffer_load_dwordx4 v[196:199], v8, s[68:71], s41 offen offset:256
    s_mov_b64 exec, -1
    s_mov_b32 s41, 7864320
    buffer_load_dwordx4 v[200:203], v8, s[68:71], s41 offen offset:0
    buffer_load_dwordx4 v[204:207], v8, s[68:71], s41 offen offset:64
    buffer_load_dwordx4 v[208:211], v8, s[68:71], s41 offen offset:128
    buffer_load_dwordx4 v[212:215], v8, s[68:71], s41 offen offset:192
    buffer_load_dwordx4 v[216:219], v8, s[68:71], s41 offen offset:256
    s_waitcnt vmcnt(0)
    s_mov_b32 s76, 0
    s_mul_i32 s77, s76, 40960
    s_add_u32 s78, s77, 20480
    buffer_load_dwordx4 v[112:115], v122, s[64:67], s77 offen offset:0
    buffer_load_dwordx4 v[116:119], v122, s[64:67], s77 offen offset:1024
    buffer_load_dwordx4 v[152:155], v122, s[64:67], s77 offen offset:2048
    buffer_load_dwordx4 v[156:159], v122, s[64:67], s77 offen offset:3072
    s_add_u32 s79, s77, 4096
    buffer_load_dwordx4 v[244:247], v122, s[64:67], s79 offen
    buffer_load_dwordx4 v[124:127], v122, s[64:67], s78 offen offset:0
    buffer_load_dwordx4 v[128:131], v122, s[64:67], s78 offen offset:1024
    buffer_load_dwordx4 v[132:135], v122, s[64:67], s78 offen offset:2048
    buffer_load_dwordx4 v[136:139], v122, s[64:67], s78 offen offset:3072
    s_add_u32 s79, s78, 4096
    buffer_load_dwordx4 v[140:143], v122, s[64:67], s79 offen
    s_and_b32 s79, s76, 1
    s_mul_i32 s79, s79, 49152
    v_add_u32 v8, s79, v123
    s_waitcnt vmcnt(0)
    v_mfma_f32_16x16x32_bf16 v[220:223], v[160:163], v[112:115], 0
    v_mfma_f32_16x16x32_bf16 v[224:227], v[180:183], v[112:115], 0
    v_mfma_f32_16x16x32_bf16 v[228:231], v[200:203], v[112:115], 0
    v_mfma_f32_16x16x32_bf16 v[220:223], v[164:167], v[116:119], v[220:223]
    v_mfma_f32_16x16x32_bf16 v[224:227], v[184:187], v[116:119], v[224:227]
    v_mfma_f32_16x16x32_bf16 v[228:231], v[204:207], v[116:119], v[228:231]
    v_mfma_f32_16x16x32_bf16 v[220:223], v[168:171], v[152:155], v[220:223]
    v_mfma_f32_16x16x32_bf16 v[224:227], v[188:191], v[152:155], v[224:227]
    v_mfma_f32_16x16x32_bf16 v[228:231], v[208:211], v[152:155], v[228:231]
    v_mfma_f32_16x16x32_bf16 v[220:223], v[172:175], v[156:159], v[220:223]
    v_mfma_f32_16x16x32_bf16 v[224:227], v[192:195], v[156:159], v[224:227]
    v_mfma_f32_16x16x32_bf16 v[228:231], v[212:215], v[156:159], v[228:231]
    v_mfma_f32_16x16x32_bf16 v[220:223], v[176:179], v[244:247], v[220:223]
    v_mfma_f32_16x16x32_bf16 v[224:227], v[196:199], v[244:247], v[224:227]
    v_mfma_f32_16x16x32_bf16 v[228:231], v[216:219], v[244:247], v[228:231]
    v_mfma_f32_16x16x32_bf16 v[232:235], v[160:163], v[124:127], 0
    v_mfma_f32_16x16x32_bf16 v[236:239], v[180:183], v[124:127], 0
    v_mfma_f32_16x16x32_bf16 v[240:243], v[200:203], v[124:127], 0
    v_mfma_f32_16x16x32_bf16 v[232:235], v[164:167], v[128:131], v[232:235]
    v_mfma_f32_16x16x32_bf16 v[236:239], v[184:187], v[128:131], v[236:239]
    v_mfma_f32_16x16x32_bf16 v[240:243], v[204:207], v[128:131], v[240:243]
    v_mfma_f32_16x16x32_bf16 v[232:235], v[168:171], v[132:135], v[232:235]
    v_mfma_f32_16x16x32_bf16 v[236:239], v[188:191], v[132:135], v[236:239]
    v_mfma_f32_16x16x32_bf16 v[240:243], v[208:211], v[132:135], v[240:243]
    v_mfma_f32_16x16x32_bf16 v[232:235], v[172:175], v[136:139], v[232:235]
    v_mfma_f32_16x16x32_bf16 v[236:239], v[192:195], v[136:139], v[236:239]
    v_mfma_f32_16x16x32_bf16 v[240:243], v[212:215], v[136:139], v[240:243]
    v_mfma_f32_16x16x32_bf16 v[232:235], v[176:179], v[140:143], v[232:235]
    v_mfma_f32_16x16x32_bf16 v[236:239], v[196:199], v[140:143], v[236:239]
    v_mfma_f32_16x16x32_bf16 v[240:243], v[216:219], v[140:143], v[240:243]
    s_nop 7
    ds_write_b128 v8, v[220:223] offset:0
    ds_write_b128 v8, v[224:227] offset:1024
    ds_write_b128 v8, v[228:231] offset:2048
    ds_write_b128 v8, v[232:235] offset:6144
    ds_write_b128 v8, v[236:239] offset:7168
    ds_write_b128 v8, v[240:243] offset:8192
    s_add_u32 s77, s76, 1
    v_mov_b32 v8, s77
    v_mov_b32 v121, 24624
    s_waitcnt lgkmcnt(0)
    ds_write_b32 v121, v8
    s_mov_b32 s76, 1
    s_mul_i32 s77, s76, 40960
    s_add_u32 s78, s77, 20480
    buffer_load_dwordx4 v[112:115], v122, s[64:67], s77 offen offset:0
    buffer_load_dwordx4 v[116:119], v122, s[64:67], s77 offen offset:1024
    buffer_load_dwordx4 v[152:155], v122, s[64:67], s77 offen offset:2048
    buffer_load_dwordx4 v[156:159], v122, s[64:67], s77 offen offset:3072
    s_add_u32 s79, s77, 4096
    buffer_load_dwordx4 v[244:247], v122, s[64:67], s79 offen
    buffer_load_dwordx4 v[124:127], v122, s[64:67], s78 offen offset:0
    buffer_load_dwordx4 v[128:131], v122, s[64:67], s78 offen offset:1024
    buffer_load_dwordx4 v[132:135], v122, s[64:67], s78 offen offset:2048
    buffer_load_dwordx4 v[136:139], v122, s[64:67], s78 offen offset:3072
    s_add_u32 s79, s78, 4096
    buffer_load_dwordx4 v[140:143], v122, s[64:67], s79 offen
    s_and_b32 s79, s76, 1
    s_mul_i32 s79, s79, 49152
    v_add_u32 v8, s79, v123
    s_waitcnt vmcnt(0)
    v_mfma_f32_16x16x32_bf16 v[220:223], v[160:163], v[112:115], 0
    v_mfma_f32_16x16x32_bf16 v[224:227], v[180:183], v[112:115], 0
    v_mfma_f32_16x16x32_bf16 v[228:231], v[200:203], v[112:115], 0
    v_mfma_f32_16x16x32_bf16 v[220:223], v[164:167], v[116:119], v[220:223]
    v_mfma_f32_16x16x32_bf16 v[224:227], v[184:187], v[116:119], v[224:227]
    v_mfma_f32_16x16x32_bf16 v[228:231], v[204:207], v[116:119], v[228:231]
    v_mfma_f32_16x16x32_bf16 v[220:223], v[168:171], v[152:155], v[220:223]
    v_mfma_f32_16x16x32_bf16 v[224:227], v[188:191], v[152:155], v[224:227]
    v_mfma_f32_16x16x32_bf16 v[228:231], v[208:211], v[152:155], v[228:231]
    v_mfma_f32_16x16x32_bf16 v[220:223], v[172:175], v[156:159], v[220:223]
    v_mfma_f32_16x16x32_bf16 v[224:227], v[192:195], v[156:159], v[224:227]
    v_mfma_f32_16x16x32_bf16 v[228:231], v[212:215], v[156:159], v[228:231]
    v_mfma_f32_16x16x32_bf16 v[220:223], v[176:179], v[244:247], v[220:223]
    v_mfma_f32_16x16x32_bf16 v[224:227], v[196:199], v[244:247], v[224:227]
    v_mfma_f32_16x16x32_bf16 v[228:231], v[216:219], v[244:247], v[228:231]
    v_mfma_f32_16x16x32_bf16 v[232:235], v[160:163], v[124:127], 0
    v_mfma_f32_16x16x32_bf16 v[236:239], v[180:183], v[124:127], 0
    v_mfma_f32_16x16x32_bf16 v[240:243], v[200:203], v[124:127], 0
    v_mfma_f32_16x16x32_bf16 v[232:235], v[164:167], v[128:131], v[232:235]
    v_mfma_f32_16x16x32_bf16 v[236:239], v[184:187], v[128:131], v[236:239]
    v_mfma_f32_16x16x32_bf16 v[240:243], v[204:207], v[128:131], v[240:243]
    v_mfma_f32_16x16x32_bf16 v[232:235], v[168:171], v[132:135], v[232:235]
    v_mfma_f32_16x16x32_bf16 v[236:239], v[188:191], v[132:135], v[236:239]
    v_mfma_f32_16x16x32_bf16 v[240:243], v[208:211], v[132:135], v[240:243]
    v_mfma_f32_16x16x32_bf16 v[232:235], v[172:175], v[136:139], v[232:235]
    v_mfma_f32_16x16x32_bf16 v[236:239], v[192:195], v[136:139], v[236:239]
    v_mfma_f32_16x16x32_bf16 v[240:243], v[212:215], v[136:139], v[240:243]
    v_mfma_f32_16x16x32_bf16 v[232:235], v[176:179], v[140:143], v[232:235]
    v_mfma_f32_16x16x32_bf16 v[236:239], v[196:199], v[140:143], v[236:239]
    v_mfma_f32_16x16x32_bf16 v[240:243], v[216:219], v[140:143], v[240:243]
    s_nop 7
    ds_write_b128 v8, v[220:223] offset:0
    ds_write_b128 v8, v[224:227] offset:1024
    ds_write_b128 v8, v[228:231] offset:2048
    ds_write_b128 v8, v[232:235] offset:6144
    ds_write_b128 v8, v[236:239] offset:7168
    ds_write_b128 v8, v[240:243] offset:8192
    s_add_u32 s77, s76, 1
    v_mov_b32 v8, s77
    v_mov_b32 v121, 24624
    s_waitcnt lgkmcnt(0)
    ds_write_b32 v121, v8
ch_wo_xw2:
    s_cmp_lg_u32 s38, 3
    s_cbranch_scc1 ch_wo_xw3
    s_mov_b32 exec_lo, 0xff00ff
    s_mov_b32 exec_hi, 0xff00ff
    s_mov_b32 s41, 7884800
    buffer_load_dwordx4 v[160:163], v8, s[68:71], s41 offen offset:0
    buffer_load_dwordx4 v[164:167], v8, s[68:71], s41 offen offset:64
    buffer_load_dwordx4 v[168:171], v8, s[68:71], s41 offen offset:128
    buffer_load_dwordx4 v[172:175], v8, s[68:71], s41 offen offset:192
    buffer_load_dwordx4 v[176:179], v8, s[68:71], s41 offen offset:256
    s_mov_b64 exec, -1
    s_mov_b32 s41, 15728640
    buffer_load_dwordx4 v[180:183], v8, s[68:71], s41 offen offset:0
    buffer_load_dwordx4 v[184:187], v8, s[68:71], s41 offen offset:64
    buffer_load_dwordx4 v[188:191], v8, s[68:71], s41 offen offset:128
    buffer_load_dwordx4 v[192:195], v8, s[68:71], s41 offen offset:192
    buffer_load_dwordx4 v[196:199], v8, s[68:71], s41 offen offset:256
    s_mov_b32 exec_lo, 0xff00ff
    s_mov_b32 exec_hi, 0xff00ff
    s_mov_b32 s41, 15749120
    buffer_load_dwordx4 v[200:203], v8, s[68:71], s41 offen offset:0
    buffer_load_dwordx4 v[204:207], v8, s[68:71], s41 offen offset:64
    buffer_load_dwordx4 v[208:211], v8, s[68:71], s41 offen offset:128
    buffer_load_dwordx4 v[212:215], v8, s[68:71], s41 offen offset:192
    buffer_load_dwordx4 v[216:219], v8, s[68:71], s41 offen offset:256
    s_mov_b64 exec, -1
    s_waitcnt vmcnt(0)
    s_mov_b32 s76, 0
    s_mul_i32 s77, s76, 40960
    s_add_u32 s78, s77, 20480
    buffer_load_dwordx4 v[112:115], v122, s[64:67], s77 offen offset:0
    buffer_load_dwordx4 v[116:119], v122, s[64:67], s77 offen offset:1024
    buffer_load_dwordx4 v[152:155], v122, s[64:67], s77 offen offset:2048
    buffer_load_dwordx4 v[156:159], v122, s[64:67], s77 offen offset:3072
    s_add_u32 s79, s77, 4096
    buffer_load_dwordx4 v[244:247], v122, s[64:67], s79 offen
    buffer_load_dwordx4 v[124:127], v122, s[64:67], s78 offen offset:0
    buffer_load_dwordx4 v[128:131], v122, s[64:67], s78 offen offset:1024
    buffer_load_dwordx4 v[132:135], v122, s[64:67], s78 offen offset:2048
    buffer_load_dwordx4 v[136:139], v122, s[64:67], s78 offen offset:3072
    s_add_u32 s79, s78, 4096
    buffer_load_dwordx4 v[140:143], v122, s[64:67], s79 offen
    s_and_b32 s79, s76, 1
    s_mul_i32 s79, s79, 49152
    v_add_u32 v8, s79, v123
    s_waitcnt vmcnt(0)
    v_mfma_f32_16x16x32_bf16 v[220:223], v[160:163], v[112:115], 0
    v_mfma_f32_16x16x32_bf16 v[224:227], v[112:115], v[180:183], 0
    v_mfma_f32_16x16x32_bf16 v[228:231], v[112:115], v[200:203], 0
    v_mfma_f32_16x16x32_bf16 v[220:223], v[164:167], v[116:119], v[220:223]
    v_mfma_f32_16x16x32_bf16 v[224:227], v[116:119], v[184:187], v[224:227]
    v_mfma_f32_16x16x32_bf16 v[228:231], v[116:119], v[204:207], v[228:231]
    v_mfma_f32_16x16x32_bf16 v[220:223], v[168:171], v[152:155], v[220:223]
    v_mfma_f32_16x16x32_bf16 v[224:227], v[152:155], v[188:191], v[224:227]
    v_mfma_f32_16x16x32_bf16 v[228:231], v[152:155], v[208:211], v[228:231]
    v_mfma_f32_16x16x32_bf16 v[220:223], v[172:175], v[156:159], v[220:223]
    v_mfma_f32_16x16x32_bf16 v[224:227], v[156:159], v[192:195], v[224:227]
    v_mfma_f32_16x16x32_bf16 v[228:231], v[156:159], v[212:215], v[228:231]
    v_mfma_f32_16x16x32_bf16 v[220:223], v[176:179], v[244:247], v[220:223]
    v_mfma_f32_16x16x32_bf16 v[224:227], v[244:247], v[196:199], v[224:227]
    v_mfma_f32_16x16x32_bf16 v[228:231], v[244:247], v[216:219], v[228:231]
    v_mfma_f32_16x16x32_bf16 v[232:235], v[160:163], v[124:127], 0
    v_mfma_f32_16x16x32_bf16 v[236:239], v[124:127], v[180:183], 0
    v_mfma_f32_16x16x32_bf16 v[240:243], v[124:127], v[200:203], 0
    v_mfma_f32_16x16x32_bf16 v[232:235], v[164:167], v[128:131], v[232:235]
    v_mfma_f32_16x16x32_bf16 v[236:239], v[128:131], v[184:187], v[236:239]
    v_mfma_f32_16x16x32_bf16 v[240:243], v[128:131], v[204:207], v[240:243]
    v_mfma_f32_16x16x32_bf16 v[232:235], v[168:171], v[132:135], v[232:235]
    v_mfma_f32_16x16x32_bf16 v[236:239], v[132:135], v[188:191], v[236:239]
    v_mfma_f32_16x16x32_bf16 v[240:243], v[132:135], v[208:211], v[240:243]
    v_mfma_f32_16x16x32_bf16 v[232:235], v[172:175], v[136:139], v[232:235]
    v_mfma_f32_16x16x32_bf16 v[236:239], v[136:139], v[192:195], v[236:239]
    v_mfma_f32_16x16x32_bf16 v[240:243], v[136:139], v[212:215], v[240:243]
    v_mfma_f32_16x16x32_bf16 v[232:235], v[176:179], v[140:143], v[232:235]
    v_mfma_f32_16x16x32_bf16 v[236:239], v[140:143], v[196:199], v[236:239]
    v_mfma_f32_16x16x32_bf16 v[240:243], v[140:143], v[216:219], v[240:243]
    s_nop 7
    ds_write_b128 v8, v[220:223] offset:3072
    ds_write_b128 v8, v[224:227] offset:4096
    ds_write_b128 v8, v[228:231] offset:5120
    ds_write_b128 v8, v[232:235] offset:9216
    ds_write_b128 v8, v[236:239] offset:10240
    ds_write_b128 v8, v[240:243] offset:11264
    s_add_u32 s77, s76, 1
    v_mov_b32 v8, s77
    v_mov_b32 v121, 24660
    s_waitcnt lgkmcnt(0)
    ds_write_b32 v121, v8
    s_mov_b32 s76, 1
    s_mul_i32 s77, s76, 40960
    s_add_u32 s78, s77, 20480
    buffer_load_dwordx4 v[112:115], v122, s[64:67], s77 offen offset:0
    buffer_load_dwordx4 v[116:119], v122, s[64:67], s77 offen offset:1024
    buffer_load_dwordx4 v[152:155], v122, s[64:67], s77 offen offset:2048
    buffer_load_dwordx4 v[156:159], v122, s[64:67], s77 offen offset:3072
    s_add_u32 s79, s77, 4096
    buffer_load_dwordx4 v[244:247], v122, s[64:67], s79 offen
    buffer_load_dwordx4 v[124:127], v122, s[64:67], s78 offen offset:0
    buffer_load_dwordx4 v[128:131], v122, s[64:67], s78 offen offset:1024
    buffer_load_dwordx4 v[132:135], v122, s[64:67], s78 offen offset:2048
    buffer_load_dwordx4 v[136:139], v122, s[64:67], s78 offen offset:3072
    s_add_u32 s79, s78, 4096
    buffer_load_dwordx4 v[140:143], v122, s[64:67], s79 offen
    s_and_b32 s79, s76, 1
    s_mul_i32 s79, s79, 49152
    v_add_u32 v8, s79, v123
    s_waitcnt vmcnt(0)
    v_mfma_f32_16x16x32_bf16 v[220:223], v[160:163], v[112:115], 0
    v_mfma_f32_16x16x32_bf16 v[224:227], v[112:115], v[180:183], 0
    v_mfma_f32_16x16x32_bf16 v[228:231], v[112:115], v[200:203], 0
    v_mfma_f32_16x16x32_bf16 v[220:223], v[164:167], v[116:119], v[220:223]
    v_mfma_f32_16x16x32_bf16 v[224:227], v[116:119], v[184:187], v[224:227]
    v_mfma_f32_16x16x32_bf16 v[228:231], v[116:119], v[204:207], v[228:231]
    v_mfma_f32_16x16x32_bf16 v[220:223], v[168:171], v[152:155], v[220:223]
    v_mfma_f32_16x16x32_bf16 v[224:227], v[152:155], v[188:191], v[224:227]
    v_mfma_f32_16x16x32_bf16 v[228:231], v[152:155], v[208:211], v[228:231]
    v_mfma_f32_16x16x32_bf16 v[220:223], v[172:175], v[156:159], v[220:223]
    v_mfma_f32_16x16x32_bf16 v[224:227], v[156:159], v[192:195], v[224:227]
    v_mfma_f32_16x16x32_bf16 v[228:231], v[156:159], v[212:215], v[228:231]
    v_mfma_f32_16x16x32_bf16 v[220:223], v[176:179], v[244:247], v[220:223]
    v_mfma_f32_16x16x32_bf16 v[224:227], v[244:247], v[196:199], v[224:227]
    v_mfma_f32_16x16x32_bf16 v[228:231], v[244:247], v[216:219], v[228:231]
    v_mfma_f32_16x16x32_bf16 v[232:235], v[160:163], v[124:127], 0
    v_mfma_f32_16x16x32_bf16 v[236:239], v[124:127], v[180:183], 0
    v_mfma_f32_16x16x32_bf16 v[240:243], v[124:127], v[200:203], 0
    v_mfma_f32_16x16x32_bf16 v[232:235], v[164:167], v[128:131], v[232:235]
    v_mfma_f32_16x16x32_bf16 v[236:239], v[128:131], v[184:187], v[236:239]
    v_mfma_f32_16x16x32_bf16 v[240:243], v[128:131], v[204:207], v[240:243]
    v_mfma_f32_16x16x32_bf16 v[232:235], v[168:171], v[132:135], v[232:235]
    v_mfma_f32_16x16x32_bf16 v[236:239], v[132:135], v[188:191], v[236:239]
    v_mfma_f32_16x16x32_bf16 v[240:243], v[132:135], v[208:211], v[240:243]
    v_mfma_f32_16x16x32_bf16 v[232:235], v[172:175], v[136:139], v[232:235]
    v_mfma_f32_16x16x32_bf16 v[236:239], v[136:139], v[192:195], v[236:239]
    v_mfma_f32_16x16x32_bf16 v[240:243], v[136:139], v[212:215], v[240:243]
    v_mfma_f32_16x16x32_bf16 v[232:235], v[176:179], v[140:143], v[232:235]
    v_mfma_f32_16x16x32_bf16 v[236:239], v[140:143], v[196:199], v[236:239]
    v_mfma_f32_16x16x32_bf16 v[240:243], v[140:143], v[216:219], v[240:243]
    s_nop 7
    ds_write_b128 v8, v[220:223] offset:3072
    ds_write_b128 v8, v[224:227] offset:4096
    ds_write_b128 v8, v[228:231] offset:5120
    ds_write_b128 v8, v[232:235] offset:9216
    ds_write_b128 v8, v[236:239] offset:10240
    ds_write_b128 v8, v[240:243] offset:11264
    s_add_u32 s77, s76, 1
    v_mov_b32 v8, s77
    v_mov_b32 v121, 24660
    s_waitcnt lgkmcnt(0)
    ds_write_b32 v121, v8
ch_wo_xw3:
ch_wo_start:
    s_waitcnt vmcnt(0)
ch_wo_loop:
    s_waitcnt vmcnt(0)
    s_and_b32 s41, s40, 1
    s_mul_i32 s46, s41, 131072
    s_add_u32 s47, s40, 1
    s_cmp_lt_u32 s38, 2
    s_cbranch_scc1 ch_wo_nold
    s_add_u32 s76, s40, 2
    s_cmp_ge_u32 s76, 64
    s_cbranch_scc1 ch_wo_nold
    v_mov_b32 v121, 24664
ch_wo_sw:
    ds_read_b32 v8, v121
    s_waitcnt lgkmcnt(0)
    v_cmp_gt_u32 vcc, s47, v8
    s_add_u32 s50, s50, 1
    s_cmp_ge_u32 s50, 0x2000000
    s_cbranch_scc1 ch_end
    s_cbranch_vccz ch_wo_sw_x
    s_sleep 2
    s_branch ch_wo_sw
ch_wo_sw_x:
    s_mul_i32 s77, s76, 40960
    s_add_u32 s78, s77, 20480
    buffer_load_dwordx4 v[112:115], v122, s[64:67], s77 offen offset:0
    buffer_load_dwordx4 v[116:119], v122, s[64:67], s77 offen offset:1024
    buffer_load_dwordx4 v[152:155], v122, s[64:67], s77 offen offset:2048
    buffer_load_dwordx4 v[156:159], v122, s[64:67], s77 offen offset:3072
    s_add_u32 s79, s77, 4096
    buffer_load_dwordx4 v[244:247], v122, s[64:67], s79 offen
    buffer_load_dwordx4 v[124:127], v122, s[64:67], s78 offen offset:0
    buffer_load_dwordx4 v[128:131], v122, s[64:67], s78 offen offset:1024
    buffer_load_dwordx4 v[132:135], v122, s[64:67], s78 offen offset:2048
    buffer_load_dwordx4 v[136:139], v122, s[64:67], s78 offen offset:3072
    s_add_u32 s79, s78, 4096
    buffer_load_dwordx4 v[140:143], v122, s[64:67], s79 offen
ch_wo_nold:
    v_mov_b32 v121, 24600
ch_wo_lw:
    ds_read_b32 v8, v121
    s_waitcnt lgkmcnt(0)
    v_cmp_gt_u32 vcc, s47, v8
    s_add_u32 s50, s50, 1
    s_cmp_ge_u32 s50, 0x2000000
    s_cbranch_scc1 ch_end
    s_cbranch_vccz ch_wo_lw_x
    s_sleep 2
    s_branch ch_wo_lw
ch_wo_lw_x:
    s_mov_b32 exec_lo, 0xff00ff
    s_mov_b32 exec_hi, 0xff00ff
ch_wo_og:
    buffer_load_dwordx4 v[80:83], v3, s[8:11], s46 offen offset:0 sc1
    buffer_load_dwordx4 v[84:87], v3, s[8:11], s46 offen offset:512 sc1
    buffer_load_dwordx4 v[88:91], v3, s[8:11], s46 offen offset:1024 sc1
    buffer_load_dwordx4 v[92:95], v3, s[8:11], s46 offen offset:1536 sc1
    buffer_load_dwordx4 v[96:99], v3, s[8:11], s46 offen offset:2048 sc1
    buffer_load_dwordx4 v[100:103], v3, s[8:11], s46 offen offset:2560 sc1
    buffer_load_dwordx4 v[104:107], v3, s[8:11], s46 offen offset:3072 sc1
    buffer_load_dwordx4 v[108:111], v3, s[8:11], s46 offen offset:3584 sc1
    s_waitcnt vmcnt(0)
    v_max3_u32 v8, v80, v81, v82
    v_max3_u32 v8, v8, v83, v84
    v_max3_u32 v8, v8, v85, v86
    v_max3_u32 v8, v8, v87, v88
    v_max3_u32 v8, v8, v89, v90
    v_max3_u32 v8, v8, v91, v92
    v_max3_u32 v8, v8, v93, v94
    v_max3_u32 v8, v8, v95, v96
    v_max3_u32 v8, v8, v97, v98
    v_max3_u32 v8, v8, v99, v100
    v_max3_u32 v8, v8, v101, v102
    v_max3_u32 v8, v8, v103, v104
    v_max3_u32 v8, v8, v105, v106
    v_max3_u32 v8, v8, v107, v108
    v_max3_u32 v8, v8, v109, v110
    v_max_u32 v8, v8, v111
    v_cmp_eq_u32 vcc, -1, v8
    s_add_u32 s50, s50, 1
    s_cmp_ge_u32 s50, 0x2000000
    s_cbranch_scc1 ch_end
    s_cbranch_vccnz ch_wo_og
    s_mov_b64 exec, -1
    v_mfma_f32_16x16x32_bf16 v[144:147], v[16:19], v[80:83], 0
    v_mfma_f32_16x16x32_bf16 v[148:151], v[48:51], v[80:83], 0
    v_mfma_f32_16x16x32_bf16 v[144:147], v[20:23], v[84:87], v[144:147]
    v_mfma_f32_16x16x32_bf16 v[148:151], v[52:55], v[84:87], v[148:151]
    v_mfma_f32_16x16x32_bf16 v[144:147], v[24:27], v[88:91], v[144:147]
    v_mfma_f32_16x16x32_bf16 v[148:151], v[56:59], v[88:91], v[148:151]
    v_mfma_f32_16x16x32_bf16 v[144:147], v[28:31], v[92:95], v[144:147]
    v_mfma_f32_16x16x32_bf16 v[148:151], v[60:63], v[92:95], v[148:151]
    v_mfma_f32_16x16x32_bf16 v[144:147], v[32:35], v[96:99], v[144:147]
    v_mfma_f32_16x16x32_bf16 v[148:151], v[64:67], v[96:99], v[148:151]
    v_mfma_f32_16x16x32_bf16 v[144:147], v[36:39], v[100:103], v[144:147]
    v_mfma_f32_16x16x32_bf16 v[148:151], v[68:71], v[100:103], v[148:151]
    v_mfma_f32_16x16x32_bf16 v[144:147], v[40:43], v[104:107], v[144:147]
    v_mfma_f32_16x16x32_bf16 v[148:151], v[72:75], v[104:107], v[148:151]
    v_mfma_f32_16x16x32_bf16 v[144:147], v[44:47], v[108:111], v[144:147]
    v_mfma_f32_16x16x32_bf16 v[148:151], v[76:79], v[108:111], v[148:151]
    s_and_b32 s41, s40, 3
    s_mul_i32 s42, s41, 262144
    s_add_u32 s41, s40, 2
    s_and_b32 s41, s41, 3
    s_mul_i32 s43, s41, 262144
    v_mov_b32 v121, s47
    s_nop 4
    ds_write_b128 v9, v[144:147]
    ds_write_b128 v9, v[148:151] offset:1024
    s_waitcnt lgkmcnt(0)
    ds_write_b32 v120, v121
    s_cmp_ge_u32 s38, 2
    s_cbranch_scc1 ch_wo_x
    s_mov_b32 exec_lo, 0xff00ff
    s_mov_b32 exec_hi, 0xff00ff
    buffer_store_dwordx4 v[12:15], v6, s[8:11], s43 offen sc1
    s_mov_b64 exec, -1
    v_mov_b32 v8, 24608
ch_wo_fl:
    ds_read_b128 v[80:83], v8
    s_waitcnt lgkmcnt(0)
    v_min_u32 v80, v80, v81
    v_min3_u32 v80, v80, v82, v83
    v_cmp_gt_u32 vcc, s47, v80
    s_add_u32 s50, s50, 1
    s_cmp_ge_u32 s50, 0x2000000
    s_cbranch_scc1 ch_end
    s_cbranch_vccnz ch_wo_fl
    ds_read_b128 v[80:83], v11 offset:0
    ds_read_b128 v[84:87], v11 offset:2048
    ds_read_b128 v[88:91], v11 offset:4096
    ds_read_b128 v[92:95], v11 offset:6144
    s_waitcnt lgkmcnt(0)
    v_pk_add_f32 v[144:145], v[80:81], v[84:85]
    v_pk_add_f32 v[148:149], v[88:89], v[92:93]
    v_pk_add_f32 v[146:147], v[82:83], v[86:87]
    v_pk_add_f32 v[150:151], v[90:91], v[94:95]
    v_pk_add_f32 v[144:145], v[144:145], v[148:149]
    v_pk_add_f32 v[146:147], v[146:147], v[150:151]
    s_mov_b32 exec_lo, 0xff00ff
    s_mov_b32 exec_hi, 0xff00ff
    v_min_u32 v144, s44, v144
    v_min_u32 v145, s44, v145
    v_min_u32 v146, s44, v146
    v_min_u32 v147, s44, v147
    buffer_store_dwordx4 v[144:147], v6, s[8:11], s42 offen sc1
    s_cmp_lg_u32 s38, 0
    s_cbranch_scc1 ch_wo_nops
    v_mov_b32 v121, 24656
    v_mov_b32 v8, s47
    ds_write_b32 v121, v8
ch_wo_nops:
    s_waitcnt vmcnt(0)
    s_mov_b32 exec_lo, s48
    s_mov_b32 exec_hi, s49
    buffer_load_dwordx4 v[80:83], v7, s[8:11], s42 offen offset:0 sc1
    buffer_load_dwordx4 v[84:87], v7, s[8:11], s42 offen offset:512 sc1
    buffer_load_dwordx4 v[88:91], v7, s[8:11], s42 offen offset:1024 sc1
    buffer_load_dwordx4 v[92:95], v7, s[8:11], s42 offen offset:1536 sc1
    buffer_load_dwordx4 v[96:99], v7, s[8:11], s42 offen offset:2048 sc1
    buffer_load_dwordx4 v[100:103], v7, s[8:11], s42 offen offset:2560 sc1
    buffer_load_dwordx4 v[104:107], v7, s[8:11], s42 offen offset:3072 sc1
    buffer_load_dwordx4 v[108:111], v7, s[8:11], s42 offen offset:3584 sc1
    s_sleep 5
    buffer_load_dwordx4 v[160:163], v7, s[8:11], s42 offen offset:0 sc1
    buffer_load_dwordx4 v[164:167], v7, s[8:11], s42 offen offset:512 sc1
    buffer_load_dwordx4 v[168:171], v7, s[8:11], s42 offen offset:1024 sc1
    buffer_load_dwordx4 v[172:175], v7, s[8:11], s42 offen offset:1536 sc1
    buffer_load_dwordx4 v[176:179], v7, s[8:11], s42 offen offset:2048 sc1
    buffer_load_dwordx4 v[180:183], v7, s[8:11], s42 offen offset:2560 sc1
    buffer_load_dwordx4 v[184:187], v7, s[8:11], s42 offen offset:3072 sc1
    buffer_load_dwordx4 v[188:191], v7, s[8:11], s42 offen offset:3584 sc1
    s_sleep 5
    buffer_load_dwordx4 v[192:195], v7, s[8:11], s42 offen offset:0 sc1
    buffer_load_dwordx4 v[196:199], v7, s[8:11], s42 offen offset:512 sc1
    buffer_load_dwordx4 v[200:203], v7, s[8:11], s42 offen offset:1024 sc1
    buffer_load_dwordx4 v[204:207], v7, s[8:11], s42 offen offset:1536 sc1
    buffer_load_dwordx4 v[208:211], v7, s[8:11], s42 offen offset:2048 sc1
    buffer_load_dwordx4 v[212:215], v7, s[8:11], s42 offen offset:2560 sc1
    buffer_load_dwordx4 v[216:219], v7, s[8:11], s42 offen offset:3072 sc1
    buffer_load_dwordx4 v[220:223], v7, s[8:11], s42 offen offset:3584 sc1
ch_wo_pg:
    s_waitcnt vmcnt(16)
    v_max3_u32 v8, v80, v81, v82
    v_max3_u32 v8, v8, v83, v84
    v_max3_u32 v8, v8, v85, v86
    v_max3_u32 v8, v8, v87, v88
    v_max3_u32 v8, v8, v89, v90
    v_max3_u32 v8, v8, v91, v92
    v_max3_u32 v8, v8, v93, v94
    v_max3_u32 v8, v8, v95, v96
    v_max3_u32 v8, v8, v97, v98
    v_max3_u32 v8, v8, v99, v100
    v_max3_u32 v8, v8, v101, v102
    v_max3_u32 v8, v8, v103, v104
    v_max3_u32 v8, v8, v105, v106
    v_max3_u32 v8, v8, v107, v108
    v_max3_u32 v8, v8, v109, v110
    v_max_u32 v8, v8, v111
    v_cmp_eq_u32 vcc, -1, v8
    s_add_u32 s50, s50, 1
    s_cmp_ge_u32 s50, 0x2000000
    s_cbranch_scc1 ch_end
    s_cbranch_vccz ch_wo_pok0
    buffer_load_dwordx4 v[80:83], v7, s[8:11], s42 offen offset:0 sc1
    buffer_load_dwordx4 v[84:87], v7, s[8:11], s42 offen offset:512 sc1
    buffer_load_dwordx4 v[88:91], v7, s[8:11], s42 offen offset:1024 sc1
    buffer_load_dwordx4 v[92:95], v7, s[8:11], s42 offen offset:1536 sc1
    buffer_load_dwordx4 v[96:99], v7, s[8:11], s42 offen offset:2048 sc1
    buffer_load_dwordx4 v[100:103], v7, s[8:11], s42 offen offset:2560 sc1
    buffer_load_dwordx4 v[104:107], v7, s[8:11], s42 offen offset:3072 sc1
    buffer_load_dwordx4 v[108:111], v7, s[8:11], s42 offen offset:3584 sc1
    s_waitcnt vmcnt(16)
    v_max3_u32 v8, v160, v161, v162
    v_max3_u32 v8, v8, v163, v164
    v_max3_u32 v8, v8, v165, v166
    v_max3_u32 v8, v8, v167, v168
    v_max3_u32 v8, v8, v169, v170
    v_max3_u32 v8, v8, v171, v172
    v_max3_u32 v8, v8, v173, v174
    v_max3_u32 v8, v8, v175, v176
    v_max3_u32 v8, v8, v177, v178
    v_max3_u32 v8, v8, v179, v180
    v_max3_u32 v8, v8, v181, v182
    v_max3_u32 v8, v8, v183, v184
    v_max3_u32 v8, v8, v185, v186
    v_max3_u32 v8, v8, v187, v188
    v_max3_u32 v8, v8, v189, v190
    v_max_u32 v8, v8, v191
    v_cmp_eq_u32 vcc, -1, v8
    s_add_u32 s50, s50, 1
    s_cmp_ge_u32 s50, 0x2000000
    s_cbranch_scc1 ch_end
    s_cbranch_vccz ch_wo_pok1
    buffer_load_dwordx4 v[160:163], v7, s[8:11], s42 offen offset:0 sc1
    buffer_load_dwordx4 v[164:167], v7, s[8:11], s42 offen offset:512 sc1
    buffer_load_dwordx4 v[168:171], v7, s[8:11], s42 offen offset:1024 sc1
    buffer_load_dwordx4 v[172:175], v7, s[8:11], s42 offen offset:1536 sc1
    buffer_load_dwordx4 v[176:179], v7, s[8:11], s42 offen offset:2048 sc1
    buffer_load_dwordx4 v[180:183], v7, s[8:11], s42 offen offset:2560 sc1
    buffer_load_dwordx4 v[184:187], v7, s[8:11], s42 offen offset:3072 sc1
    buffer_load_dwordx4 v[188:191], v7, s[8:11], s42 offen offset:3584 sc1
    s_waitcnt vmcnt(16)
    v_max3_u32 v8, v192, v193, v194
    v_max3_u32 v8, v8, v195, v196
    v_max3_u32 v8, v8, v197, v198
    v_max3_u32 v8, v8, v199, v200
    v_max3_u32 v8, v8, v201, v202
    v_max3_u32 v8, v8, v203, v204
    v_max3_u32 v8, v8, v205, v206
    v_max3_u32 v8, v8, v207, v208
    v_max3_u32 v8, v8, v209, v210
    v_max3_u32 v8, v8, v211, v212
    v_max3_u32 v8, v8, v213, v214
    v_max3_u32 v8, v8, v215, v216
    v_max3_u32 v8, v8, v217, v218
    v_max3_u32 v8, v8, v219, v220
    v_max3_u32 v8, v8, v221, v222
    v_max_u32 v8, v8, v223
    v_cmp_eq_u32 vcc, -1, v8
    s_add_u32 s50, s50, 1
    s_cmp_ge_u32 s50, 0x2000000
    s_cbranch_scc1 ch_end
    s_cbranch_vccz ch_wo_pok2
    buffer_load_dwordx4 v[192:195], v7, s[8:11], s42 offen offset:0 sc1
    buffer_load_dwordx4 v[196:199], v7, s[8:11], s42 offen offset:512 sc1
    buffer_load_dwordx4 v[200:203], v7, s[8:11], s42 offen offset:1024 sc1
    buffer_load_dwordx4 v[204:207], v7, s[8:11], s42 offen offset:1536 sc1
    buffer_load_dwordx4 v[208:211], v7, s[8:11], s42 offen offset:2048 sc1
    buffer_load_dwordx4 v[212:215], v7, s[8:11], s42 offen offset:2560 sc1
    buffer_load_dwordx4 v[216:219], v7, s[8:11], s42 offen offset:3072 sc1
    buffer_load_dwordx4 v[220:223], v7, s[8:11], s42 offen offset:3584 sc1
    s_branch ch_wo_pg
ch_wo_pok0:
    v_pk_add_f32 v[144:145], v[80:81], v[84:85]
    v_pk_add_f32 v[146:147], v[82:83], v[86:87]
    v_pk_add_f32 v[144:145], v[144:145], v[88:89]
    v_pk_add_f32 v[146:147], v[146:147], v[90:91]
    v_pk_add_f32 v[144:145], v[144:145], v[92:93]
    v_pk_add_f32 v[146:147], v[146:147], v[94:95]
    v_pk_add_f32 v[144:145], v[144:145], v[96:97]
    v_pk_add_f32 v[146:147], v[146:147], v[98:99]
    v_pk_add_f32 v[144:145], v[144:145], v[100:101]
    v_pk_add_f32 v[146:147], v[146:147], v[102:103]
    v_pk_add_f32 v[144:145], v[144:145], v[104:105]
    v_pk_add_f32 v[146:147], v[146:147], v[106:107]
    v_pk_add_f32 v[144:145], v[144:145], v[108:109]
    v_pk_add_f32 v[146:147], v[146:147], v[110:111]
    s_branch ch_wo_pdone
ch_wo_pok1:
    v_pk_add_f32 v[144:145], v[160:161], v[164:165]
    v_pk_add_f32 v[146:147], v[162:163], v[166:167]
    v_pk_add_f32 v[144:145], v[144:145], v[168:169]
    v_pk_add_f32 v[146:147], v[146:147], v[170:171]
    v_pk_add_f32 v[144:145], v[144:145], v[172:173]
    v_pk_add_f32 v[146:147], v[146:147], v[174:175]
    v_pk_add_f32 v[144:145], v[144:145], v[176:177]
    v_pk_add_f32 v[146:147], v[146:147], v[178:179]
    v_pk_add_f32 v[144:145], v[144:145], v[180:181]
    v_pk_add_f32 v[146:147], v[146:147], v[182:183]
    v_pk_add_f32 v[144:145], v[144:145], v[184:185]
    v_pk_add_f32 v[146:147], v[146:147], v[186:187]
    v_pk_add_f32 v[144:145], v[144:145], v[188:189]
    v_pk_add_f32 v[146:147], v[146:147], v[190:191]
    s_branch ch_wo_pdone
ch_wo_pok2:
    v_pk_add_f32 v[144:145], v[192:193], v[196:197]
    v_pk_add_f32 v[146:147], v[194:195], v[198:199]
    v_pk_add_f32 v[144:145], v[144:145], v[200:201]
    v_pk_add_f32 v[146:147], v[146:147], v[202:203]
    v_pk_add_f32 v[144:145], v[144:145], v[204:205]
    v_pk_add_f32 v[146:147], v[146:147], v[206:207]
    v_pk_add_f32 v[144:145], v[144:145], v[208:209]
    v_pk_add_f32 v[146:147], v[146:147], v[210:211]
    v_pk_add_f32 v[144:145], v[144:145], v[212:213]
    v_pk_add_f32 v[146:147], v[146:147], v[214:215]
    v_pk_add_f32 v[144:145], v[144:145], v[216:217]
    v_pk_add_f32 v[146:147], v[146:147], v[218:219]
    v_pk_add_f32 v[144:145], v[144:145], v[220:221]
    v_pk_add_f32 v[146:147], v[146:147], v[222:223]
ch_wo_pdone:
    v_cvt_pk_bf16_f32 v148, v144, v145
    v_cvt_pk_bf16_f32 v149, v146, v147
    v_min_u32 v148, s44, v148
    v_min_u32 v149, s44, v149
    s_and_b32 s41, s40, 1
    s_mul_i32 s43, s41, 81920
    s_sub_u32 s42, 81920, s43
    s_mov_b32 exec_lo, s48
    s_mov_b32 exec_hi, s49
    buffer_store_dwordx2 v[148:149], v10, s[8:11], s42 offen
    buffer_store_dwordx2 v[12:13], v10, s[8:11], s43 offen
    s_mov_b64 exec, -1
    s_cmp_lg_u32 s38, 0
    s_cbranch_scc1 ch_wo_nosig
    v_mov_b32 v121, 24604
    v_mov_b32 v8, s47
    ds_write_b32 v121, v8
ch_wo_nosig:
    s_branch ch_wo_next
ch_wo_x:
    s_add_u32 s76, s40, 2
    s_cmp_ge_u32 s76, 64
    s_cbranch_scc1 ch_wo_next
    v_mov_b32 v121, 24656
ch_wo_xpw:
    ds_read_b32 v8, v121
    s_waitcnt lgkmcnt(0)
    v_cmp_gt_u32 vcc, s47, v8
    s_add_u32 s50, s50, 1
    s_cmp_ge_u32 s50, 0x2000000
    s_cbranch_scc1 ch_end
    s_cbranch_vccz ch_wo_xpw_x
    s_sleep 2
    s_branch ch_wo_xpw
ch_wo_xpw_x:
    v_mov_b32 v8, 24640
ch_wo_xrw:
    ds_read_b128 v[80:83], v8
    s_waitcnt lgkmcnt(0)
    v_min3_u32 v80, v81, v82, v83
    v_cmp_gt_u32 vcc, s47, v80
    s_add_u32 s50, s50, 1
    s_cmp_ge_u32 s50, 0x2000000
    s_cbranch_scc1 ch_end
    s_cbranch_vccnz ch_wo_xrw
    s_cmp_eq_u32 s38, 3
    s_cbranch_scc1 ch_wo_x7
    s_and_b32 s79, s76, 1
    s_mul_i32 s79, s79, 49152
    v_add_u32 v8, s79, v123
    s_waitcnt vmcnt(0)
    v_mfma_f32_16x16x32_bf16 v[220:223], v[160:163], v[112:115], 0
    v_mfma_f32_16x16x32_bf16 v[224:227], v[180:183], v[112:115], 0
    v_mfma_f32_16x16x32_bf16 v[228:231], v[200:203], v[112:115], 0
    v_mfma_f32_16x16x32_bf16 v[220:223], v[164:167], v[116:119], v[220:223]
    v_mfma_f32_16x16x32_bf16 v[224:227], v[184:187], v[116:119], v[224:227]
    v_mfma_f32_16x16x32_bf16 v[228:231], v[204:207], v[116:119], v[228:231]
    v_mfma_f32_16x16x32_bf16 v[220:223], v[168:171], v[152:155], v[220:223]
    v_mfma_f32_16x16x32_bf16 v[224:227], v[188:191], v[152:155], v[224:227]
    v_mfma_f32_16x16x32_bf16 v[228:231], v[208:211], v[152:155], v[228:231]
    v_mfma_f32_16x16x32_bf16 v[220:223], v[172:175], v[156:159], v[220:223]
    v_mfma_f32_16x16x32_bf16 v[224:227], v[192:195], v[156:159], v[224:227]
    v_mfma_f32_16x16x32_bf16 v[228:231], v[212:215], v[156:159], v[228:231]
    v_mfma_f32_16x16x32_bf16 v[220:223], v[176:179], v[244:247], v[220:223]
    v_mfma_f32_16x16x32_bf16 v[224:227], v[196:199], v[244:247], v[224:227]
    v_mfma_f32_16x16x32_bf16 v[228:231], v[216:219], v[244:247], v[228:231]
    v_mfma_f32_16x16x32_bf16 v[232:235], v[160:163], v[124:127], 0
    v_mfma_f32_16x16x32_bf16 v[236:239], v[180:183], v[124:127], 0
    v_mfma_f32_16x16x32_bf16 v[240:243], v[200:203], v[124:127], 0
    v_mfma_f32_16x16x32_bf16 v[232:235], v[164:167], v[128:131], v[232:235]
    v_mfma_f32_16x16x32_bf16 v[236:239], v[184:187], v[128:131], v[236:239]
    v_mfma_f32_16x16x32_bf16 v[240:243], v[204:207], v[128:131], v[240:243]
    v_mfma_f32_16x16x32_bf16 v[232:235], v[168:171], v[132:135], v[232:235]
    v_mfma_f32_16x16x32_bf16 v[236:239], v[188:191], v[132:135], v[236:239]
    v_mfma_f32_16x16x32_bf16 v[240:243], v[208:211], v[132:135], v[240:243]
    v_mfma_f32_16x16x32_bf16 v[232:235], v[172:175], v[136:139], v[232:235]
    v_mfma_f32_16x16x32_bf16 v[236:239], v[192:195], v[136:139], v[236:239]
    v_mfma_f32_16x16x32_bf16 v[240:243], v[212:215], v[136:139], v[240:243]
    v_mfma_f32_16x16x32_bf16 v[232:235], v[176:179], v[140:143], v[232:235]
    v_mfma_f32_16x16x32_bf16 v[236:239], v[196:199], v[140:143], v[236:239]
    v_mfma_f32_16x16x32_bf16 v[240:243], v[216:219], v[140:143], v[240:243]
    s_nop 7
    ds_write_b128 v8, v[220:223] offset:0
    ds_write_b128 v8, v[224:227] offset:1024
    ds_write_b128 v8, v[228:231] offset:2048
    ds_write_b128 v8, v[232:235] offset:6144
    ds_write_b128 v8, v[236:239] offset:7168
    ds_write_b128 v8, v[240:243] offset:8192
    s_add_u32 s77, s76, 1
    v_mov_b32 v8, s77
    v_mov_b32 v121, 24624
    s_waitcnt lgkmcnt(0)
    ds_write_b32 v121, v8
    s_branch ch_wo_next
ch_wo_x7:
    s_and_b32 s79, s76, 1
    s_mul_i32 s79, s79, 49152
    v_add_u32 v8, s79, v123
    s_waitcnt vmcnt(0)
    v_mfma_f32_16x16x32_bf16 v[220:223], v[160:163], v[112:115], 0
    v_mfma_f32_16x16x32_bf16 v[224:227], v[112:115], v[180:183], 0
    v_mfma_f32_16x16x32_bf16 v[228:231], v[112:115], v[200:203], 0
    v_mfma_f32_16x16x32_bf16 v[220:223], v[164:167], v[116:119], v[220:223]
    v_mfma_f32_16x16x32_bf16 v[224:227], v[116:119], v[184:187], v[224:227]
    v_mfma_f32_16x16x32_bf16 v[228:231], v[116:119], v[204:207], v[228:231]
    v_mfma_f32_16x16x32_bf16 v[220:223], v[168:171], v[152:155], v[220:223]
    v_mfma_f32_16x16x32_bf16 v[224:227], v[152:155], v[188:191], v[224:227]
    v_mfma_f32_16x16x32_bf16 v[228:231], v[152:155], v[208:211], v[228:231]
    v_mfma_f32_16x16x32_bf16 v[220:223], v[172:175], v[156:159], v[220:223]
    v_mfma_f32_16x16x32_bf16 v[224:227], v[156:159], v[192:195], v[224:227]
    v_mfma_f32_16x16x32_bf16 v[228:231], v[156:159], v[212:215], v[228:231]
    v_mfma_f32_16x16x32_bf16 v[220:223], v[176:179], v[244:247], v[220:223]
    v_mfma_f32_16x16x32_bf16 v[224:227], v[244:247], v[196:199], v[224:227]
    v_mfma_f32_16x16x32_bf16 v[228:231], v[244:247], v[216:219], v[228:231]
    v_mfma_f32_16x16x32_bf16 v[232:235], v[160:163], v[124:127], 0
    v_mfma_f32_16x16x32_bf16 v[236:239], v[124:127], v[180:183], 0
    v_mfma_f32_16x16x32_bf16 v[240:243], v[124:127], v[200:203], 0
    v_mfma_f32_16x16x32_bf16 v[232:235], v[164:167], v[128:131], v[232:235]
    v_mfma_f32_16x16x32_bf16 v[236:239], v[128:131], v[184:187], v[236:239]
    v_mfma_f32_16x16x32_bf16 v[240:243], v[128:131], v[204:207], v[240:243]
    v_mfma_f32_16x16x32_bf16 v[232:235], v[168:171], v[132:135], v[232:235]
    v_mfma_f32_16x16x32_bf16 v[236:239], v[132:135], v[188:191], v[236:239]
    v_mfma_f32_16x16x32_bf16 v[240:243], v[132:135], v[208:211], v[240:243]
    v_mfma_f32_16x16x32_bf16 v[232:235], v[172:175], v[136:139], v[232:235]
    v_mfma_f32_16x16x32_bf16 v[236:239], v[136:139], v[192:195], v[236:239]
    v_mfma_f32_16x16x32_bf16 v[240:243], v[136:139], v[212:215], v[240:243]
    v_mfma_f32_16x16x32_bf16 v[232:235], v[176:179], v[140:143], v[232:235]
    v_mfma_f32_16x16x32_bf16 v[236:239], v[140:143], v[196:199], v[236:239]
    v_mfma_f32_16x16x32_bf16 v[240:243], v[140:143], v[216:219], v[240:243]
    s_nop 7
    ds_write_b128 v8, v[220:223] offset:3072
    ds_write_b128 v8, v[224:227] offset:4096
    ds_write_b128 v8, v[228:231] offset:5120
    ds_write_b128 v8, v[232:235] offset:9216
    ds_write_b128 v8, v[236:239] offset:10240
    ds_write_b128 v8, v[240:243] offset:11264
    s_add_u32 s77, s76, 1
    v_mov_b32 v8, s77
    v_mov_b32 v121, 24660
    s_waitcnt lgkmcnt(0)
    ds_write_b32 v121, v8
ch_wo_next:
    s_add_u32 s40, s40, 1
    s_cmp_lt_u32 s40, 63
    s_cbranch_scc1 ch_wo_loop
ch_end:
    s_endpgm
.section .rodata,"a"
.p2align 6
.amdhsa_kernel chain_kernel
  .amdhsa_next_free_vgpr 256
  .amdhsa_next_free_sgpr 102
  .amdhsa_accum_offset 256
  .amdhsa_group_segment_fixed_size 0
  .amdhsa_kernarg_size 112
  .amdhsa_user_sgpr_count 2
  .amdhsa_user_sgpr_kernarg_segment_ptr 1
  .amdhsa_system_sgpr_workgroup_id_x 1
  .amdhsa_float_denorm_mode_32 3
.end_amdhsa_kernel
.text
.globl p3_kernel
.p2align 8
.type p3_kernel,@function
p3_kernel:
    s_load_dwordx2 s[4:5], s[0:1], 104
    s_cmp_ge_u32 s2, 512
    s_cbranch_scc1 p3_end
    v_lshrrev_b32 v4, 6, v0
    v_and_b32 v0, 63, v0
    v_readfirstlane_b32 s29, v4
    v_and_b32 v1, 15, v0
    v_lshrrev_b32 v2, 4, v0
    s_lshr_b32 s30, s2, 3
    s_and_b32 s31, s2, 7
    s_lshl_b32 s31, s31, 2
    s_add_u32 s31, s31, s29
    s_mul_i32 s32, s31, 192
    s_lshl_b32 s33, s30, 5
    s_add_u32 s33, s33, s31
    s_waitcnt lgkmcnt(0)
    s_add_u32 s8, s4, 0x2620000
    s_addc_u32 s9, s5, 0
    s_and_b32 s9, s9, 0xffff
    s_mov_b32 s10, 0x6000000
    s_mov_b32 s11, 0x20000
    s_add_u32 s16, s4, 0x8620000
    s_addc_u32 s17, s5, 0
    s_and_b32 s17, s17, 0xffff
    s_mov_b32 s18, 0x1000000
    s_mov_b32 s19, 0x20000
    s_add_u32 s20, s4, 0x9620000
    s_addc_u32 s21, s5, 0
    s_and_b32 s21, s21, 0xffff
    s_mov_b32 s22, 0x800000
    s_mov_b32 s23, 0x20000
    s_add_u32 s24, s4, 0x9e20000
    s_addc_u32 s25, s5, 0
    s_and_b32 s25, s25, 0xffff
    s_mov_b32 s26, 0x1800000
    s_mov_b32 s27, 0x20000
    v_lshlrev_b32 v3, 4, v0
    v_lshlrev_b32 v4, 3, v0
    s_lshl_b32 s34, s33, 14
    s_add_u32 s35, s34, 33554432
    s_add_u32 s36, s34, 67108864
    s_lshl_b32 s37, s33, 13
    s_lshl_b32 s38, s33, 12
    s_add_u32 s39, s34, 0
    buffer_load_dwordx4 v[16:19], v3, s[8:11], s39 offen
    buffer_load_dwordx4 v[20:23], v3, s[8:11], s39 offen offset:1024
    s_add_u32 s39, s35, 0
    buffer_load_dwordx4 v[24:27], v3, s[8:11], s39 offen
    buffer_load_dwordx4 v[28:31], v3, s[8:11], s39 offen offset:1024
    s_add_u32 s39, s37, 0
    buffer_load_dwordx4 v[32:35], v3, s[16:19], s39 offen
    s_add_u32 s39, s34, 2048
    buffer_load_dwordx4 v[36:39], v3, s[8:11], s39 offen
    buffer_load_dwordx4 v[40:43], v3, s[8:11], s39 offen offset:1024
    s_add_u32 s39, s35, 2048
    buffer_load_dwordx4 v[44:47], v3, s[8:11], s39 offen
    buffer_load_dwordx4 v[48:51], v3, s[8:11], s39 offen offset:1024
    s_add_u32 s39, s37, 1024
    buffer_load_dwordx4 v[52:55], v3, s[16:19], s39 offen
    s_add_u32 s39, s34, 4096
    buffer_load_dwordx4 v[56:59], v3, s[8:11], s39 offen
    buffer_load_dwordx4 v[60:63], v3, s[8:11], s39 offen offset:1024
    s_add_u32 s39, s35, 4096
    buffer_load_dwordx4 v[64:67], v3, s[8:11], s39 offen
    buffer_load_dwordx4 v[68:71], v3, s[8:11], s39 offen offset:1024
    s_add_u32 s39, s37, 2048
    buffer_load_dwordx4 v[72:75], v3, s[16:19], s39 offen
    s_add_u32 s39, s34, 6144
    buffer_load_dwordx4 v[76:79], v3, s[8:11], s39 offen
    buffer_load_dwordx4 v[80:83], v3, s[8:11], s39 offen offset:1024
    s_add_u32 s39, s35, 6144
    buffer_load_dwordx4 v[84:87], v3, s[8:11], s39 offen
    buffer_load_dwordx4 v[88:91], v3, s[8:11], s39 offen offset:1024
    s_add_u32 s39, s37, 3072
    buffer_load_dwordx4 v[92:95], v3, s[16:19], s39 offen
    s_add_u32 s39, s34, 8192
    buffer_load_dwordx4 v[96:99], v3, s[8:11], s39 offen
    buffer_load_dwordx4 v[100:103], v3, s[8:11], s39 offen offset:1024
    s_add_u32 s39, s35, 8192
    buffer_load_dwordx4 v[104:107], v3, s[8:11], s39 offen
    buffer_load_dwordx4 v[108:111], v3, s[8:11], s39 offen offset:1024
    s_add_u32 s39, s37, 4096
    buffer_load_dwordx4 v[112:115], v3, s[16:19], s39 offen
    s_add_u32 s39, s34, 10240
    buffer_load_dwordx4 v[116:119], v3, s[8:11], s39 offen
    buffer_load_dwordx4 v[120:123], v3, s[8:11], s39 offen offset:1024
    s_add_u32 s39, s35, 10240
    buffer_load_dwordx4 v[124:127], v3, s[8:11], s39 offen
    buffer_load_dwordx4 v[128:131], v3, s[8:11], s39 offen offset:1024
    s_add_u32 s39, s37, 5120
    buffer_load_dwordx4 v[132:135], v3, s[16:19], s39 offen
    s_add_u32 s39, s34, 12288
    buffer_load_dwordx4 v[136:139], v3, s[8:11], s39 offen
    buffer_load_dwordx4 v[140:143], v3, s[8:11], s39 offen offset:1024
    s_add_u32 s39, s35, 12288
    buffer_load_dwordx4 v[144:147], v3, s[8:11], s39 offen
    buffer_load_dwordx4 v[148:151], v3, s[8:11], s39 offen offset:1024
    s_add_u32 s39, s37, 6144
    buffer_load_dwordx4 v[152:155], v3, s[16:19], s39 offen
    s_add_u32 s39, s34, 14336
    buffer_load_dwordx4 v[156:159], v3, s[8:11], s39 offen
    buffer_load_dwordx4 v[160:163], v3, s[8:11], s39 offen offset:1024
    s_add_u32 s39, s35, 14336
    buffer_load_dwordx4 v[164:167], v3, s[8:11], s39 offen
    buffer_load_dwordx4 v[168:171], v3, s[8:11], s39 offen offset:1024
    s_add_u32 s39, s37, 7168
    buffer_load_dwordx4 v[172:175], v3, s[16:19], s39 offen
    v_lshlrev_b32 v5, 2, v2
    v_add_u32 v6, 0, v5
    v_cmp_gt_u32 s[40:41], v6, v1
    v_add_u32 v6, 1, v5
    v_cmp_gt_u32 s[42:43], v6, v1
    v_add_u32 v6, 2, v5
    v_cmp_gt_u32 s[44:45], v6, v1
    v_add_u32 v6, 3, v5
    v_cmp_gt_u32 s[46:47], v6, v1
    s_waitcnt vmcnt(35)
    v_mfma_f32_16x16x32_bf16 v[176:179], v[24:27], v[16:19], 0
    v_mfma_f32_16x16x32_bf16 v[180:183], v[24:27], v[20:23], 0
    v_mfma_f32_16x16x32_bf16 v[184:187], v[28:31], v[20:23], 0
    v_mfma_f32_16x16x32_bf16 v[188:191], v[32:35], v[16:19], 0
    v_mfma_f32_16x16x32_bf16 v[192:195], v[32:35], v[20:23], 0
    s_waitcnt vmcnt(30)
    v_mfma_f32_16x16x32_bf16 v[176:179], v[44:47], v[36:39], v[176:179]
    v_mfma_f32_16x16x32_bf16 v[180:183], v[44:47], v[40:43], v[180:183]
    v_mfma_f32_16x16x32_bf16 v[184:187], v[48:51], v[40:43], v[184:187]
    v_mfma_f32_16x16x32_bf16 v[188:191], v[52:55], v[36:39], v[188:191]
    v_mfma_f32_16x16x32_bf16 v[192:195], v[52:55], v[40:43], v[192:195]
    s_waitcnt vmcnt(25)
    v_mfma_f32_16x16x32_bf16 v[176:179], v[64:67], v[56:59], v[176:179]
    v_mfma_f32_16x16x32_bf16 v[180:183], v[64:67], v[60:63], v[180:183]
    v_mfma_f32_16x16x32_bf16 v[184:187], v[68:71], v[60:63], v[184:187]
    v_mfma_f32_16x16x32_bf16 v[188:191], v[72:75], v[56:59], v[188:191]
    v_mfma_f32_16x16x32_bf16 v[192:195], v[72:75], v[60:63], v[192:195]
    s_waitcnt vmcnt(20)
    v_mfma_f32_16x16x32_bf16 v[176:179], v[84:87], v[76:79], v[176:179]
    v_mfma_f32_16x16x32_bf16 v[180:183], v[84:87], v[80:83], v[180:183]
    v_mfma_f32_16x16x32_bf16 v[184:187], v[88:91], v[80:83], v[184:187]
    v_mfma_f32_16x16x32_bf16 v[188:191], v[92:95], v[76:79], v[188:191]
    v_mfma_f32_16x16x32_bf16 v[192:195], v[92:95], v[80:83], v[192:195]
    s_waitcnt vmcnt(15)
    v_mfma_f32_16x16x32_bf16 v[176:179], v[104:107], v[96:99], v[176:179]
    v_mfma_f32_16x16x32_bf16 v[180:183], v[104:107], v[100:103], v[180:183]
    v_mfma_f32_16x16x32_bf16 v[184:187], v[108:111], v[100:103], v[184:187]
    v_mfma_f32_16x16x32_bf16 v[188:191], v[112:115], v[96:99], v[188:191]
    v_mfma_f32_16x16x32_bf16 v[192:195], v[112:115], v[100:103], v[192:195]
    s_waitcnt vmcnt(10)
    v_mfma_f32_16x16x32_bf16 v[176:179], v[124:127], v[116:119], v[176:179]
    v_mfma_f32_16x16x32_bf16 v[180:183], v[124:127], v[120:123], v[180:183]
    v_mfma_f32_16x16x32_bf16 v[184:187], v[128:131], v[120:123], v[184:187]
    v_mfma_f32_16x16x32_bf16 v[188:191], v[132:135], v[116:119], v[188:191]
    v_mfma_f32_16x16x32_bf16 v[192:195], v[132:135], v[120:123], v[192:195]
    s_waitcnt vmcnt(5)
    v_mfma_f32_16x16x32_bf16 v[176:179], v[144:147], v[136:139], v[176:179]
    v_mfma_f32_16x16x32_bf16 v[180:183], v[144:147], v[140:143], v[180:183]
    v_mfma_f32_16x16x32_bf16 v[184:187], v[148:151], v[140:143], v[184:187]
    v_mfma_f32_16x16x32_bf16 v[188:191], v[152:155], v[136:139], v[188:191]
    v_mfma_f32_16x16x32_bf16 v[192:195], v[152:155], v[140:143], v[192:195]
    s_waitcnt vmcnt(0)
    v_mfma_f32_16x16x32_bf16 v[176:179], v[164:167], v[156:159], v[176:179]
    v_mfma_f32_16x16x32_bf16 v[180:183], v[164:167], v[160:163], v[180:183]
    v_mfma_f32_16x16x32_bf16 v[184:187], v[168:171], v[160:163], v[184:187]
    v_mfma_f32_16x16x32_bf16 v[188:191], v[172:175], v[156:159], v[188:191]
    v_mfma_f32_16x16x32_bf16 v[192:195], v[172:175], v[160:163], v[192:195]
    s_nop 7
    s_nop 7
    s_add_u32 s39, s36, 0
    buffer_load_dwordx4 v[16:19], v3, s[8:11], s39 offen
    buffer_load_dwordx4 v[20:23], v3, s[8:11], s39 offen offset:1024
    s_add_u32 s39, s36, 2048
    buffer_load_dwordx4 v[24:27], v3, s[8:11], s39 offen
    buffer_load_dwordx4 v[28:31], v3, s[8:11], s39 offen offset:1024
    s_add_u32 s39, s36, 4096
    buffer_load_dwordx4 v[32:35], v3, s[8:11], s39 offen
    buffer_load_dwordx4 v[36:39], v3, s[8:11], s39 offen offset:1024
    s_add_u32 s39, s36, 6144
    buffer_load_dwordx4 v[40:43], v3, s[8:11], s39 offen
    buffer_load_dwordx4 v[44:47], v3, s[8:11], s39 offen offset:1024
    s_add_u32 s39, s36, 8192
    buffer_load_dwordx4 v[48:51], v3, s[8:11], s39 offen
    buffer_load_dwordx4 v[52:55], v3, s[8:11], s39 offen offset:1024
    s_add_u32 s39, s36, 10240
    buffer_load_dwordx4 v[56:59], v3, s[8:11], s39 offen
    buffer_load_dwordx4 v[60:63], v3, s[8:11], s39 offen offset:1024
    s_add_u32 s39, s36, 12288
    buffer_load_dwordx4 v[64:67], v3, s[8:11], s39 offen
    buffer_load_dwordx4 v[68:71], v3, s[8:11], s39 offen offset:1024
    s_add_u32 s39, s36, 14336
    buffer_load_dwordx4 v[72:75], v3, s[8:11], s39 offen
    buffer_load_dwordx4 v[76:79], v3, s[8:11], s39 offen offset:1024
    v_mov_b32 v80, 0
    v_mov_b32 v81, 0
    v_mov_b32 v82, 0
    v_mov_b32 v83, 0
    v_mov_b32 v84, 0
    v_mov_b32 v85, 0
    v_mov_b32 v86, 0
    v_mov_b32 v87, 0
    v_mov_b32 v88, 0
    v_mov_b32 v89, 0
    v_mov_b32 v90, 0
    v_mov_b32 v91, 0
    v_mov_b32 v92, 0
    v_mov_b32 v93, 0
    v_mov_b32 v94, 0
    v_mov_b32 v95, 0
    v_mov_b32 v96, 0
    v_mov_b32 v97, 0
    v_mov_b32 v98, 0
    v_mov_b32 v99, 0
    v_mov_b32 v100, 0
    v_mov_b32 v101, 0
    v_mov_b32 v102, 0
    v_mov_b32 v103, 0
    v_mov_b32 v104, 0
    v_mov_b32 v105, 0
    v_mov_b32 v106, 0
    v_mov_b32 v107, 0
    v_mov_b32 v108, 0
    v_mov_b32 v109, 0
    v_mov_b32 v110, 0
    v_mov_b32 v111, 0
    v_mov_b32 v112, 0
    v_mov_b32 v113, 0
    v_mov_b32 v114, 0
    v_mov_b32 v115, 0
    v_mov_b32 v116, 0
    v_mov_b32 v117, 0
    v_mov_b32 v118, 0
    v_mov_b32 v119, 0
    v_mov_b32 v120, 0
    v_mov_b32 v121, 0
    v_mov_b32 v122, 0
    v_mov_b32 v123, 0
    v_mov_b32 v124, 0
    v_mov_b32 v125, 0
    v_mov_b32 v126, 0
    v_mov_b32 v127, 0
    v_mov_b32 v128, 0
    v_mov_b32 v129, 0
    v_mov_b32 v130, 0
    v_mov_b32 v131, 0
    v_mov_b32 v132, 0
    v_mov_b32 v133, 0
    v_mov_b32 v134, 0
    v_mov_b32 v135, 0
    v_mov_b32 v136, 0
    v_mov_b32 v137, 0
    v_mov_b32 v138, 0
    v_mov_b32 v139, 0
    v_mov_b32 v140, 0
    v_mov_b32 v141, 0
    v_mov_b32 v142, 0
    v_mov_b32 v143, 0
    s_mov_b32 exec_lo, 0xffffffff
    s_mov_b32 exec_hi, 0x0
    buffer_load_dwordx2 v[80:81], v4, s[20:23], s38 offen offset:0
    buffer_load_dwordx2 v[84:85], v4, s[20:23], s38 offen offset:256
    buffer_load_dwordx2 v[88:89], v4, s[20:23], s38 offen offset:512
    buffer_load_dwordx2 v[92:93], v4, s[20:23], s38 offen offset:768
    buffer_load_dwordx2 v[96:97], v4, s[20:23], s38 offen offset:1024
    buffer_load_dwordx2 v[100:101], v4, s[20:23], s38 offen offset:1280
    buffer_load_dwordx2 v[104:105], v4, s[20:23], s38 offen offset:1536
    buffer_load_dwordx2 v[108:109], v4, s[20:23], s38 offen offset:1792
    buffer_load_dwordx2 v[112:113], v4, s[20:23], s38 offen offset:2048
    buffer_load_dwordx2 v[116:117], v4, s[20:23], s38 offen offset:2304
    buffer_load_dwordx2 v[120:121], v4, s[20:23], s38 offen offset:2560
    buffer_load_dwordx2 v[124:125], v4, s[20:23], s38 offen offset:2816
    buffer_load_dwordx2 v[128:129], v4, s[20:23], s38 offen offset:3072
    buffer_load_dwordx2 v[132:133], v4, s[20:23], s38 offen offset:3328
    buffer_load_dwordx2 v[136:137], v4, s[20:23], s38 offen offset:3584
    buffer_load_dwordx2 v[140:141], v4, s[20:23], s38 offen offset:3840
    s_mov_b64 exec, -1
    s_mov_b32 s48, 0x3d93cd3a
    s_mov_b32 s49, 0xffff0000
    v_cvt_pk_bf16_f32 v9, v176, v177
    v_lshlrev_b32 v176, 16, v9
    v_and_b32 v177, s49, v9
    v_cvt_pk_bf16_f32 v9, v178, v179
    v_lshlrev_b32 v178, 16, v9
    v_and_b32 v179, s49, v9
    v_cvt_pk_bf16_f32 v9, v180, v181
    v_lshlrev_b32 v180, 16, v9
    v_and_b32 v181, s49, v9
    v_cvt_pk_bf16_f32 v9, v182, v183
    v_lshlrev_b32 v182, 16, v9
    v_and_b32 v183, s49, v9
    v_cvt_pk_bf16_f32 v9, v184, v185
    v_lshlrev_b32 v184, 16, v9
    v_and_b32 v185, s49, v9
    v_cvt_pk_bf16_f32 v9, v186, v187
    v_lshlrev_b32 v186, 16, v9
    v_and_b32 v187, s49, v9
    v_cvt_pk_bf16_f32 v9, v188, v189
    v_lshlrev_b32 v188, 16, v9
    v_and_b32 v189, s49, v9
    v_cvt_pk_bf16_f32 v9, v190, v191
    v_lshlrev_b32 v190, 16, v9
    v_and_b32 v191, s49, v9
    v_cvt_pk_bf16_f32 v9, v192, v193
    v_lshlrev_b32 v192, 16, v9
    v_and_b32 v193, s49, v9
    v_cvt_pk_bf16_f32 v9, v194, v195
    v_lshlrev_b32 v194, 16, v9
    v_and_b32 v195, s49, v9
    v_mul_f32 v176, s48, v176
    v_mul_f32 v177, s48, v177
    v_mul_f32 v178, s48, v178
    v_mul_f32 v179, s48, v179
    v_mul_f32 v180, s48, v180
    v_mul_f32 v181, s48, v181
    v_mul_f32 v182, s48, v182
    v_mul_f32 v183, s48, v183
    v_mul_f32 v184, s48, v184
    v_mul_f32 v185, s48, v185
    v_mul_f32 v186, s48, v186
    v_mul_f32 v187, s48, v187
    v_mul_f32 v188, s48, v188
    v_mul_f32 v189, s48, v189
    v_mul_f32 v190, s48, v190
    v_mul_f32 v191, s48, v191
    v_mul_f32 v192, s48, v192
    v_mul_f32 v193, s48, v193
    v_mul_f32 v194, s48, v194
    v_mul_f32 v195, s48, v195
    v_cvt_pk_bf16_f32 v9, v176, v177
    v_lshlrev_b32 v176, 16, v9
    v_and_b32 v177, s49, v9
    v_cvt_pk_bf16_f32 v9, v178, v179
    v_lshlrev_b32 v178, 16, v9
    v_and_b32 v179, s49, v9
    v_cvt_pk_bf16_f32 v9, v180, v181
    v_lshlrev_b32 v180, 16, v9
    v_and_b32 v181, s49, v9
    v_cvt_pk_bf16_f32 v9, v182, v183
    v_lshlrev_b32 v182, 16, v9
    v_and_b32 v183, s49, v9
    v_cvt_pk_bf16_f32 v9, v184, v185
    v_lshlrev_b32 v184, 16, v9
    v_and_b32 v185, s49, v9
    v_cvt_pk_bf16_f32 v9, v186, v187
    v_lshlrev_b32 v186, 16, v9
    v_and_b32 v187, s49, v9
    v_cvt_pk_bf16_f32 v9, v188, v189
    v_lshlrev_b32 v188, 16, v9
    v_and_b32 v189, s49, v9
    v_cvt_pk_bf16_f32 v9, v190, v191
    v_lshlrev_b32 v190, 16, v9
    v_and_b32 v191, s49, v9
    v_cvt_pk_bf16_f32 v9, v192, v193
    v_lshlrev_b32 v192, 16, v9
    v_and_b32 v193, s49, v9
    v_cvt_pk_bf16_f32 v9, v194, v195
    v_lshlrev_b32 v194, 16, v9
    v_and_b32 v195, s49, v9
    v_mov_b32 v9, 0xff800000
    v_cndmask_b32 v176, v176, v9, s[40:41]
    v_cndmask_b32 v177, v177, v9, s[42:43]
    v_cndmask_b32 v178, v178, v9, s[44:45]
    v_cndmask_b32 v179, v179, v9, s[46:47]
    v_cndmask_b32 v184, v184, v9, s[40:41]
    v_cndmask_b32 v185, v185, v9, s[42:43]
    v_cndmask_b32 v186, v186, v9, s[44:45]
    v_cndmask_b32 v187, v187, v9, s[46:47]
    s_mov_b32 exec_lo, 0x0
    s_mov_b32 exec_hi, 0xffffffff
    v_mov_b32 v188, 0xff800000
    v_mov_b32 v189, 0xff800000
    v_mov_b32 v190, 0xff800000
    v_mov_b32 v191, 0xff800000
    v_mov_b32 v192, 0xff800000
    v_mov_b32 v193, 0xff800000
    v_mov_b32 v194, 0xff800000
    v_mov_b32 v195, 0xff800000
    s_mov_b64 exec, -1
    s_mov_b32 s48, 0x3fb8aa3b
    v_max3_f32 v9, v176, v177, v178
    v_max3_f32 v9, v9, v179, v188
    v_max3_f32 v9, v9, v189, v190
    v_max_f32 v9, v9, v191
    v_mov_b32 v10, v9
    v_mov_b32 v11, v9
    s_nop 1
    v_permlane32_swap_b32 v10, v11
    s_nop 1
    v_max_f32 v9, v10, v11
    v_mov_b32 v10, v9
    v_mov_b32 v11, v9
    s_nop 1
    v_permlane16_swap_b32 v10, v11
    s_nop 1
    v_max_f32 v9, v10, v11
    v_mul_f32 v9, s48, v9
    v_fma_f32 v176, v176, s48, -v9
    v_fma_f32 v177, v177, s48, -v9
    v_fma_f32 v178, v178, s48, -v9
    v_fma_f32 v179, v179, s48, -v9
    v_fma_f32 v188, v188, s48, -v9
    v_fma_f32 v189, v189, s48, -v9
    v_fma_f32 v190, v190, s48, -v9
    v_fma_f32 v191, v191, s48, -v9
    v_exp_f32 v176, v176
    v_exp_f32 v177, v177
    v_exp_f32 v178, v178
    v_exp_f32 v179, v179
    v_exp_f32 v188, v188
    v_exp_f32 v189, v189
    v_exp_f32 v190, v190
    v_exp_f32 v191, v191
    s_nop 0
    v_add_f32 v9, v176, v177
    v_add_f32 v9, v9, v178
    v_add_f32 v9, v9, v179
    v_add_f32 v9, v9, v188
    v_add_f32 v9, v9, v189
    v_add_f32 v9, v9, v190
    v_add_f32 v9, v9, v191
    v_mov_b32 v10, v9
    v_mov_b32 v11, v9
    s_nop 1
    v_permlane32_swap_b32 v10, v11
    s_nop 1
    v_add_f32 v9, v10, v11
    v_mov_b32 v10, v9
    v_mov_b32 v11, v9
    s_nop 1
    v_permlane16_swap_b32 v10, v11
    s_nop 1
    v_add_f32 v9, v10, v11
    v_rcp_f32 v9, v9
    s_nop 0
    v_mul_f32 v176, v176, v9
    v_mul_f32 v177, v177, v9
    v_mul_f32 v178, v178, v9
    v_mul_f32 v179, v179, v9
    v_mul_f32 v188, v188, v9
    v_mul_f32 v189, v189, v9
    v_mul_f32 v190, v190, v9
    v_mul_f32 v191, v191, v9
    v_max3_f32 v9, v180, v181, v182
    v_max3_f32 v9, v9, v183, v184
    v_max3_f32 v9, v9, v185, v186
    v_max3_f32 v9, v9, v187, v192
    v_max3_f32 v9, v9, v193, v194
    v_max_f32 v9, v9, v195
    v_mov_b32 v10, v9
    v_mov_b32 v11, v9
    s_nop 1
    v_permlane32_swap_b32 v10, v11
    s_nop 1
    v_max_f32 v9, v10, v11
    v_mov_b32 v10, v9
    v_mov_b32 v11, v9
    s_nop 1
    v_permlane16_swap_b32 v10, v11
    s_nop 1
    v_max_f32 v9, v10, v11
    v_mul_f32 v9, s48, v9
    v_fma_f32 v180, v180, s48, -v9
    v_fma_f32 v181, v181, s48, -v9
    v_fma_f32 v182, v182, s48, -v9
    v_fma_f32 v183, v183, s48, -v9
    v_fma_f32 v184, v184, s48, -v9
    v_fma_f32 v185, v185, s48, -v9
    v_fma_f32 v186, v186, s48, -v9
    v_fma_f32 v187, v187, s48, -v9
    v_fma_f32 v192, v192, s48, -v9
    v_fma_f32 v193, v193, s48, -v9
    v_fma_f32 v194, v194, s48, -v9
    v_fma_f32 v195, v195, s48, -v9
    v_exp_f32 v180, v180
    v_exp_f32 v181, v181
    v_exp_f32 v182, v182
    v_exp_f32 v183, v183
    v_exp_f32 v184, v184
    v_exp_f32 v185, v185
    v_exp_f32 v186, v186
    v_exp_f32 v187, v187
    v_exp_f32 v192, v192
    v_exp_f32 v193, v193
    v_exp_f32 v194, v194
    v_exp_f32 v195, v195
    s_nop 0
    v_add_f32 v9, v180, v181
    v_add_f32 v9, v9, v182
    v_add_f32 v9, v9, v183
    v_add_f32 v9, v9, v184
    v_add_f32 v9, v9, v185
    v_add_f32 v9, v9, v186
    v_add_f32 v9, v9, v187
    v_add_f32 v9, v9, v192
    v_add_f32 v9, v9, v193
    v_add_f32 v9, v9, v194
    v_add_f32 v9, v9, v195
    v_mov_b32 v10, v9
    v_mov_b32 v11, v9
    s_nop 1
    v_permlane32_swap_b32 v10, v11
    s_nop 1
    v_add_f32 v9, v10, v11
    v_mov_b32 v10, v9
    v_mov_b32 v11, v9
    s_nop 1
    v_permlane16_swap_b32 v10, v11
    s_nop 1
    v_add_f32 v9, v10, v11
    v_rcp_f32 v9, v9
    s_nop 0
    v_mul_f32 v180, v180, v9
    v_mul_f32 v181, v181, v9
    v_mul_f32 v182, v182, v9
    v_mul_f32 v183, v183, v9
    v_mul_f32 v184, v184, v9
    v_mul_f32 v185, v185, v9
    v_mul_f32 v186, v186, v9
    v_mul_f32 v187, v187, v9
    v_mul_f32 v192, v192, v9
    v_mul_f32 v193, v193, v9
    v_mul_f32 v194, v194, v9
    v_mul_f32 v195, v195, v9
    v_cvt_pk_bf16_f32 v144, v176, v177
    v_cvt_pk_bf16_f32 v145, v178, v179
    v_mov_b32 v146, 0
    v_mov_b32 v147, 0
    v_cvt_pk_bf16_f32 v148, v188, v189
    v_cvt_pk_bf16_f32 v149, v190, v191
    v_mov_b32 v150, 0
    v_mov_b32 v151, 0
    v_cvt_pk_bf16_f32 v152, v180, v181
    v_cvt_pk_bf16_f32 v153, v182, v183
    v_cvt_pk_bf16_f32 v154, v184, v185
    v_cvt_pk_bf16_f32 v155, v186, v187
    v_cvt_pk_bf16_f32 v156, v192, v193
    v_cvt_pk_bf16_f32 v157, v194, v195
    v_mov_b32 v158, 0
    v_mov_b32 v159, 0
    v_mul_u32_u24 v3, 12288, v1
    v_lshl_add_u32 v3, v2, 3, v3
    s_lshl_b32 s39, s32, 1
    v_add_u32 v3, s39, v3
    s_mul_i32 s34, s30, 393216
    s_add_u32 s35, s34, 196608
    s_waitcnt vmcnt(0)
    v_mfma_f32_16x16x32_bf16 v[160:163], v[16:19], v[144:147], 0
    v_mfma_f32_16x16x32_bf16 v[164:167], v[16:19], v[152:155], 0
    v_mfma_f32_16x16x32_bf16 v[168:171], v[20:23], v[144:147], 0
    v_mfma_f32_16x16x32_bf16 v[172:175], v[20:23], v[152:155], 0
    v_mfma_f32_16x16x32_bf16 v[176:179], v[24:27], v[144:147], 0
    v_mfma_f32_16x16x32_bf16 v[180:183], v[24:27], v[152:155], 0
    v_mfma_f32_16x16x32_bf16 v[184:187], v[28:31], v[144:147], 0
    v_mfma_f32_16x16x32_bf16 v[188:191], v[28:31], v[152:155], 0
    v_mfma_f32_16x16x32_bf16 v[192:195], v[32:35], v[144:147], 0
    v_mfma_f32_16x16x32_bf16 v[196:199], v[32:35], v[152:155], 0
    v_mfma_f32_16x16x32_bf16 v[200:203], v[36:39], v[144:147], 0
    v_mfma_f32_16x16x32_bf16 v[204:207], v[36:39], v[152:155], 0
    v_mfma_f32_16x16x32_bf16 v[208:211], v[40:43], v[144:147], 0
    v_mfma_f32_16x16x32_bf16 v[212:215], v[40:43], v[152:155], 0
    v_mfma_f32_16x16x32_bf16 v[216:219], v[44:47], v[144:147], 0
    v_mfma_f32_16x16x32_bf16 v[220:223], v[44:47], v[152:155], 0
    v_mfma_f32_16x16x32_bf16 v[160:163], v[80:83], v[148:151], v[160:163]
    v_mfma_f32_16x16x32_bf16 v[164:167], v[80:83], v[156:159], v[164:167]
    v_mfma_f32_16x16x32_bf16 v[168:171], v[84:87], v[148:151], v[168:171]
    v_mfma_f32_16x16x32_bf16 v[172:175], v[84:87], v[156:159], v[172:175]
    v_mfma_f32_16x16x32_bf16 v[176:179], v[88:91], v[148:151], v[176:179]
    v_mfma_f32_16x16x32_bf16 v[180:183], v[88:91], v[156:159], v[180:183]
    v_mfma_f32_16x16x32_bf16 v[184:187], v[92:95], v[148:151], v[184:187]
    v_mfma_f32_16x16x32_bf16 v[188:191], v[92:95], v[156:159], v[188:191]
    v_mfma_f32_16x16x32_bf16 v[192:195], v[96:99], v[148:151], v[192:195]
    v_mfma_f32_16x16x32_bf16 v[196:199], v[96:99], v[156:159], v[196:199]
    v_mfma_f32_16x16x32_bf16 v[200:203], v[100:103], v[148:151], v[200:203]
    v_mfma_f32_16x16x32_bf16 v[204:207], v[100:103], v[156:159], v[204:207]
    v_mfma_f32_16x16x32_bf16 v[208:211], v[104:107], v[148:151], v[208:211]
    v_mfma_f32_16x16x32_bf16 v[212:215], v[104:107], v[156:159], v[212:215]
    v_mfma_f32_16x16x32_bf16 v[216:219], v[108:111], v[148:151], v[216:219]
    v_mfma_f32_16x16x32_bf16 v[220:223], v[108:111], v[156:159], v[220:223]
    s_nop 7
    s_nop 1
    v_cvt_pk_bf16_f32 v224, v160, v161
    v_cvt_pk_bf16_f32 v225, v162, v163
    buffer_store_dwordx2 v[224:225], v3, s[24:27], s34 offen offset:0
    v_cvt_pk_bf16_f32 v226, v164, v165
    v_cvt_pk_bf16_f32 v227, v166, v167
    buffer_store_dwordx2 v[226:227], v3, s[24:27], s35 offen offset:0
    v_cvt_pk_bf16_f32 v228, v176, v177
    v_cvt_pk_bf16_f32 v229, v178, v179
    buffer_store_dwordx2 v[228:229], v3, s[24:27], s34 offen offset:48
    v_cvt_pk_bf16_f32 v230, v180, v181
    v_cvt_pk_bf16_f32 v231, v182, v183
    buffer_store_dwordx2 v[230:231], v3, s[24:27], s35 offen offset:48
    v_cvt_pk_bf16_f32 v232, v192, v193
    v_cvt_pk_bf16_f32 v233, v194, v195
    buffer_store_dwordx2 v[232:233], v3, s[24:27], s34 offen offset:96
    v_cvt_pk_bf16_f32 v234, v196, v197
    v_cvt_pk_bf16_f32 v235, v198, v199
    buffer_store_dwordx2 v[234:235], v3, s[24:27], s35 offen offset:96
    v_cvt_pk_bf16_f32 v236, v208, v209
    v_cvt_pk_bf16_f32 v237, v210, v211
    buffer_store_dwordx2 v[236:237], v3, s[24:27], s34 offen offset:144
    v_cvt_pk_bf16_f32 v238, v212, v213
    v_cvt_pk_bf16_f32 v239, v214, v215
    buffer_store_dwordx2 v[238:239], v3, s[24:27], s35 offen offset:144
    s_mov_b32 exec_lo, 0xffffffff
    s_mov_b32 exec_hi, 0x0
    v_cvt_pk_bf16_f32 v224, v168, v169
    v_cvt_pk_bf16_f32 v225, v170, v171
    buffer_store_dwordx2 v[224:225], v3, s[24:27], s34 offen offset:32
    v_cvt_pk_bf16_f32 v226, v172, v173
    v_cvt_pk_bf16_f32 v227, v174, v175
    buffer_store_dwordx2 v[226:227], v3, s[24:27], s35 offen offset:32
    v_cvt_pk_bf16_f32 v228, v184, v185
    v_cvt_pk_bf16_f32 v229, v186, v187
    buffer_store_dwordx2 v[228:229], v3, s[24:27], s34 offen offset:80
    v_cvt_pk_bf16_f32 v230, v188, v189
    v_cvt_pk_bf16_f32 v231, v190, v191
    buffer_store_dwordx2 v[230:231], v3, s[24:27], s35 offen offset:80
    v_cvt_pk_bf16_f32 v232, v200, v201
    v_cvt_pk_bf16_f32 v233, v202, v203
    buffer_store_dwordx2 v[232:233], v3, s[24:27], s34 offen offset:128
    v_cvt_pk_bf16_f32 v234, v204, v205
    v_cvt_pk_bf16_f32 v235, v206, v207
    buffer_store_dwordx2 v[234:235], v3, s[24:27], s35 offen offset:128
    v_cvt_pk_bf16_f32 v236, v216, v217
    v_cvt_pk_bf16_f32 v237, v218, v219
    buffer_store_dwordx2 v[236:237], v3, s[24:27], s34 offen offset:176
    v_cvt_pk_bf16_f32 v238, v220, v221
    v_cvt_pk_bf16_f32 v239, v222, v223
    buffer_store_dwordx2 v[238:239], v3, s[24:27], s35 offen offset:176
    s_mov_b64 exec, -1
    s_nop 3
    v_mfma_f32_16x16x32_bf16 v[160:163], v[48:51], v[144:147], 0
    v_mfma_f32_16x16x32_bf16 v[164:167], v[48:51], v[152:155], 0
    v_mfma_f32_16x16x32_bf16 v[168:171], v[52:55], v[144:147], 0
    v_mfma_f32_16x16x32_bf16 v[172:175], v[52:55], v[152:155], 0
    v_mfma_f32_16x16x32_bf16 v[176:179], v[56:59], v[144:147], 0
    v_mfma_f32_16x16x32_bf16 v[180:183], v[56:59], v[152:155], 0
    v_mfma_f32_16x16x32_bf16 v[184:187], v[60:63], v[144:147], 0
    v_mfma_f32_16x16x32_bf16 v[188:191], v[60:63], v[152:155], 0
    v_mfma_f32_16x16x32_bf16 v[192:195], v[64:67], v[144:147], 0
    v_mfma_f32_16x16x32_bf16 v[196:199], v[64:67], v[152:155], 0
    v_mfma_f32_16x16x32_bf16 v[200:203], v[68:71], v[144:147], 0
    v_mfma_f32_16x16x32_bf16 v[204:207], v[68:71], v[152:155], 0
    v_mfma_f32_16x16x32_bf16 v[208:211], v[72:75], v[144:147], 0
    v_mfma_f32_16x16x32_bf16 v[212:215], v[72:75], v[152:155], 0
    v_mfma_f32_16x16x32_bf16 v[216:219], v[76:79], v[144:147], 0
    v_mfma_f32_16x16x32_bf16 v[220:223], v[76:79], v[152:155], 0
    v_mfma_f32_16x16x32_bf16 v[160:163], v[112:115], v[148:151], v[160:163]
    v_mfma_f32_16x16x32_bf16 v[164:167], v[112:115], v[156:159], v[164:167]
    v_mfma_f32_16x16x32_bf16 v[168:171], v[116:119], v[148:151], v[168:171]
    v_mfma_f32_16x16x32_bf16 v[172:175], v[116:119], v[156:159], v[172:175]
    v_mfma_f32_16x16x32_bf16 v[176:179], v[120:123], v[148:151], v[176:179]
    v_mfma_f32_16x16x32_bf16 v[180:183], v[120:123], v[156:159], v[180:183]
    v_mfma_f32_16x16x32_bf16 v[184:187], v[124:127], v[148:151], v[184:187]
    v_mfma_f32_16x16x32_bf16 v[188:191], v[124:127], v[156:159], v[188:191]
    v_mfma_f32_16x16x32_bf16 v[192:195], v[128:131], v[148:151], v[192:195]
    v_mfma_f32_16x16x32_bf16 v[196:199], v[128:131], v[156:159], v[196:199]
    v_mfma_f32_16x16x32_bf16 v[200:203], v[132:135], v[148:151], v[200:203]
    v_mfma_f32_16x16x32_bf16 v[204:207], v[132:135], v[156:159], v[204:207]
    v_mfma_f32_16x16x32_bf16 v[208:211], v[136:139], v[148:151], v[208:211]
    v_mfma_f32_16x16x32_bf16 v[212:215], v[136:139], v[156:159], v[212:215]
    v_mfma_f32_16x16x32_bf16 v[216:219], v[140:143], v[148:151], v[216:219]
    v_mfma_f32_16x16x32_bf16 v[220:223], v[140:143], v[156:159], v[220:223]
    s_nop 7
    s_nop 1
    v_cvt_pk_bf16_f32 v224, v160, v161
    v_cvt_pk_bf16_f32 v225, v162, v163
    buffer_store_dwordx2 v[224:225], v3, s[24:27], s34 offen offset:192
    v_cvt_pk_bf16_f32 v226, v164, v165
    v_cvt_pk_bf16_f32 v227, v166, v167
    buffer_store_dwordx2 v[226:227], v3, s[24:27], s35 offen offset:192
    v_cvt_pk_bf16_f32 v228, v176, v177
    v_cvt_pk_bf16_f32 v229, v178, v179
    buffer_store_dwordx2 v[228:229], v3, s[24:27], s34 offen offset:240
    v_cvt_pk_bf16_f32 v230, v180, v181
    v_cvt_pk_bf16_f32 v231, v182, v183
    buffer_store_dwordx2 v[230:231], v3, s[24:27], s35 offen offset:240
    v_cvt_pk_bf16_f32 v232, v192, v193
    v_cvt_pk_bf16_f32 v233, v194, v195
    buffer_store_dwordx2 v[232:233], v3, s[24:27], s34 offen offset:288
    v_cvt_pk_bf16_f32 v234, v196, v197
    v_cvt_pk_bf16_f32 v235, v198, v199
    buffer_store_dwordx2 v[234:235], v3, s[24:27], s35 offen offset:288
    v_cvt_pk_bf16_f32 v236, v208, v209
    v_cvt_pk_bf16_f32 v237, v210, v211
    buffer_store_dwordx2 v[236:237], v3, s[24:27], s34 offen offset:336
    v_cvt_pk_bf16_f32 v238, v212, v213
    v_cvt_pk_bf16_f32 v239, v214, v215
    buffer_store_dwordx2 v[238:239], v3, s[24:27], s35 offen offset:336
    s_mov_b32 exec_lo, 0xffffffff
    s_mov_b32 exec_hi, 0x0
    v_cvt_pk_bf16_f32 v224, v168, v169
    v_cvt_pk_bf16_f32 v225, v170, v171
    buffer_store_dwordx2 v[224:225], v3, s[24:27], s34 offen offset:224
    v_cvt_pk_bf16_f32 v226, v172, v173
    v_cvt_pk_bf16_f32 v227, v174, v175
    buffer_store_dwordx2 v[226:227], v3, s[24:27], s35 offen offset:224
    v_cvt_pk_bf16_f32 v228, v184, v185
    v_cvt_pk_bf16_f32 v229, v186, v187
    buffer_store_dwordx2 v[228:229], v3, s[24:27], s34 offen offset:272
    v_cvt_pk_bf16_f32 v230, v188, v189
    v_cvt_pk_bf16_f32 v231, v190, v191
    buffer_store_dwordx2 v[230:231], v3, s[24:27], s35 offen offset:272
    v_cvt_pk_bf16_f32 v232, v200, v201
    v_cvt_pk_bf16_f32 v233, v202, v203
    buffer_store_dwordx2 v[232:233], v3, s[24:27], s34 offen offset:320
    v_cvt_pk_bf16_f32 v234, v204, v205
    v_cvt_pk_bf16_f32 v235, v206, v207
    buffer_store_dwordx2 v[234:235], v3, s[24:27], s35 offen offset:320
    v_cvt_pk_bf16_f32 v236, v216, v217
    v_cvt_pk_bf16_f32 v237, v218, v219
    buffer_store_dwordx2 v[236:237], v3, s[24:27], s34 offen offset:368
    v_cvt_pk_bf16_f32 v238, v220, v221
    v_cvt_pk_bf16_f32 v239, v222, v223
    buffer_store_dwordx2 v[238:239], v3, s[24:27], s35 offen offset:368
    s_mov_b64 exec, -1
    s_nop 3
p3_end:
    s_endpgm
.section .rodata,"a"
.p2align 6
.amdhsa_kernel p3_kernel
  .amdhsa_next_free_vgpr 240
  .amdhsa_next_free_sgpr 102
  .amdhsa_accum_offset 240
  .amdhsa_group_segment_fixed_size 0
  .amdhsa_kernarg_size 112
  .amdhsa_user_sgpr_count 2
  .amdhsa_user_sgpr_kernarg_segment_ptr 1
  .amdhsa_system_sgpr_workgroup_id_x 1
  .amdhsa_float_denorm_mode_32 3
.end_amdhsa_kernel
.text
.globl p4_kernel
.p2align 8
.type p4_kernel,@function
p4_kernel:
    s_load_dwordx2 s[4:5], s[0:1], 104
    s_cmp_ge_u32 s2, 240
    s_cbranch_scc1 p4_end
    s_and_b32 s20, s2, 15
    s_lshr_b32 s24, s2, 4
    s_mul_i32 s25, s24, 0x3334
    s_lshr_b32 s25, s25, 16
    s_mul_i32 s21, s25, 5
    s_sub_u32 s21, s24, s21
    s_mul_i32 s22, s25, 4096
    s_mov_b32 s40, s25
    s_waitcnt lgkmcnt(0)
    s_add_u32 s8, s4, 0x9e20000
    s_addc_u32 s9, s5, 0
    s_and_b32 s9, s9, 0xffff
    s_mov_b32 s10, 0x1800000
    s_mov_b32 s11, 0x20000
    s_add_u32 s12, s4, 0x1900000
    s_addc_u32 s13, s5, 0
    s_and_b32 s13, s13, 0xffff
    s_mov_b32 s14, 0x780000
    s_mov_b32 s15, 0x20000
    s_add_u32 s16, s4, 0xb620000
    s_addc_u32 s17, s5, 0
    s_and_b32 s17, s17, 0xffff
    s_mov_b32 s18, 0x1400000
    s_mov_b32 s19, 0x20000
    v_and_b32 v1, 63, v0
    v_lshrrev_b32 v8, 6, v0
    s_nop 0
    v_readfirstlane_b32 s23, v8
    v_lshrrev_b32 v8, 3, v1
    v_and_b32 v9, 7, v1
    v_xor_b32 v9, v9, v8
    v_lshlrev_b32 v9, 4, v9
    s_mov_b32 s24, 12288
    v_mul_lo_u32 v2, v8, s24
    v_add_u32 v2, v2, v9
    s_mov_b32 s24, 12288
    v_mul_lo_u32 v3, v8, s24
    v_add_u32 v3, v3, v9
    s_mul_i32 s24, s20, 128
    s_mul_i32 s25, s23, 32
    s_add_u32 s24, s24, s25
    s_mul_i32 s24, s24, 12288
    s_mul_i32 s41, s23, 4096
    s_lshl_b32 s25, s23, 5
    s_add_u32 s30, s24, s22
    s_add_u32 s31, s30, 98304
    s_add_u32 s32, s30, 196608
    s_add_u32 s33, s30, 294912
    s_lshl_b32 s24, s21, 7
    s_add_u32 s24, s24, s25
    s_mul_i32 s24, s24, 12288
    s_add_u32 s34, s24, s22
    s_add_u32 s35, s34, 98304
    s_add_u32 s36, s34, 196608
    s_add_u32 s37, s34, 294912
    s_lshl_b32 s38, s23, 12
    v_and_b32 v8, 15, v1
    v_lshrrev_b32 v9, 4, v1
    v_and_b32 v10, 7, v8
    v_xor_b32 v10, v10, v9
    v_lshlrev_b32 v10, 4, v10
    v_lshl_add_u32 v10, v8, 7, v10
    s_lshr_b32 s26, s23, 1
    s_and_b32 s27, s23, 1
    s_mul_i32 s24, s26, 8192
    v_add_u32 v4, s24, v10
    v_xor_b32 v5, 64, v4
    s_lshl_b32 s24, s27, 13
    v_add_u32 v6, s24, v10
    v_xor_b32 v7, 64, v6
    v_add_u32 v12, 0x10000, v4
    v_add_u32 v13, 0x10000, v5
    v_add_u32 v14, 0x10000, v6
    v_add_u32 v15, 0x10000, v7
    v_mov_b32 v96, 0
    v_mov_b32 v97, 0
    v_mov_b32 v98, 0
    v_mov_b32 v99, 0
    v_mov_b32 v100, 0
    v_mov_b32 v101, 0
    v_mov_b32 v102, 0
    v_mov_b32 v103, 0
    v_mov_b32 v104, 0
    v_mov_b32 v105, 0
    v_mov_b32 v106, 0
    v_mov_b32 v107, 0
    v_mov_b32 v108, 0
    v_mov_b32 v109, 0
    v_mov_b32 v110, 0
    v_mov_b32 v111, 0
    v_mov_b32 v112, 0
    v_mov_b32 v113, 0
    v_mov_b32 v114, 0
    v_mov_b32 v115, 0
    v_mov_b32 v116, 0
    v_mov_b32 v117, 0
    v_mov_b32 v118, 0
    v_mov_b32 v119, 0
    v_mov_b32 v120, 0
    v_mov_b32 v121, 0
    v_mov_b32 v122, 0
    v_mov_b32 v123, 0
    v_mov_b32 v124, 0
    v_mov_b32 v125, 0
    v_mov_b32 v126, 0
    v_mov_b32 v127, 0
    v_mov_b32 v128, 0
    v_mov_b32 v129, 0
    v_mov_b32 v130, 0
    v_mov_b32 v131, 0
    v_mov_b32 v132, 0
    v_mov_b32 v133, 0
    v_mov_b32 v134, 0
    v_mov_b32 v135, 0
    v_mov_b32 v136, 0
    v_mov_b32 v137, 0
    v_mov_b32 v138, 0
    v_mov_b32 v139, 0
    v_mov_b32 v140, 0
    v_mov_b32 v141, 0
    v_mov_b32 v142, 0
    v_mov_b32 v143, 0
    v_mov_b32 v144, 0
    v_mov_b32 v145, 0
    v_mov_b32 v146, 0
    v_mov_b32 v147, 0
    v_mov_b32 v148, 0
    v_mov_b32 v149, 0
    v_mov_b32 v150, 0
    v_mov_b32 v151, 0
    v_mov_b32 v152, 0
    v_mov_b32 v153, 0
    v_mov_b32 v154, 0
    v_mov_b32 v155, 0
    v_mov_b32 v156, 0
    v_mov_b32 v157, 0
    v_mov_b32 v158, 0
    v_mov_b32 v159, 0
    s_add_u32 m0, s41, 0
    s_nop 0
    buffer_load_dwordx4 v2, s[8:11], s30 offen lds
    s_add_u32 s30, s30, 128
    s_add_u32 m0, s38, 16384
    s_nop 0
    buffer_load_dwordx4 v3, s[12:15], s34 offen lds
    s_add_u32 s34, s34, 128
    s_add_u32 m0, s41, 1024
    s_nop 0
    buffer_load_dwordx4 v2, s[8:11], s31 offen lds
    s_add_u32 s31, s31, 128
    s_add_u32 m0, s38, 17408
    s_nop 0
    buffer_load_dwordx4 v3, s[12:15], s35 offen lds
    s_add_u32 s35, s35, 128
    s_add_u32 m0, s41, 2048
    s_nop 0
    buffer_load_dwordx4 v2, s[8:11], s32 offen lds
    s_add_u32 s32, s32, 128
    s_add_u32 m0, s38, 18432
    s_nop 0
    buffer_load_dwordx4 v3, s[12:15], s36 offen lds
    s_add_u32 s36, s36, 128
    s_add_u32 m0, s41, 3072
    s_nop 0
    buffer_load_dwordx4 v2, s[8:11], s33 offen lds
    s_add_u32 s33, s33, 128
    s_add_u32 m0, s38, 19456
    s_nop 0
    buffer_load_dwordx4 v3, s[12:15], s37 offen lds
    s_add_u32 s37, s37, 128
    s_add_u32 m0, s41, 32768
    s_nop 0
    buffer_load_dwordx4 v2, s[8:11], s30 offen lds
    s_add_u32 s30, s30, 128
    s_add_u32 m0, s38, 49152
    s_nop 0
    buffer_load_dwordx4 v3, s[12:15], s34 offen lds
    s_add_u32 s34, s34, 128
    s_add_u32 m0, s41, 33792
    s_nop 0
    buffer_load_dwordx4 v2, s[8:11], s31 offen lds
    s_add_u32 s31, s31, 128
    s_add_u32 m0, s38, 50176
    s_nop 0
    buffer_load_dwordx4 v3, s[12:15], s35 offen lds
    s_add_u32 s35, s35, 128
    s_add_u32 m0, s41, 34816
    s_nop 0
    buffer_load_dwordx4 v2, s[8:11], s32 offen lds
    s_add_u32 s32, s32, 128
    s_add_u32 m0, s38, 51200
    s_nop 0
    buffer_load_dwordx4 v3, s[12:15], s36 offen lds
    s_add_u32 s36, s36, 128
    s_add_u32 m0, s41, 35840
    s_nop 0
    buffer_load_dwordx4 v2, s[8:11], s33 offen lds
    s_add_u32 s33, s33, 128
    s_add_u32 m0, s38, 52224
    s_nop 0
    buffer_load_dwordx4 v3, s[12:15], s37 offen lds
    s_add_u32 s37, s37, 128
    s_add_u32 m0, s41, 65536
    s_nop 0
    buffer_load_dwordx4 v2, s[8:11], s30 offen lds
    s_add_u32 s30, s30, 128
    s_add_u32 m0, s38, 81920
    s_nop 0
    buffer_load_dwordx4 v3, s[12:15], s34 offen lds
    s_add_u32 s34, s34, 128
    s_add_u32 m0, s41, 66560
    s_nop 0
    buffer_load_dwordx4 v2, s[8:11], s31 offen lds
    s_add_u32 s31, s31, 128
    s_add_u32 m0, s38, 82944
    s_nop 0
    buffer_load_dwordx4 v3, s[12:15], s35 offen lds
    s_add_u32 s35, s35, 128
    s_add_u32 m0, s41, 67584
    s_nop 0
    buffer_load_dwordx4 v2, s[8:11], s32 offen lds
    s_add_u32 s32, s32, 128
    s_add_u32 m0, s38, 83968
    s_nop 0
    buffer_load_dwordx4 v3, s[12:15], s36 offen lds
    s_add_u32 s36, s36, 128
    s_add_u32 m0, s41, 68608
    s_nop 0
    buffer_load_dwordx4 v2, s[8:11], s33 offen lds
    s_add_u32 s33, s33, 128
    s_add_u32 m0, s38, 84992
    s_nop 0
    buffer_load_dwordx4 v3, s[12:15], s37 offen lds
    s_add_u32 s37, s37, 128
    s_waitcnt vmcnt(16)
    s_barrier
    s_add_u32 m0, s41, 98304
    s_nop 0
    buffer_load_dwordx4 v2, s[8:11], s30 offen lds
    s_add_u32 s30, s30, 128
    s_add_u32 m0, s38, 114688
    s_nop 0
    buffer_load_dwordx4 v3, s[12:15], s34 offen lds
    s_add_u32 s34, s34, 128
    s_add_u32 m0, s41, 99328
    s_nop 0
    buffer_load_dwordx4 v2, s[8:11], s31 offen lds
    s_add_u32 s31, s31, 128
    s_add_u32 m0, s38, 115712
    s_nop 0
    buffer_load_dwordx4 v3, s[12:15], s35 offen lds
    s_add_u32 s35, s35, 128
    s_add_u32 m0, s41, 100352
    s_nop 0
    buffer_load_dwordx4 v2, s[8:11], s32 offen lds
    s_add_u32 s32, s32, 128
    s_add_u32 m0, s38, 116736
    s_nop 0
    buffer_load_dwordx4 v3, s[12:15], s36 offen lds
    s_add_u32 s36, s36, 128
    s_add_u32 m0, s41, 101376
    s_nop 0
    buffer_load_dwordx4 v2, s[8:11], s33 offen lds
    s_add_u32 s33, s33, 128
    s_add_u32 m0, s38, 117760
    s_nop 0
    buffer_load_dwordx4 v3, s[12:15], s37 offen lds
    s_add_u32 s37, s37, 128
    ds_read_b128 v[16:19], v4 offset:0
    ds_read_b128 v[20:23], v4 offset:2048
    ds_read_b128 v[24:27], v4 offset:4096
    ds_read_b128 v[28:31], v4 offset:6144
    ds_read_b128 v[32:35], v6 offset:16384
    ds_read_b128 v[36:39], v6 offset:18432
    ds_read_b128 v[40:43], v6 offset:20480
    ds_read_b128 v[44:47], v6 offset:22528
    ds_read_b128 v[48:51], v5 offset:0
    ds_read_b128 v[52:55], v5 offset:2048
    ds_read_b128 v[56:59], v5 offset:4096
    ds_read_b128 v[60:63], v5 offset:6144
    s_waitcnt lgkmcnt(4)
    v_mfma_f32_16x16x32_bf16 v[96:99], v[32:35], v[16:19], v[96:99]
    v_mfma_f32_16x16x32_bf16 v[100:103], v[36:39], v[16:19], v[100:103]
    v_mfma_f32_16x16x32_bf16 v[104:107], v[40:43], v[16:19], v[104:107]
    v_mfma_f32_16x16x32_bf16 v[108:111], v[44:47], v[16:19], v[108:111]
    ds_read_b128 v[64:67], v7 offset:16384
    ds_read_b128 v[68:71], v7 offset:18432
    ds_read_b128 v[72:75], v7 offset:20480
    ds_read_b128 v[76:79], v7 offset:22528
    v_mfma_f32_16x16x32_bf16 v[112:115], v[32:35], v[20:23], v[112:115]
    v_mfma_f32_16x16x32_bf16 v[116:119], v[36:39], v[20:23], v[116:119]
    v_mfma_f32_16x16x32_bf16 v[120:123], v[40:43], v[20:23], v[120:123]
    v_mfma_f32_16x16x32_bf16 v[124:127], v[44:47], v[20:23], v[124:127]
    v_mfma_f32_16x16x32_bf16 v[128:131], v[32:35], v[24:27], v[128:131]
    v_mfma_f32_16x16x32_bf16 v[132:135], v[36:39], v[24:27], v[132:135]
    v_mfma_f32_16x16x32_bf16 v[136:139], v[40:43], v[24:27], v[136:139]
    v_mfma_f32_16x16x32_bf16 v[140:143], v[44:47], v[24:27], v[140:143]
    v_mfma_f32_16x16x32_bf16 v[144:147], v[32:35], v[28:31], v[144:147]
    v_mfma_f32_16x16x32_bf16 v[148:151], v[36:39], v[28:31], v[148:151]
    v_mfma_f32_16x16x32_bf16 v[152:155], v[40:43], v[28:31], v[152:155]
    v_mfma_f32_16x16x32_bf16 v[156:159], v[44:47], v[28:31], v[156:159]
    s_waitcnt lgkmcnt(0)
    v_mfma_f32_16x16x32_bf16 v[96:99], v[64:67], v[48:51], v[96:99]
    v_mfma_f32_16x16x32_bf16 v[100:103], v[68:71], v[48:51], v[100:103]
    v_mfma_f32_16x16x32_bf16 v[104:107], v[72:75], v[48:51], v[104:107]
    v_mfma_f32_16x16x32_bf16 v[108:111], v[76:79], v[48:51], v[108:111]
    v_mfma_f32_16x16x32_bf16 v[112:115], v[64:67], v[52:55], v[112:115]
    v_mfma_f32_16x16x32_bf16 v[116:119], v[68:71], v[52:55], v[116:119]
    v_mfma_f32_16x16x32_bf16 v[120:123], v[72:75], v[52:55], v[120:123]
    v_mfma_f32_16x16x32_bf16 v[124:127], v[76:79], v[52:55], v[124:127]
    v_mfma_f32_16x16x32_bf16 v[128:131], v[64:67], v[56:59], v[128:131]
    v_mfma_f32_16x16x32_bf16 v[132:135], v[68:71], v[56:59], v[132:135]
    v_mfma_f32_16x16x32_bf16 v[136:139], v[72:75], v[56:59], v[136:139]
    v_mfma_f32_16x16x32_bf16 v[140:143], v[76:79], v[56:59], v[140:143]
    v_mfma_f32_16x16x32_bf16 v[144:147], v[64:67], v[60:63], v[144:147]
    v_mfma_f32_16x16x32_bf16 v[148:151], v[68:71], v[60:63], v[148:151]
    v_mfma_f32_16x16x32_bf16 v[152:155], v[72:75], v[60:63], v[152:155]
    v_mfma_f32_16x16x32_bf16 v[156:159], v[76:79], v[60:63], v[156:159]
    s_waitcnt vmcnt(16)
    s_barrier
    s_add_u32 m0, s41, 0
    s_nop 0
    buffer_load_dwordx4 v2, s[8:11], s30 offen lds
    s_add_u32 s30, s30, 128
    s_add_u32 m0, s38, 16384
    s_nop 0
    buffer_load_dwordx4 v3, s[12:15], s34 offen lds
    s_add_u32 s34, s34, 128
    s_add_u32 m0, s41, 1024
    s_nop 0
    buffer_load_dwordx4 v2, s[8:11], s31 offen lds
    s_add_u32 s31, s31, 128
    s_add_u32 m0, s38, 17408
    s_nop 0
    buffer_load_dwordx4 v3, s[12:15], s35 offen lds
    s_add_u32 s35, s35, 128
    s_add_u32 m0, s41, 2048
    s_nop 0
    buffer_load_dwordx4 v2, s[8:11], s32 offen lds
    s_add_u32 s32, s32, 128
    s_add_u32 m0, s38, 18432
    s_nop 0
    buffer_load_dwordx4 v3, s[12:15], s36 offen lds
    s_add_u32 s36, s36, 128
    s_add_u32 m0, s41, 3072
    s_nop 0
    buffer_load_dwordx4 v2, s[8:11], s33 offen lds
    s_add_u32 s33, s33, 128
    s_add_u32 m0, s38, 19456
    s_nop 0
    buffer_load_dwordx4 v3, s[12:15], s37 offen lds
    s_add_u32 s37, s37, 128
    ds_read_b128 v[16:19], v4 offset:32768
    ds_read_b128 v[20:23], v4 offset:34816
    ds_read_b128 v[24:27], v4 offset:36864
    ds_read_b128 v[28:31], v4 offset:38912
    ds_read_b128 v[32:35], v6 offset:49152
    ds_read_b128 v[36:39], v6 offset:51200
    ds_read_b128 v[40:43], v6 offset:53248
    ds_read_b128 v[44:47], v6 offset:55296
    ds_read_b128 v[48:51], v5 offset:32768
    ds_read_b128 v[52:55], v5 offset:34816
    ds_read_b128 v[56:59], v5 offset:36864
    ds_read_b128 v[60:63], v5 offset:38912
    s_waitcnt lgkmcnt(4)
    v_mfma_f32_16x16x32_bf16 v[96:99], v[32:35], v[16:19], v[96:99]
    v_mfma_f32_16x16x32_bf16 v[100:103], v[36:39], v[16:19], v[100:103]
    v_mfma_f32_16x16x32_bf16 v[104:107], v[40:43], v[16:19], v[104:107]
    v_mfma_f32_16x16x32_bf16 v[108:111], v[44:47], v[16:19], v[108:111]
    ds_read_b128 v[64:67], v7 offset:49152
    ds_read_b128 v[68:71], v7 offset:51200
    ds_read_b128 v[72:75], v7 offset:53248
    ds_read_b128 v[76:79], v7 offset:55296
    v_mfma_f32_16x16x32_bf16 v[112:115], v[32:35], v[20:23], v[112:115]
    v_mfma_f32_16x16x32_bf16 v[116:119], v[36:39], v[20:23], v[116:119]
    v_mfma_f32_16x16x32_bf16 v[120:123], v[40:43], v[20:23], v[120:123]
    v_mfma_f32_16x16x32_bf16 v[124:127], v[44:47], v[20:23], v[124:127]
    v_mfma_f32_16x16x32_bf16 v[128:131], v[32:35], v[24:27], v[128:131]
    v_mfma_f32_16x16x32_bf16 v[132:135], v[36:39], v[24:27], v[132:135]
    v_mfma_f32_16x16x32_bf16 v[136:139], v[40:43], v[24:27], v[136:139]
    v_mfma_f32_16x16x32_bf16 v[140:143], v[44:47], v[24:27], v[140:143]
    v_mfma_f32_16x16x32_bf16 v[144:147], v[32:35], v[28:31], v[144:147]
    v_mfma_f32_16x16x32_bf16 v[148:151], v[36:39], v[28:31], v[148:151]
    v_mfma_f32_16x16x32_bf16 v[152:155], v[40:43], v[28:31], v[152:155]
    v_mfma_f32_16x16x32_bf16 v[156:159], v[44:47], v[28:31], v[156:159]
    s_waitcnt lgkmcnt(0)
    v_mfma_f32_16x16x32_bf16 v[96:99], v[64:67], v[48:51], v[96:99]
    v_mfma_f32_16x16x32_bf16 v[100:103], v[68:71], v[48:51], v[100:103]
    v_mfma_f32_16x16x32_bf16 v[104:107], v[72:75], v[48:51], v[104:107]
    v_mfma_f32_16x16x32_bf16 v[108:111], v[76:79], v[48:51], v[108:111]
    v_mfma_f32_16x16x32_bf16 v[112:115], v[64:67], v[52:55], v[112:115]
    v_mfma_f32_16x16x32_bf16 v[116:119], v[68:71], v[52:55], v[116:119]
    v_mfma_f32_16x16x32_bf16 v[120:123], v[72:75], v[52:55], v[120:123]
    v_mfma_f32_16x16x32_bf16 v[124:127], v[76:79], v[52:55], v[124:127]
    v_mfma_f32_16x16x32_bf16 v[128:131], v[64:67], v[56:59], v[128:131]
    v_mfma_f32_16x16x32_bf16 v[132:135], v[68:71], v[56:59], v[132:135]
    v_mfma_f32_16x16x32_bf16 v[136:139], v[72:75], v[56:59], v[136:139]
    v_mfma_f32_16x16x32_bf16 v[140:143], v[76:79], v[56:59], v[140:143]
    v_mfma_f32_16x16x32_bf16 v[144:147], v[64:67], v[60:63], v[144:147]
    v_mfma_f32_16x16x32_bf16 v[148:151], v[68:71], v[60:63], v[148:151]
    v_mfma_f32_16x16x32_bf16 v[152:155], v[72:75], v[60:63], v[152:155]
    v_mfma_f32_16x16x32_bf16 v[156:159], v[76:79], v[60:63], v[156:159]
    s_waitcnt vmcnt(16)
    s_barrier
    s_add_u32 m0, s41, 32768
    s_nop 0
    buffer_load_dwordx4 v2, s[8:11], s30 offen lds
    s_add_u32 s30, s30, 128
    s_add_u32 m0, s38, 49152
    s_nop 0
    buffer_load_dwordx4 v3, s[12:15], s34 offen lds
    s_add_u32 s34, s34, 128
    s_add_u32 m0, s41, 33792
    s_nop 0
    buffer_load_dwordx4 v2, s[8:11], s31 offen lds
    s_add_u32 s31, s31, 128
    s_add_u32 m0, s38, 50176
    s_nop 0
    buffer_load_dwordx4 v3, s[12:15], s35 offen lds
    s_add_u32 s35, s35, 128
    s_add_u32 m0, s41, 34816
    s_nop 0
    buffer_load_dwordx4 v2, s[8:11], s32 offen lds
    s_add_u32 s32, s32, 128
    s_add_u32 m0, s38, 51200
    s_nop 0
    buffer_load_dwordx4 v3, s[12:15], s36 offen lds
    s_add_u32 s36, s36, 128
    s_add_u32 m0, s41, 35840
    s_nop 0
    buffer_load_dwordx4 v2, s[8:11], s33 offen lds
    s_add_u32 s33, s33, 128
    s_add_u32 m0, s38, 52224
    s_nop 0
    buffer_load_dwordx4 v3, s[12:15], s37 offen lds
    s_add_u32 s37, s37, 128
    ds_read_b128 v[16:19], v12 offset:0
    ds_read_b128 v[20:23], v12 offset:2048
    ds_read_b128 v[24:27], v12 offset:4096
    ds_read_b128 v[28:31], v12 offset:6144
    ds_read_b128 v[32:35], v14 offset:16384
    ds_read_b128 v[36:39], v14 offset:18432
    ds_read_b128 v[40:43], v14 offset:20480
    ds_read_b128 v[44:47], v14 offset:22528
    ds_read_b128 v[48:51], v13 offset:0
    ds_read_b128 v[52:55], v13 offset:2048
    ds_read_b128 v[56:59], v13 offset:4096
    ds_read_b128 v[60:63], v13 offset:6144
    s_waitcnt lgkmcnt(4)
    v_mfma_f32_16x16x32_bf16 v[96:99], v[32:35], v[16:19], v[96:99]
    v_mfma_f32_16x16x32_bf16 v[100:103], v[36:39], v[16:19], v[100:103]
    v_mfma_f32_16x16x32_bf16 v[104:107], v[40:43], v[16:19], v[104:107]
    v_mfma_f32_16x16x32_bf16 v[108:111], v[44:47], v[16:19], v[108:111]
    ds_read_b128 v[64:67], v15 offset:16384
    ds_read_b128 v[68:71], v15 offset:18432
    ds_read_b128 v[72:75], v15 offset:20480
    ds_read_b128 v[76:79], v15 offset:22528
    v_mfma_f32_16x16x32_bf16 v[112:115], v[32:35], v[20:23], v[112:115]
    v_mfma_f32_16x16x32_bf16 v[116:119], v[36:39], v[20:23], v[116:119]
    v_mfma_f32_16x16x32_bf16 v[120:123], v[40:43], v[20:23], v[120:123]
    v_mfma_f32_16x16x32_bf16 v[124:127], v[44:47], v[20:23], v[124:127]
    v_mfma_f32_16x16x32_bf16 v[128:131], v[32:35], v[24:27], v[128:131]
    v_mfma_f32_16x16x32_bf16 v[132:135], v[36:39], v[24:27], v[132:135]
    v_mfma_f32_16x16x32_bf16 v[136:139], v[40:43], v[24:27], v[136:139]
    v_mfma_f32_16x16x32_bf16 v[140:143], v[44:47], v[24:27], v[140:143]
    v_mfma_f32_16x16x32_bf16 v[144:147], v[32:35], v[28:31], v[144:147]
    v_mfma_f32_16x16x32_bf16 v[148:151], v[36:39], v[28:31], v[148:151]
    v_mfma_f32_16x16x32_bf16 v[152:155], v[40:43], v[28:31], v[152:155]
    v_mfma_f32_16x16x32_bf16 v[156:159], v[44:47], v[28:31], v[156:159]
    s_waitcnt lgkmcnt(0)
    v_mfma_f32_16x16x32_bf16 v[96:99], v[64:67], v[48:51], v[96:99]
    v_mfma_f32_16x16x32_bf16 v[100:103], v[68:71], v[48:51], v[100:103]
    v_mfma_f32_16x16x32_bf16 v[104:107], v[72:75], v[48:51], v[104:107]
    v_mfma_f32_16x16x32_bf16 v[108:111], v[76:79], v[48:51], v[108:111]
    v_mfma_f32_16x16x32_bf16 v[112:115], v[64:67], v[52:55], v[112:115]
    v_mfma_f32_16x16x32_bf16 v[116:119], v[68:71], v[52:55], v[116:119]
    v_mfma_f32_16x16x32_bf16 v[120:123], v[72:75], v[52:55], v[120:123]
    v_mfma_f32_16x16x32_bf16 v[124:127], v[76:79], v[52:55], v[124:127]
    v_mfma_f32_16x16x32_bf16 v[128:131], v[64:67], v[56:59], v[128:131]
    v_mfma_f32_16x16x32_bf16 v[132:135], v[68:71], v[56:59], v[132:135]
    v_mfma_f32_16x16x32_bf16 v[136:139], v[72:75], v[56:59], v[136:139]
    v_mfma_f32_16x16x32_bf16 v[140:143], v[76:79], v[56:59], v[140:143]
    v_mfma_f32_16x16x32_bf16 v[144:147], v[64:67], v[60:63], v[144:147]
    v_mfma_f32_16x16x32_bf16 v[148:151], v[68:71], v[60:63], v[148:151]
    v_mfma_f32_16x16x32_bf16 v[152:155], v[72:75], v[60:63], v[152:155]
    v_mfma_f32_16x16x32_bf16 v[156:159], v[76:79], v[60:63], v[156:159]
    s_waitcnt vmcnt(16)
    s_barrier
    s_add_u32 m0, s41, 65536
    s_nop 0
    buffer_load_dwordx4 v2, s[8:11], s30 offen lds
    s_add_u32 s30, s30, 128
    s_add_u32 m0, s38, 81920
    s_nop 0
    buffer_load_dwordx4 v3, s[12:15], s34 offen lds
    s_add_u32 s34, s34, 128
    s_add_u32 m0, s41, 66560
    s_nop 0
    buffer_load_dwordx4 v2, s[8:11], s31 offen lds
    s_add_u32 s31, s31, 128
    s_add_u32 m0, s38, 82944
    s_nop 0
    buffer_load_dwordx4 v3, s[12:15], s35 offen lds
    s_add_u32 s35, s35, 128
    s_add_u32 m0, s41, 67584
    s_nop 0
    buffer_load_dwordx4 v2, s[8:11], s32 offen lds
    s_add_u32 s32, s32, 128
    s_add_u32 m0, s38, 83968
    s_nop 0
    buffer_load_dwordx4 v3, s[12:15], s36 offen lds
    s_add_u32 s36, s36, 128
    s_add_u32 m0, s41, 68608
    s_nop 0
    buffer_load_dwordx4 v2, s[8:11], s33 offen lds
    s_add_u32 s33, s33, 128
    s_add_u32 m0, s38, 84992
    s_nop 0
    buffer_load_dwordx4 v3, s[12:15], s37 offen lds
    s_add_u32 s37, s37, 128
    ds_read_b128 v[16:19], v12 offset:32768
    ds_read_b128 v[20:23], v12 offset:34816
    ds_read_b128 v[24:27], v12 offset:36864
    ds_read_b128 v[28:31], v12 offset:38912
    ds_read_b128 v[32:35], v14 offset:49152
    ds_read_b128 v[36:39], v14 offset:51200
    ds_read_b128 v[40:43], v14 offset:53248
    ds_read_b128 v[44:47], v14 offset:55296
    ds_read_b128 v[48:51], v13 offset:32768
    ds_read_b128 v[52:55], v13 offset:34816
    ds_read_b128 v[56:59], v13 offset:36864
    ds_read_b128 v[60:63], v13 offset:38912
    s_waitcnt lgkmcnt(4)
    v_mfma_f32_16x16x32_bf16 v[96:99], v[32:35], v[16:19], v[96:99]
    v_mfma_f32_16x16x32_bf16 v[100:103], v[36:39], v[16:19], v[100:103]
    v_mfma_f32_16x16x32_bf16 v[104:107], v[40:43], v[16:19], v[104:107]
    v_mfma_f32_16x16x32_bf16 v[108:111], v[44:47], v[16:19], v[108:111]
    ds_read_b128 v[64:67], v15 offset:49152
    ds_read_b128 v[68:71], v15 offset:51200
    ds_read_b128 v[72:75], v15 offset:53248
    ds_read_b128 v[76:79], v15 offset:55296
    v_mfma_f32_16x16x32_bf16 v[112:115], v[32:35], v[20:23], v[112:115]
    v_mfma_f32_16x16x32_bf16 v[116:119], v[36:39], v[20:23], v[116:119]
    v_mfma_f32_16x16x32_bf16 v[120:123], v[40:43], v[20:23], v[120:123]
    v_mfma_f32_16x16x32_bf16 v[124:127], v[44:47], v[20:23], v[124:127]
    v_mfma_f32_16x16x32_bf16 v[128:131], v[32:35], v[24:27], v[128:131]
    v_mfma_f32_16x16x32_bf16 v[132:135], v[36:39], v[24:27], v[132:135]
    v_mfma_f32_16x16x32_bf16 v[136:139], v[40:43], v[24:27], v[136:139]
    v_mfma_f32_16x16x32_bf16 v[140:143], v[44:47], v[24:27], v[140:143]
    v_mfma_f32_16x16x32_bf16 v[144:147], v[32:35], v[28:31], v[144:147]
    v_mfma_f32_16x16x32_bf16 v[148:151], v[36:39], v[28:31], v[148:151]
    v_mfma_f32_16x16x32_bf16 v[152:155], v[40:43], v[28:31], v[152:155]
    v_mfma_f32_16x16x32_bf16 v[156:159], v[44:47], v[28:31], v[156:159]
    s_waitcnt lgkmcnt(0)
    v_mfma_f32_16x16x32_bf16 v[96:99], v[64:67], v[48:51], v[96:99]
    v_mfma_f32_16x16x32_bf16 v[100:103], v[68:71], v[48:51], v[100:103]
    v_mfma_f32_16x16x32_bf16 v[104:107], v[72:75], v[48:51], v[104:107]
    v_mfma_f32_16x16x32_bf16 v[108:111], v[76:79], v[48:51], v[108:111]
    v_mfma_f32_16x16x32_bf16 v[112:115], v[64:67], v[52:55], v[112:115]
    v_mfma_f32_16x16x32_bf16 v[116:119], v[68:71], v[52:55], v[116:119]
    v_mfma_f32_16x16x32_bf16 v[120:123], v[72:75], v[52:55], v[120:123]
    v_mfma_f32_16x16x32_bf16 v[124:127], v[76:79], v[52:55], v[124:127]
    v_mfma_f32_16x16x32_bf16 v[128:131], v[64:67], v[56:59], v[128:131]
    v_mfma_f32_16x16x32_bf16 v[132:135], v[68:71], v[56:59], v[132:135]
    v_mfma_f32_16x16x32_bf16 v[136:139], v[72:75], v[56:59], v[136:139]
    v_mfma_f32_16x16x32_bf16 v[140:143], v[76:79], v[56:59], v[140:143]
    v_mfma_f32_16x16x32_bf16 v[144:147], v[64:67], v[60:63], v[144:147]
    v_mfma_f32_16x16x32_bf16 v[148:151], v[68:71], v[60:63], v[148:151]
    v_mfma_f32_16x16x32_bf16 v[152:155], v[72:75], v[60:63], v[152:155]
    v_mfma_f32_16x16x32_bf16 v[156:159], v[76:79], v[60:63], v[156:159]
    s_waitcnt vmcnt(16)
    s_barrier
    s_add_u32 m0, s41, 98304
    s_nop 0
    buffer_load_dwordx4 v2, s[8:11], s30 offen lds
    s_add_u32 s30, s30, 128
    s_add_u32 m0, s38, 114688
    s_nop 0
    buffer_load_dwordx4 v3, s[12:15], s34 offen lds
    s_add_u32 s34, s34, 128
    s_add_u32 m0, s41, 99328
    s_nop 0
    buffer_load_dwordx4 v2, s[8:11], s31 offen lds
    s_add_u32 s31, s31, 128
    s_add_u32 m0, s38, 115712
    s_nop 0
    buffer_load_dwordx4 v3, s[12:15], s35 offen lds
    s_add_u32 s35, s35, 128
    s_add_u32 m0, s41, 100352
    s_nop 0
    buffer_load_dwordx4 v2, s[8:11], s32 offen lds
    s_add_u32 s32, s32, 128
    s_add_u32 m0, s38, 116736
    s_nop 0
    buffer_load_dwordx4 v3, s[12:15], s36 offen lds
    s_add_u32 s36, s36, 128
    s_add_u32 m0, s41, 101376
    s_nop 0
    buffer_load_dwordx4 v2, s[8:11], s33 offen lds
    s_add_u32 s33, s33, 128
    s_add_u32 m0, s38, 117760
    s_nop 0
    buffer_load_dwordx4 v3, s[12:15], s37 offen lds
    s_add_u32 s37, s37, 128
    ds_read_b128 v[16:19], v4 offset:0
    ds_read_b128 v[20:23], v4 offset:2048
    ds_read_b128 v[24:27], v4 offset:4096
    ds_read_b128 v[28:31], v4 offset:6144
    ds_read_b128 v[32:35], v6 offset:16384
    ds_read_b128 v[36:39], v6 offset:18432
    ds_read_b128 v[40:43], v6 offset:20480
    ds_read_b128 v[44:47], v6 offset:22528
    ds_read_b128 v[48:51], v5 offset:0
    ds_read_b128 v[52:55], v5 offset:2048
    ds_read_b128 v[56:59], v5 offset:4096
    ds_read_b128 v[60:63], v5 offset:6144
    s_waitcnt lgkmcnt(4)
    v_mfma_f32_16x16x32_bf16 v[96:99], v[32:35], v[16:19], v[96:99]
    v_mfma_f32_16x16x32_bf16 v[100:103], v[36:39], v[16:19], v[100:103]
    v_mfma_f32_16x16x32_bf16 v[104:107], v[40:43], v[16:19], v[104:107]
    v_mfma_f32_16x16x32_bf16 v[108:111], v[44:47], v[16:19], v[108:111]
    ds_read_b128 v[64:67], v7 offset:16384
    ds_read_b128 v[68:71], v7 offset:18432
    ds_read_b128 v[72:75], v7 offset:20480
    ds_read_b128 v[76:79], v7 offset:22528
    v_mfma_f32_16x16x32_bf16 v[112:115], v[32:35], v[20:23], v[112:115]
    v_mfma_f32_16x16x32_bf16 v[116:119], v[36:39], v[20:23], v[116:119]
    v_mfma_f32_16x16x32_bf16 v[120:123], v[40:43], v[20:23], v[120:123]
    v_mfma_f32_16x16x32_bf16 v[124:127], v[44:47], v[20:23], v[124:127]
    v_mfma_f32_16x16x32_bf16 v[128:131], v[32:35], v[24:27], v[128:131]
    v_mfma_f32_16x16x32_bf16 v[132:135], v[36:39], v[24:27], v[132:135]
    v_mfma_f32_16x16x32_bf16 v[136:139], v[40:43], v[24:27], v[136:139]
    v_mfma_f32_16x16x32_bf16 v[140:143], v[44:47], v[24:27], v[140:143]
    v_mfma_f32_16x16x32_bf16 v[144:147], v[32:35], v[28:31], v[144:147]
    v_mfma_f32_16x16x32_bf16 v[148:151], v[36:39], v[28:31], v[148:151]
    v_mfma_f32_16x16x32_bf16 v[152:155], v[40:43], v[28:31], v[152:155]
    v_mfma_f32_16x16x32_bf16 v[156:159], v[44:47], v[28:31], v[156:159]
    s_waitcnt lgkmcnt(0)
    v_mfma_f32_16x16x32_bf16 v[96:99], v[64:67], v[48:51], v[96:99]
    v_mfma_f32_16x16x32_bf16 v[100:103], v[68:71], v[48:51], v[100:103]
    v_mfma_f32_16x16x32_bf16 v[104:107], v[72:75], v[48:51], v[104:107]
    v_mfma_f32_16x16x32_bf16 v[108:111], v[76:79], v[48:51], v[108:111]
    v_mfma_f32_16x16x32_bf16 v[112:115], v[64:67], v[52:55], v[112:115]
    v_mfma_f32_16x16x32_bf16 v[116:119], v[68:71], v[52:55], v[116:119]
    v_mfma_f32_16x16x32_bf16 v[120:123], v[72:75], v[52:55], v[120:123]
    v_mfma_f32_16x16x32_bf16 v[124:127], v[76:79], v[52:55], v[124:127]
    v_mfma_f32_16x16x32_bf16 v[128:131], v[64:67], v[56:59], v[128:131]
    v_mfma_f32_16x16x32_bf16 v[132:135], v[68:71], v[56:59], v[132:135]
    v_mfma_f32_16x16x32_bf16 v[136:139], v[72:75], v[56:59], v[136:139]
    v_mfma_f32_16x16x32_bf16 v[140:143], v[76:79], v[56:59], v[140:143]
    v_mfma_f32_16x16x32_bf16 v[144:147], v[64:67], v[60:63], v[144:147]
    v_mfma_f32_16x16x32_bf16 v[148:151], v[68:71], v[60:63], v[148:151]
    v_mfma_f32_16x16x32_bf16 v[152:155], v[72:75], v[60:63], v[152:155]
    v_mfma_f32_16x16x32_bf16 v[156:159], v[76:79], v[60:63], v[156:159]
    s_waitcnt vmcnt(16)
    s_barrier
    s_add_u32 m0, s41, 0
    s_nop 0
    buffer_load_dwordx4 v2, s[8:11], s30 offen lds
    s_add_u32 s30, s30, 128
    s_add_u32 m0, s38, 16384
    s_nop 0
    buffer_load_dwordx4 v3, s[12:15], s34 offen lds
    s_add_u32 s34, s34, 128
    s_add_u32 m0, s41, 1024
    s_nop 0
    buffer_load_dwordx4 v2, s[8:11], s31 offen lds
    s_add_u32 s31, s31, 128
    s_add_u32 m0, s38, 17408
    s_nop 0
    buffer_load_dwordx4 v3, s[12:15], s35 offen lds
    s_add_u32 s35, s35, 128
    s_add_u32 m0, s41, 2048
    s_nop 0
    buffer_load_dwordx4 v2, s[8:11], s32 offen lds
    s_add_u32 s32, s32, 128
    s_add_u32 m0, s38, 18432
    s_nop 0
    buffer_load_dwordx4 v3, s[12:15], s36 offen lds
    s_add_u32 s36, s36, 128
    s_add_u32 m0, s41, 3072
    s_nop 0
    buffer_load_dwordx4 v2, s[8:11], s33 offen lds
    s_add_u32 s33, s33, 128
    s_add_u32 m0, s38, 19456
    s_nop 0
    buffer_load_dwordx4 v3, s[12:15], s37 offen lds
    s_add_u32 s37, s37, 128
    ds_read_b128 v[16:19], v4 offset:32768
    ds_read_b128 v[20:23], v4 offset:34816
    ds_read_b128 v[24:27], v4 offset:36864
    ds_read_b128 v[28:31], v4 offset:38912
    ds_read_b128 v[32:35], v6 offset:49152
    ds_read_b128 v[36:39], v6 offset:51200
    ds_read_b128 v[40:43], v6 offset:53248
    ds_read_b128 v[44:47], v6 offset:55296
    ds_read_b128 v[48:51], v5 offset:32768
    ds_read_b128 v[52:55], v5 offset:34816
    ds_read_b128 v[56:59], v5 offset:36864
    ds_read_b128 v[60:63], v5 offset:38912
    s_waitcnt lgkmcnt(4)
    v_mfma_f32_16x16x32_bf16 v[96:99], v[32:35], v[16:19], v[96:99]
    v_mfma_f32_16x16x32_bf16 v[100:103], v[36:39], v[16:19], v[100:103]
    v_mfma_f32_16x16x32_bf16 v[104:107], v[40:43], v[16:19], v[104:107]
    v_mfma_f32_16x16x32_bf16 v[108:111], v[44:47], v[16:19], v[108:111]
    ds_read_b128 v[64:67], v7 offset:49152
    ds_read_b128 v[68:71], v7 offset:51200
    ds_read_b128 v[72:75], v7 offset:53248
    ds_read_b128 v[76:79], v7 offset:55296
    v_mfma_f32_16x16x32_bf16 v[112:115], v[32:35], v[20:23], v[112:115]
    v_mfma_f32_16x16x32_bf16 v[116:119], v[36:39], v[20:23], v[116:119]
    v_mfma_f32_16x16x32_bf16 v[120:123], v[40:43], v[20:23], v[120:123]
    v_mfma_f32_16x16x32_bf16 v[124:127], v[44:47], v[20:23], v[124:127]
    v_mfma_f32_16x16x32_bf16 v[128:131], v[32:35], v[24:27], v[128:131]
    v_mfma_f32_16x16x32_bf16 v[132:135], v[36:39], v[24:27], v[132:135]
    v_mfma_f32_16x16x32_bf16 v[136:139], v[40:43], v[24:27], v[136:139]
    v_mfma_f32_16x16x32_bf16 v[140:143], v[44:47], v[24:27], v[140:143]
    v_mfma_f32_16x16x32_bf16 v[144:147], v[32:35], v[28:31], v[144:147]
    v_mfma_f32_16x16x32_bf16 v[148:151], v[36:39], v[28:31], v[148:151]
    v_mfma_f32_16x16x32_bf16 v[152:155], v[40:43], v[28:31], v[152:155]
    v_mfma_f32_16x16x32_bf16 v[156:159], v[44:47], v[28:31], v[156:159]
    s_waitcnt lgkmcnt(0)
    v_mfma_f32_16x16x32_bf16 v[96:99], v[64:67], v[48:51], v[96:99]
    v_mfma_f32_16x16x32_bf16 v[100:103], v[68:71], v[48:51], v[100:103]
    v_mfma_f32_16x16x32_bf16 v[104:107], v[72:75], v[48:51], v[104:107]
    v_mfma_f32_16x16x32_bf16 v[108:111], v[76:79], v[48:51], v[108:111]
    v_mfma_f32_16x16x32_bf16 v[112:115], v[64:67], v[52:55], v[112:115]
    v_mfma_f32_16x16x32_bf16 v[116:119], v[68:71], v[52:55], v[116:119]
    v_mfma_f32_16x16x32_bf16 v[120:123], v[72:75], v[52:55], v[120:123]
    v_mfma_f32_16x16x32_bf16 v[124:127], v[76:79], v[52:55], v[124:127]
    v_mfma_f32_16x16x32_bf16 v[128:131], v[64:67], v[56:59], v[128:131]
    v_mfma_f32_16x16x32_bf16 v[132:135], v[68:71], v[56:59], v[132:135]
    v_mfma_f32_16x16x32_bf16 v[136:139], v[72:75], v[56:59], v[136:139]
    v_mfma_f32_16x16x32_bf16 v[140:143], v[76:79], v[56:59], v[140:143]
    v_mfma_f32_16x16x32_bf16 v[144:147], v[64:67], v[60:63], v[144:147]
    v_mfma_f32_16x16x32_bf16 v[148:151], v[68:71], v[60:63], v[148:151]
    v_mfma_f32_16x16x32_bf16 v[152:155], v[72:75], v[60:63], v[152:155]
    v_mfma_f32_16x16x32_bf16 v[156:159], v[76:79], v[60:63], v[156:159]
    s_waitcnt vmcnt(16)
    s_barrier
    s_add_u32 m0, s41, 32768
    s_nop 0
    buffer_load_dwordx4 v2, s[8:11], s30 offen lds
    s_add_u32 s30, s30, 128
    s_add_u32 m0, s38, 49152
    s_nop 0
    buffer_load_dwordx4 v3, s[12:15], s34 offen lds
    s_add_u32 s34, s34, 128
    s_add_u32 m0, s41, 33792
    s_nop 0
    buffer_load_dwordx4 v2, s[8:11], s31 offen lds
    s_add_u32 s31, s31, 128
    s_add_u32 m0, s38, 50176
    s_nop 0
    buffer_load_dwordx4 v3, s[12:15], s35 offen lds
    s_add_u32 s35, s35, 128
    s_add_u32 m0, s41, 34816
    s_nop 0
    buffer_load_dwordx4 v2, s[8:11], s32 offen lds
    s_add_u32 s32, s32, 128
    s_add_u32 m0, s38, 51200
    s_nop 0
    buffer_load_dwordx4 v3, s[12:15], s36 offen lds
    s_add_u32 s36, s36, 128
    s_add_u32 m0, s41, 35840
    s_nop 0
    buffer_load_dwordx4 v2, s[8:11], s33 offen lds
    s_add_u32 s33, s33, 128
    s_add_u32 m0, s38, 52224
    s_nop 0
    buffer_load_dwordx4 v3, s[12:15], s37 offen lds
    s_add_u32 s37, s37, 128
    ds_read_b128 v[16:19], v12 offset:0
    ds_read_b128 v[20:23], v12 offset:2048
    ds_read_b128 v[24:27], v12 offset:4096
    ds_read_b128 v[28:31], v12 offset:6144
    ds_read_b128 v[32:35], v14 offset:16384
    ds_read_b128 v[36:39], v14 offset:18432
    ds_read_b128 v[40:43], v14 offset:20480
    ds_read_b128 v[44:47], v14 offset:22528
    ds_read_b128 v[48:51], v13 offset:0
    ds_read_b128 v[52:55], v13 offset:2048
    ds_read_b128 v[56:59], v13 offset:4096
    ds_read_b128 v[60:63], v13 offset:6144
    s_waitcnt lgkmcnt(4)
    v_mfma_f32_16x16x32_bf16 v[96:99], v[32:35], v[16:19], v[96:99]
    v_mfma_f32_16x16x32_bf16 v[100:103], v[36:39], v[16:19], v[100:103]
    v_mfma_f32_16x16x32_bf16 v[104:107], v[40:43], v[16:19], v[104:107]
    v_mfma_f32_16x16x32_bf16 v[108:111], v[44:47], v[16:19], v[108:111]
    ds_read_b128 v[64:67], v15 offset:16384
    ds_read_b128 v[68:71], v15 offset:18432
    ds_read_b128 v[72:75], v15 offset:20480
    ds_read_b128 v[76:79], v15 offset:22528
    v_mfma_f32_16x16x32_bf16 v[112:115], v[32:35], v[20:23], v[112:115]
    v_mfma_f32_16x16x32_bf16 v[116:119], v[36:39], v[20:23], v[116:119]
    v_mfma_f32_16x16x32_bf16 v[120:123], v[40:43], v[20:23], v[120:123]
    v_mfma_f32_16x16x32_bf16 v[124:127], v[44:47], v[20:23], v[124:127]
    v_mfma_f32_16x16x32_bf16 v[128:131], v[32:35], v[24:27], v[128:131]
    v_mfma_f32_16x16x32_bf16 v[132:135], v[36:39], v[24:27], v[132:135]
    v_mfma_f32_16x16x32_bf16 v[136:139], v[40:43], v[24:27], v[136:139]
    v_mfma_f32_16x16x32_bf16 v[140:143], v[44:47], v[24:27], v[140:143]
    v_mfma_f32_16x16x32_bf16 v[144:147], v[32:35], v[28:31], v[144:147]
    v_mfma_f32_16x16x32_bf16 v[148:151], v[36:39], v[28:31], v[148:151]
    v_mfma_f32_16x16x32_bf16 v[152:155], v[40:43], v[28:31], v[152:155]
    v_mfma_f32_16x16x32_bf16 v[156:159], v[44:47], v[28:31], v[156:159]
    s_waitcnt lgkmcnt(0)
    v_mfma_f32_16x16x32_bf16 v[96:99], v[64:67], v[48:51], v[96:99]
    v_mfma_f32_16x16x32_bf16 v[100:103], v[68:71], v[48:51], v[100:103]
    v_mfma_f32_16x16x32_bf16 v[104:107], v[72:75], v[48:51], v[104:107]
    v_mfma_f32_16x16x32_bf16 v[108:111], v[76:79], v[48:51], v[108:111]
    v_mfma_f32_16x16x32_bf16 v[112:115], v[64:67], v[52:55], v[112:115]
    v_mfma_f32_16x16x32_bf16 v[116:119], v[68:71], v[52:55], v[116:119]
    v_mfma_f32_16x16x32_bf16 v[120:123], v[72:75], v[52:55], v[120:123]
    v_mfma_f32_16x16x32_bf16 v[124:127], v[76:79], v[52:55], v[124:127]
    v_mfma_f32_16x16x32_bf16 v[128:131], v[64:67], v[56:59], v[128:131]
    v_mfma_f32_16x16x32_bf16 v[132:135], v[68:71], v[56:59], v[132:135]
    v_mfma_f32_16x16x32_bf16 v[136:139], v[72:75], v[56:59], v[136:139]
    v_mfma_f32_16x16x32_bf16 v[140:143], v[76:79], v[56:59], v[140:143]
    v_mfma_f32_16x16x32_bf16 v[144:147], v[64:67], v[60:63], v[144:147]
    v_mfma_f32_16x16x32_bf16 v[148:151], v[68:71], v[60:63], v[148:151]
    v_mfma_f32_16x16x32_bf16 v[152:155], v[72:75], v[60:63], v[152:155]
    v_mfma_f32_16x16x32_bf16 v[156:159], v[76:79], v[60:63], v[156:159]
    s_waitcnt vmcnt(16)
    s_barrier
    s_add_u32 m0, s41, 65536
    s_nop 0
    buffer_load_dwordx4 v2, s[8:11], s30 offen lds
    s_add_u32 s30, s30, 128
    s_add_u32 m0, s38, 81920
    s_nop 0
    buffer_load_dwordx4 v3, s[12:15], s34 offen lds
    s_add_u32 s34, s34, 128
    s_add_u32 m0, s41, 66560
    s_nop 0
    buffer_load_dwordx4 v2, s[8:11], s31 offen lds
    s_add_u32 s31, s31, 128
    s_add_u32 m0, s38, 82944
    s_nop 0
    buffer_load_dwordx4 v3, s[12:15], s35 offen lds
    s_add_u32 s35, s35, 128
    s_add_u32 m0, s41, 67584
    s_nop 0
    buffer_load_dwordx4 v2, s[8:11], s32 offen lds
    s_add_u32 s32, s32, 128
    s_add_u32 m0, s38, 83968
    s_nop 0
    buffer_load_dwordx4 v3, s[12:15], s36 offen lds
    s_add_u32 s36, s36, 128
    s_add_u32 m0, s41, 68608
    s_nop 0
    buffer_load_dwordx4 v2, s[8:11], s33 offen lds
    s_add_u32 s33, s33, 128
    s_add_u32 m0, s38, 84992
    s_nop 0
    buffer_load_dwordx4 v3, s[12:15], s37 offen lds
    s_add_u32 s37, s37, 128
    ds_read_b128 v[16:19], v12 offset:32768
    ds_read_b128 v[20:23], v12 offset:34816
    ds_read_b128 v[24:27], v12 offset:36864
    ds_read_b128 v[28:31], v12 offset:38912
    ds_read_b128 v[32:35], v14 offset:49152
    ds_read_b128 v[36:39], v14 offset:51200
    ds_read_b128 v[40:43], v14 offset:53248
    ds_read_b128 v[44:47], v14 offset:55296
    ds_read_b128 v[48:51], v13 offset:32768
    ds_read_b128 v[52:55], v13 offset:34816
    ds_read_b128 v[56:59], v13 offset:36864
    ds_read_b128 v[60:63], v13 offset:38912
    s_waitcnt lgkmcnt(4)
    v_mfma_f32_16x16x32_bf16 v[96:99], v[32:35], v[16:19], v[96:99]
    v_mfma_f32_16x16x32_bf16 v[100:103], v[36:39], v[16:19], v[100:103]
    v_mfma_f32_16x16x32_bf16 v[104:107], v[40:43], v[16:19], v[104:107]
    v_mfma_f32_16x16x32_bf16 v[108:111], v[44:47], v[16:19], v[108:111]
    ds_read_b128 v[64:67], v15 offset:49152
    ds_read_b128 v[68:71], v15 offset:51200
    ds_read_b128 v[72:75], v15 offset:53248
    ds_read_b128 v[76:79], v15 offset:55296
    v_mfma_f32_16x16x32_bf16 v[112:115], v[32:35], v[20:23], v[112:115]
    v_mfma_f32_16x16x32_bf16 v[116:119], v[36:39], v[20:23], v[116:119]
    v_mfma_f32_16x16x32_bf16 v[120:123], v[40:43], v[20:23], v[120:123]
    v_mfma_f32_16x16x32_bf16 v[124:127], v[44:47], v[20:23], v[124:127]
    v_mfma_f32_16x16x32_bf16 v[128:131], v[32:35], v[24:27], v[128:131]
    v_mfma_f32_16x16x32_bf16 v[132:135], v[36:39], v[24:27], v[132:135]
    v_mfma_f32_16x16x32_bf16 v[136:139], v[40:43], v[24:27], v[136:139]
    v_mfma_f32_16x16x32_bf16 v[140:143], v[44:47], v[24:27], v[140:143]
    v_mfma_f32_16x16x32_bf16 v[144:147], v[32:35], v[28:31], v[144:147]
    v_mfma_f32_16x16x32_bf16 v[148:151], v[36:39], v[28:31], v[148:151]
    v_mfma_f32_16x16x32_bf16 v[152:155], v[40:43], v[28:31], v[152:155]
    v_mfma_f32_16x16x32_bf16 v[156:159], v[44:47], v[28:31], v[156:159]
    s_waitcnt lgkmcnt(0)
    v_mfma_f32_16x16x32_bf16 v[96:99], v[64:67], v[48:51], v[96:99]
    v_mfma_f32_16x16x32_bf16 v[100:103], v[68:71], v[48:51], v[100:103]
    v_mfma_f32_16x16x32_bf16 v[104:107], v[72:75], v[48:51], v[104:107]
    v_mfma_f32_16x16x32_bf16 v[108:111], v[76:79], v[48:51], v[108:111]
    v_mfma_f32_16x16x32_bf16 v[112:115], v[64:67], v[52:55], v[112:115]
    v_mfma_f32_16x16x32_bf16 v[116:119], v[68:71], v[52:55], v[116:119]
    v_mfma_f32_16x16x32_bf16 v[120:123], v[72:75], v[52:55], v[120:123]
    v_mfma_f32_16x16x32_bf16 v[124:127], v[76:79], v[52:55], v[124:127]
    v_mfma_f32_16x16x32_bf16 v[128:131], v[64:67], v[56:59], v[128:131]
    v_mfma_f32_16x16x32_bf16 v[132:135], v[68:71], v[56:59], v[132:135]
    v_mfma_f32_16x16x32_bf16 v[136:139], v[72:75], v[56:59], v[136:139]
    v_mfma_f32_16x16x32_bf16 v[140:143], v[76:79], v[56:59], v[140:143]
    v_mfma_f32_16x16x32_bf16 v[144:147], v[64:67], v[60:63], v[144:147]
    v_mfma_f32_16x16x32_bf16 v[148:151], v[68:71], v[60:63], v[148:151]
    v_mfma_f32_16x16x32_bf16 v[152:155], v[72:75], v[60:63], v[152:155]
    v_mfma_f32_16x16x32_bf16 v[156:159], v[76:79], v[60:63], v[156:159]
    s_waitcnt vmcnt(16)
    s_barrier
    s_add_u32 m0, s41, 98304
    s_nop 0
    buffer_load_dwordx4 v2, s[8:11], s30 offen lds
    s_add_u32 s30, s30, 128
    s_add_u32 m0, s38, 114688
    s_nop 0
    buffer_load_dwordx4 v3, s[12:15], s34 offen lds
    s_add_u32 s34, s34, 128
    s_add_u32 m0, s41, 99328
    s_nop 0
    buffer_load_dwordx4 v2, s[8:11], s31 offen lds
    s_add_u32 s31, s31, 128
    s_add_u32 m0, s38, 115712
    s_nop 0
    buffer_load_dwordx4 v3, s[12:15], s35 offen lds
    s_add_u32 s35, s35, 128
    s_add_u32 m0, s41, 100352
    s_nop 0
    buffer_load_dwordx4 v2, s[8:11], s32 offen lds
    s_add_u32 s32, s32, 128
    s_add_u32 m0, s38, 116736
    s_nop 0
    buffer_load_dwordx4 v3, s[12:15], s36 offen lds
    s_add_u32 s36, s36, 128
    s_add_u32 m0, s41, 101376
    s_nop 0
    buffer_load_dwordx4 v2, s[8:11], s33 offen lds
    s_add_u32 s33, s33, 128
    s_add_u32 m0, s38, 117760
    s_nop 0
    buffer_load_dwordx4 v3, s[12:15], s37 offen lds
    s_add_u32 s37, s37, 128
    ds_read_b128 v[16:19], v4 offset:0
    ds_read_b128 v[20:23], v4 offset:2048
    ds_read_b128 v[24:27], v4 offset:4096
    ds_read_b128 v[28:31], v4 offset:6144
    ds_read_b128 v[32:35], v6 offset:16384
    ds_read_b128 v[36:39], v6 offset:18432
    ds_read_b128 v[40:43], v6 offset:20480
    ds_read_b128 v[44:47], v6 offset:22528
    ds_read_b128 v[48:51], v5 offset:0
    ds_read_b128 v[52:55], v5 offset:2048
    ds_read_b128 v[56:59], v5 offset:4096
    ds_read_b128 v[60:63], v5 offset:6144
    s_waitcnt lgkmcnt(4)
    v_mfma_f32_16x16x32_bf16 v[96:99], v[32:35], v[16:19], v[96:99]
    v_mfma_f32_16x16x32_bf16 v[100:103], v[36:39], v[16:19], v[100:103]
    v_mfma_f32_16x16x32_bf16 v[104:107], v[40:43], v[16:19], v[104:107]
    v_mfma_f32_16x16x32_bf16 v[108:111], v[44:47], v[16:19], v[108:111]
    ds_read_b128 v[64:67], v7 offset:16384
    ds_read_b128 v[68:71], v7 offset:18432
    ds_read_b128 v[72:75], v7 offset:20480
    ds_read_b128 v[76:79], v7 offset:22528
    v_mfma_f32_16x16x32_bf16 v[112:115], v[32:35], v[20:23], v[112:115]
    v_mfma_f32_16x16x32_bf16 v[116:119], v[36:39], v[20:23], v[116:119]
    v_mfma_f32_16x16x32_bf16 v[120:123], v[40:43], v[20:23], v[120:123]
    v_mfma_f32_16x16x32_bf16 v[124:127], v[44:47], v[20:23], v[124:127]
    v_mfma_f32_16x16x32_bf16 v[128:131], v[32:35], v[24:27], v[128:131]
    v_mfma_f32_16x16x32_bf16 v[132:135], v[36:39], v[24:27], v[132:135]
    v_mfma_f32_16x16x32_bf16 v[136:139], v[40:43], v[24:27], v[136:139]
    v_mfma_f32_16x16x32_bf16 v[140:143], v[44:47], v[24:27], v[140:143]
    v_mfma_f32_16x16x32_bf16 v[144:147], v[32:35], v[28:31], v[144:147]
    v_mfma_f32_16x16x32_bf16 v[148:151], v[36:39], v[28:31], v[148:151]
    v_mfma_f32_16x16x32_bf16 v[152:155], v[40:43], v[28:31], v[152:155]
    v_mfma_f32_16x16x32_bf16 v[156:159], v[44:47], v[28:31], v[156:159]
    s_waitcnt lgkmcnt(0)
    v_mfma_f32_16x16x32_bf16 v[96:99], v[64:67], v[48:51], v[96:99]
    v_mfma_f32_16x16x32_bf16 v[100:103], v[68:71], v[48:51], v[100:103]
    v_mfma_f32_16x16x32_bf16 v[104:107], v[72:75], v[48:51], v[104:107]
    v_mfma_f32_16x16x32_bf16 v[108:111], v[76:79], v[48:51], v[108:111]
    v_mfma_f32_16x16x32_bf16 v[112:115], v[64:67], v[52:55], v[112:115]
    v_mfma_f32_16x16x32_bf16 v[116:119], v[68:71], v[52:55], v[116:119]
    v_mfma_f32_16x16x32_bf16 v[120:123], v[72:75], v[52:55], v[120:123]
    v_mfma_f32_16x16x32_bf16 v[124:127], v[76:79], v[52:55], v[124:127]
    v_mfma_f32_16x16x32_bf16 v[128:131], v[64:67], v[56:59], v[128:131]
    v_mfma_f32_16x16x32_bf16 v[132:135], v[68:71], v[56:59], v[132:135]
    v_mfma_f32_16x16x32_bf16 v[136:139], v[72:75], v[56:59], v[136:139]
    v_mfma_f32_16x16x32_bf16 v[140:143], v[76:79], v[56:59], v[140:143]
    v_mfma_f32_16x16x32_bf16 v[144:147], v[64:67], v[60:63], v[144:147]
    v_mfma_f32_16x16x32_bf16 v[148:151], v[68:71], v[60:63], v[148:151]
    v_mfma_f32_16x16x32_bf16 v[152:155], v[72:75], v[60:63], v[152:155]
    v_mfma_f32_16x16x32_bf16 v[156:159], v[76:79], v[60:63], v[156:159]
    s_waitcnt vmcnt(16)
    s_barrier
    s_add_u32 m0, s41, 0
    s_nop 0
    buffer_load_dwordx4 v2, s[8:11], s30 offen lds
    s_add_u32 s30, s30, 128
    s_add_u32 m0, s38, 16384
    s_nop 0
    buffer_load_dwordx4 v3, s[12:15], s34 offen lds
    s_add_u32 s34, s34, 128
    s_add_u32 m0, s41, 1024
    s_nop 0
    buffer_load_dwordx4 v2, s[8:11], s31 offen lds
    s_add_u32 s31, s31, 128
    s_add_u32 m0, s38, 17408
    s_nop 0
    buffer_load_dwordx4 v3, s[12:15], s35 offen lds
    s_add_u32 s35, s35, 128
    s_add_u32 m0, s41, 2048
    s_nop 0
    buffer_load_dwordx4 v2, s[8:11], s32 offen lds
    s_add_u32 s32, s32, 128
    s_add_u32 m0, s38, 18432
    s_nop 0
    buffer_load_dwordx4 v3, s[12:15], s36 offen lds
    s_add_u32 s36, s36, 128
    s_add_u32 m0, s41, 3072
    s_nop 0
    buffer_load_dwordx4 v2, s[8:11], s33 offen lds
    s_add_u32 s33, s33, 128
    s_add_u32 m0, s38, 19456
    s_nop 0
    buffer_load_dwordx4 v3, s[12:15], s37 offen lds
    s_add_u32 s37, s37, 128
    ds_read_b128 v[16:19], v4 offset:32768
    ds_read_b128 v[20:23], v4 offset:34816
    ds_read_b128 v[24:27], v4 offset:36864
    ds_read_b128 v[28:31], v4 offset:38912
    ds_read_b128 v[32:35], v6 offset:49152
    ds_read_b128 v[36:39], v6 offset:51200
    ds_read_b128 v[40:43], v6 offset:53248
    ds_read_b128 v[44:47], v6 offset:55296
    ds_read_b128 v[48:51], v5 offset:32768
    ds_read_b128 v[52:55], v5 offset:34816
    ds_read_b128 v[56:59], v5 offset:36864
    ds_read_b128 v[60:63], v5 offset:38912
    s_waitcnt lgkmcnt(4)
    v_mfma_f32_16x16x32_bf16 v[96:99], v[32:35], v[16:19], v[96:99]
    v_mfma_f32_16x16x32_bf16 v[100:103], v[36:39], v[16:19], v[100:103]
    v_mfma_f32_16x16x32_bf16 v[104:107], v[40:43], v[16:19], v[104:107]
    v_mfma_f32_16x16x32_bf16 v[108:111], v[44:47], v[16:19], v[108:111]
    ds_read_b128 v[64:67], v7 offset:49152
    ds_read_b128 v[68:71], v7 offset:51200
    ds_read_b128 v[72:75], v7 offset:53248
    ds_read_b128 v[76:79], v7 offset:55296
    v_mfma_f32_16x16x32_bf16 v[112:115], v[32:35], v[20:23], v[112:115]
    v_mfma_f32_16x16x32_bf16 v[116:119], v[36:39], v[20:23], v[116:119]
    v_mfma_f32_16x16x32_bf16 v[120:123], v[40:43], v[20:23], v[120:123]
    v_mfma_f32_16x16x32_bf16 v[124:127], v[44:47], v[20:23], v[124:127]
    v_mfma_f32_16x16x32_bf16 v[128:131], v[32:35], v[24:27], v[128:131]
    v_mfma_f32_16x16x32_bf16 v[132:135], v[36:39], v[24:27], v[132:135]
    v_mfma_f32_16x16x32_bf16 v[136:139], v[40:43], v[24:27], v[136:139]
    v_mfma_f32_16x16x32_bf16 v[140:143], v[44:47], v[24:27], v[140:143]
    v_mfma_f32_16x16x32_bf16 v[144:147], v[32:35], v[28:31], v[144:147]
    v_mfma_f32_16x16x32_bf16 v[148:151], v[36:39], v[28:31], v[148:151]
    v_mfma_f32_16x16x32_bf16 v[152:155], v[40:43], v[28:31], v[152:155]
    v_mfma_f32_16x16x32_bf16 v[156:159], v[44:47], v[28:31], v[156:159]
    s_waitcnt lgkmcnt(0)
    v_mfma_f32_16x16x32_bf16 v[96:99], v[64:67], v[48:51], v[96:99]
    v_mfma_f32_16x16x32_bf16 v[100:103], v[68:71], v[48:51], v[100:103]
    v_mfma_f32_16x16x32_bf16 v[104:107], v[72:75], v[48:51], v[104:107]
    v_mfma_f32_16x16x32_bf16 v[108:111], v[76:79], v[48:51], v[108:111]
    v_mfma_f32_16x16x32_bf16 v[112:115], v[64:67], v[52:55], v[112:115]
    v_mfma_f32_16x16x32_bf16 v[116:119], v[68:71], v[52:55], v[116:119]
    v_mfma_f32_16x16x32_bf16 v[120:123], v[72:75], v[52:55], v[120:123]
    v_mfma_f32_16x16x32_bf16 v[124:127], v[76:79], v[52:55], v[124:127]
    v_mfma_f32_16x16x32_bf16 v[128:131], v[64:67], v[56:59], v[128:131]
    v_mfma_f32_16x16x32_bf16 v[132:135], v[68:71], v[56:59], v[132:135]
    v_mfma_f32_16x16x32_bf16 v[136:139], v[72:75], v[56:59], v[136:139]
    v_mfma_f32_16x16x32_bf16 v[140:143], v[76:79], v[56:59], v[140:143]
    v_mfma_f32_16x16x32_bf16 v[144:147], v[64:67], v[60:63], v[144:147]
    v_mfma_f32_16x16x32_bf16 v[148:151], v[68:71], v[60:63], v[148:151]
    v_mfma_f32_16x16x32_bf16 v[152:155], v[72:75], v[60:63], v[152:155]
    v_mfma_f32_16x16x32_bf16 v[156:159], v[76:79], v[60:63], v[156:159]
    s_waitcnt vmcnt(16)
    s_barrier
    s_add_u32 m0, s41, 32768
    s_nop 0
    buffer_load_dwordx4 v2, s[8:11], s30 offen lds
    s_add_u32 s30, s30, 128
    s_add_u32 m0, s38, 49152
    s_nop 0
    buffer_load_dwordx4 v3, s[12:15], s34 offen lds
    s_add_u32 s34, s34, 128
    s_add_u32 m0, s41, 33792
    s_nop 0
    buffer_load_dwordx4 v2, s[8:11], s31 offen lds
    s_add_u32 s31, s31, 128
    s_add_u32 m0, s38, 50176
    s_nop 0
    buffer_load_dwordx4 v3, s[12:15], s35 offen lds
    s_add_u32 s35, s35, 128
    s_add_u32 m0, s41, 34816
    s_nop 0
    buffer_load_dwordx4 v2, s[8:11], s32 offen lds
    s_add_u32 s32, s32, 128
    s_add_u32 m0, s38, 51200
    s_nop 0
    buffer_load_dwordx4 v3, s[12:15], s36 offen lds
    s_add_u32 s36, s36, 128
    s_add_u32 m0, s41, 35840
    s_nop 0
    buffer_load_dwordx4 v2, s[8:11], s33 offen lds
    s_add_u32 s33, s33, 128
    s_add_u32 m0, s38, 52224
    s_nop 0
    buffer_load_dwordx4 v3, s[12:15], s37 offen lds
    s_add_u32 s37, s37, 128
    ds_read_b128 v[16:19], v12 offset:0
    ds_read_b128 v[20:23], v12 offset:2048
    ds_read_b128 v[24:27], v12 offset:4096
    ds_read_b128 v[28:31], v12 offset:6144
    ds_read_b128 v[32:35], v14 offset:16384
    ds_read_b128 v[36:39], v14 offset:18432
    ds_read_b128 v[40:43], v14 offset:20480
    ds_read_b128 v[44:47], v14 offset:22528
    ds_read_b128 v[48:51], v13 offset:0
    ds_read_b128 v[52:55], v13 offset:2048
    ds_read_b128 v[56:59], v13 offset:4096
    ds_read_b128 v[60:63], v13 offset:6144
    s_waitcnt lgkmcnt(4)
    v_mfma_f32_16x16x32_bf16 v[96:99], v[32:35], v[16:19], v[96:99]
    v_mfma_f32_16x16x32_bf16 v[100:103], v[36:39], v[16:19], v[100:103]
    v_mfma_f32_16x16x32_bf16 v[104:107], v[40:43], v[16:19], v[104:107]
    v_mfma_f32_16x16x32_bf16 v[108:111], v[44:47], v[16:19], v[108:111]
    ds_read_b128 v[64:67], v15 offset:16384
    ds_read_b128 v[68:71], v15 offset:18432
    ds_read_b128 v[72:75], v15 offset:20480
    ds_read_b128 v[76:79], v15 offset:22528
    v_mfma_f32_16x16x32_bf16 v[112:115], v[32:35], v[20:23], v[112:115]
    v_mfma_f32_16x16x32_bf16 v[116:119], v[36:39], v[20:23], v[116:119]
    v_mfma_f32_16x16x32_bf16 v[120:123], v[40:43], v[20:23], v[120:123]
    v_mfma_f32_16x16x32_bf16 v[124:127], v[44:47], v[20:23], v[124:127]
    v_mfma_f32_16x16x32_bf16 v[128:131], v[32:35], v[24:27], v[128:131]
    v_mfma_f32_16x16x32_bf16 v[132:135], v[36:39], v[24:27], v[132:135]
    v_mfma_f32_16x16x32_bf16 v[136:139], v[40:43], v[24:27], v[136:139]
    v_mfma_f32_16x16x32_bf16 v[140:143], v[44:47], v[24:27], v[140:143]
    v_mfma_f32_16x16x32_bf16 v[144:147], v[32:35], v[28:31], v[144:147]
    v_mfma_f32_16x16x32_bf16 v[148:151], v[36:39], v[28:31], v[148:151]
    v_mfma_f32_16x16x32_bf16 v[152:155], v[40:43], v[28:31], v[152:155]
    v_mfma_f32_16x16x32_bf16 v[156:159], v[44:47], v[28:31], v[156:159]
    s_waitcnt lgkmcnt(0)
    v_mfma_f32_16x16x32_bf16 v[96:99], v[64:67], v[48:51], v[96:99]
    v_mfma_f32_16x16x32_bf16 v[100:103], v[68:71], v[48:51], v[100:103]
    v_mfma_f32_16x16x32_bf16 v[104:107], v[72:75], v[48:51], v[104:107]
    v_mfma_f32_16x16x32_bf16 v[108:111], v[76:79], v[48:51], v[108:111]
    v_mfma_f32_16x16x32_bf16 v[112:115], v[64:67], v[52:55], v[112:115]
    v_mfma_f32_16x16x32_bf16 v[116:119], v[68:71], v[52:55], v[116:119]
    v_mfma_f32_16x16x32_bf16 v[120:123], v[72:75], v[52:55], v[120:123]
    v_mfma_f32_16x16x32_bf16 v[124:127], v[76:79], v[52:55], v[124:127]
    v_mfma_f32_16x16x32_bf16 v[128:131], v[64:67], v[56:59], v[128:131]
    v_mfma_f32_16x16x32_bf16 v[132:135], v[68:71], v[56:59], v[132:135]
    v_mfma_f32_16x16x32_bf16 v[136:139], v[72:75], v[56:59], v[136:139]
    v_mfma_f32_16x16x32_bf16 v[140:143], v[76:79], v[56:59], v[140:143]
    v_mfma_f32_16x16x32_bf16 v[144:147], v[64:67], v[60:63], v[144:147]
    v_mfma_f32_16x16x32_bf16 v[148:151], v[68:71], v[60:63], v[148:151]
    v_mfma_f32_16x16x32_bf16 v[152:155], v[72:75], v[60:63], v[152:155]
    v_mfma_f32_16x16x32_bf16 v[156:159], v[76:79], v[60:63], v[156:159]
    s_waitcnt vmcnt(16)
    s_barrier
    s_add_u32 m0, s41, 65536
    s_nop 0
    buffer_load_dwordx4 v2, s[8:11], s30 offen lds
    s_add_u32 s30, s30, 128
    s_add_u32 m0, s38, 81920
    s_nop 0
    buffer_load_dwordx4 v3, s[12:15], s34 offen lds
    s_add_u32 s34, s34, 128
    s_add_u32 m0, s41, 66560
    s_nop 0
    buffer_load_dwordx4 v2, s[8:11], s31 offen lds
    s_add_u32 s31, s31, 128
    s_add_u32 m0, s38, 82944
    s_nop 0
    buffer_load_dwordx4 v3, s[12:15], s35 offen lds
    s_add_u32 s35, s35, 128
    s_add_u32 m0, s41, 67584
    s_nop 0
    buffer_load_dwordx4 v2, s[8:11], s32 offen lds
    s_add_u32 s32, s32, 128
    s_add_u32 m0, s38, 83968
    s_nop 0
    buffer_load_dwordx4 v3, s[12:15], s36 offen lds
    s_add_u32 s36, s36, 128
    s_add_u32 m0, s41, 68608
    s_nop 0
    buffer_load_dwordx4 v2, s[8:11], s33 offen lds
    s_add_u32 s33, s33, 128
    s_add_u32 m0, s38, 84992
    s_nop 0
    buffer_load_dwordx4 v3, s[12:15], s37 offen lds
    s_add_u32 s37, s37, 128
    ds_read_b128 v[16:19], v12 offset:32768
    ds_read_b128 v[20:23], v12 offset:34816
    ds_read_b128 v[24:27], v12 offset:36864
    ds_read_b128 v[28:31], v12 offset:38912
    ds_read_b128 v[32:35], v14 offset:49152
    ds_read_b128 v[36:39], v14 offset:51200
    ds_read_b128 v[40:43], v14 offset:53248
    ds_read_b128 v[44:47], v14 offset:55296
    ds_read_b128 v[48:51], v13 offset:32768
    ds_read_b128 v[52:55], v13 offset:34816
    ds_read_b128 v[56:59], v13 offset:36864
    ds_read_b128 v[60:63], v13 offset:38912
    s_waitcnt lgkmcnt(4)
    v_mfma_f32_16x16x32_bf16 v[96:99], v[32:35], v[16:19], v[96:99]
    v_mfma_f32_16x16x32_bf16 v[100:103], v[36:39], v[16:19], v[100:103]
    v_mfma_f32_16x16x32_bf16 v[104:107], v[40:43], v[16:19], v[104:107]
    v_mfma_f32_16x16x32_bf16 v[108:111], v[44:47], v[16:19], v[108:111]
    ds_read_b128 v[64:67], v15 offset:49152
    ds_read_b128 v[68:71], v15 offset:51200
    ds_read_b128 v[72:75], v15 offset:53248
    ds_read_b128 v[76:79], v15 offset:55296
    v_mfma_f32_16x16x32_bf16 v[112:115], v[32:35], v[20:23], v[112:115]
    v_mfma_f32_16x16x32_bf16 v[116:119], v[36:39], v[20:23], v[116:119]
    v_mfma_f32_16x16x32_bf16 v[120:123], v[40:43], v[20:23], v[120:123]
    v_mfma_f32_16x16x32_bf16 v[124:127], v[44:47], v[20:23], v[124:127]
    v_mfma_f32_16x16x32_bf16 v[128:131], v[32:35], v[24:27], v[128:131]
    v_mfma_f32_16x16x32_bf16 v[132:135], v[36:39], v[24:27], v[132:135]
    v_mfma_f32_16x16x32_bf16 v[136:139], v[40:43], v[24:27], v[136:139]
    v_mfma_f32_16x16x32_bf16 v[140:143], v[44:47], v[24:27], v[140:143]
    v_mfma_f32_16x16x32_bf16 v[144:147], v[32:35], v[28:31], v[144:147]
    v_mfma_f32_16x16x32_bf16 v[148:151], v[36:39], v[28:31], v[148:151]
    v_mfma_f32_16x16x32_bf16 v[152:155], v[40:43], v[28:31], v[152:155]
    v_mfma_f32_16x16x32_bf16 v[156:159], v[44:47], v[28:31], v[156:159]
    s_waitcnt lgkmcnt(0)
    v_mfma_f32_16x16x32_bf16 v[96:99], v[64:67], v[48:51], v[96:99]
    v_mfma_f32_16x16x32_bf16 v[100:103], v[68:71], v[48:51], v[100:103]
    v_mfma_f32_16x16x32_bf16 v[104:107], v[72:75], v[48:51], v[104:107]
    v_mfma_f32_16x16x32_bf16 v[108:111], v[76:79], v[48:51], v[108:111]
    v_mfma_f32_16x16x32_bf16 v[112:115], v[64:67], v[52:55], v[112:115]
    v_mfma_f32_16x16x32_bf16 v[116:119], v[68:71], v[52:55], v[116:119]
    v_mfma_f32_16x16x32_bf16 v[120:123], v[72:75], v[52:55], v[120:123]
    v_mfma_f32_16x16x32_bf16 v[124:127], v[76:79], v[52:55], v[124:127]
    v_mfma_f32_16x16x32_bf16 v[128:131], v[64:67], v[56:59], v[128:131]
    v_mfma_f32_16x16x32_bf16 v[132:135], v[68:71], v[56:59], v[132:135]
    v_mfma_f32_16x16x32_bf16 v[136:139], v[72:75], v[56:59], v[136:139]
    v_mfma_f32_16x16x32_bf16 v[140:143], v[76:79], v[56:59], v[140:143]
    v_mfma_f32_16x16x32_bf16 v[144:147], v[64:67], v[60:63], v[144:147]
    v_mfma_f32_16x16x32_bf16 v[148:151], v[68:71], v[60:63], v[148:151]
    v_mfma_f32_16x16x32_bf16 v[152:155], v[72:75], v[60:63], v[152:155]
    v_mfma_f32_16x16x32_bf16 v[156:159], v[76:79], v[60:63], v[156:159]
    s_waitcnt vmcnt(16)
    s_barrier
    s_add_u32 m0, s41, 98304
    s_nop 0
    buffer_load_dwordx4 v2, s[8:11], s30 offen lds
    s_add_u32 s30, s30, 128
    s_add_u32 m0, s38, 114688
    s_nop 0
    buffer_load_dwordx4 v3, s[12:15], s34 offen lds
    s_add_u32 s34, s34, 128
    s_add_u32 m0, s41, 99328
    s_nop 0
    buffer_load_dwordx4 v2, s[8:11], s31 offen lds
    s_add_u32 s31, s31, 128
    s_add_u32 m0, s38, 115712
    s_nop 0
    buffer_load_dwordx4 v3, s[12:15], s35 offen lds
    s_add_u32 s35, s35, 128
    s_add_u32 m0, s41, 100352
    s_nop 0
    buffer_load_dwordx4 v2, s[8:11], s32 offen lds
    s_add_u32 s32, s32, 128
    s_add_u32 m0, s38, 116736
    s_nop 0
    buffer_load_dwordx4 v3, s[12:15], s36 offen lds
    s_add_u32 s36, s36, 128
    s_add_u32 m0, s41, 101376
    s_nop 0
    buffer_load_dwordx4 v2, s[8:11], s33 offen lds
    s_add_u32 s33, s33, 128
    s_add_u32 m0, s38, 117760
    s_nop 0
    buffer_load_dwordx4 v3, s[12:15], s37 offen lds
    s_add_u32 s37, s37, 128
    ds_read_b128 v[16:19], v4 offset:0
    ds_read_b128 v[20:23], v4 offset:2048
    ds_read_b128 v[24:27], v4 offset:4096
    ds_read_b128 v[28:31], v4 offset:6144
    ds_read_b128 v[32:35], v6 offset:16384
    ds_read_b128 v[36:39], v6 offset:18432
    ds_read_b128 v[40:43], v6 offset:20480
    ds_read_b128 v[44:47], v6 offset:22528
    ds_read_b128 v[48:51], v5 offset:0
    ds_read_b128 v[52:55], v5 offset:2048
    ds_read_b128 v[56:59], v5 offset:4096
    ds_read_b128 v[60:63], v5 offset:6144
    s_waitcnt lgkmcnt(4)
    v_mfma_f32_16x16x32_bf16 v[96:99], v[32:35], v[16:19], v[96:99]
    v_mfma_f32_16x16x32_bf16 v[100:103], v[36:39], v[16:19], v[100:103]
    v_mfma_f32_16x16x32_bf16 v[104:107], v[40:43], v[16:19], v[104:107]
    v_mfma_f32_16x16x32_bf16 v[108:111], v[44:47], v[16:19], v[108:111]
    ds_read_b128 v[64:67], v7 offset:16384
    ds_read_b128 v[68:71], v7 offset:18432
    ds_read_b128 v[72:75], v7 offset:20480
    ds_read_b128 v[76:79], v7 offset:22528
    v_mfma_f32_16x16x32_bf16 v[112:115], v[32:35], v[20:23], v[112:115]
    v_mfma_f32_16x16x32_bf16 v[116:119], v[36:39], v[20:23], v[116:119]
    v_mfma_f32_16x16x32_bf16 v[120:123], v[40:43], v[20:23], v[120:123]
    v_mfma_f32_16x16x32_bf16 v[124:127], v[44:47], v[20:23], v[124:127]
    v_mfma_f32_16x16x32_bf16 v[128:131], v[32:35], v[24:27], v[128:131]
    v_mfma_f32_16x16x32_bf16 v[132:135], v[36:39], v[24:27], v[132:135]
    v_mfma_f32_16x16x32_bf16 v[136:139], v[40:43], v[24:27], v[136:139]
    v_mfma_f32_16x16x32_bf16 v[140:143], v[44:47], v[24:27], v[140:143]
    v_mfma_f32_16x16x32_bf16 v[144:147], v[32:35], v[28:31], v[144:147]
    v_mfma_f32_16x16x32_bf16 v[148:151], v[36:39], v[28:31], v[148:151]
    v_mfma_f32_16x16x32_bf16 v[152:155], v[40:43], v[28:31], v[152:155]
    v_mfma_f32_16x16x32_bf16 v[156:159], v[44:47], v[28:31], v[156:159]
    s_waitcnt lgkmcnt(0)
    v_mfma_f32_16x16x32_bf16 v[96:99], v[64:67], v[48:51], v[96:99]
    v_mfma_f32_16x16x32_bf16 v[100:103], v[68:71], v[48:51], v[100:103]
    v_mfma_f32_16x16x32_bf16 v[104:107], v[72:75], v[48:51], v[104:107]
    v_mfma_f32_16x16x32_bf16 v[108:111], v[76:79], v[48:51], v[108:111]
    v_mfma_f32_16x16x32_bf16 v[112:115], v[64:67], v[52:55], v[112:115]
    v_mfma_f32_16x16x32_bf16 v[116:119], v[68:71], v[52:55], v[116:119]
    v_mfma_f32_16x16x32_bf16 v[120:123], v[72:75], v[52:55], v[120:123]
    v_mfma_f32_16x16x32_bf16 v[124:127], v[76:79], v[52:55], v[124:127]
    v_mfma_f32_16x16x32_bf16 v[128:131], v[64:67], v[56:59], v[128:131]
    v_mfma_f32_16x16x32_bf16 v[132:135], v[68:71], v[56:59], v[132:135]
    v_mfma_f32_16x16x32_bf16 v[136:139], v[72:75], v[56:59], v[136:139]
    v_mfma_f32_16x16x32_bf16 v[140:143], v[76:79], v[56:59], v[140:143]
    v_mfma_f32_16x16x32_bf16 v[144:147], v[64:67], v[60:63], v[144:147]
    v_mfma_f32_16x16x32_bf16 v[148:151], v[68:71], v[60:63], v[148:151]
    v_mfma_f32_16x16x32_bf16 v[152:155], v[72:75], v[60:63], v[152:155]
    v_mfma_f32_16x16x32_bf16 v[156:159], v[76:79], v[60:63], v[156:159]
    s_waitcnt vmcnt(16)
    s_barrier
    s_add_u32 m0, s41, 0
    s_nop 0
    buffer_load_dwordx4 v2, s[8:11], s30 offen lds
    s_add_u32 s30, s30, 128
    s_add_u32 m0, s38, 16384
    s_nop 0
    buffer_load_dwordx4 v3, s[12:15], s34 offen lds
    s_add_u32 s34, s34, 128
    s_add_u32 m0, s41, 1024
    s_nop 0
    buffer_load_dwordx4 v2, s[8:11], s31 offen lds
    s_add_u32 s31, s31, 128
    s_add_u32 m0, s38, 17408
    s_nop 0
    buffer_load_dwordx4 v3, s[12:15], s35 offen lds
    s_add_u32 s35, s35, 128
    s_add_u32 m0, s41, 2048
    s_nop 0
    buffer_load_dwordx4 v2, s[8:11], s32 offen lds
    s_add_u32 s32, s32, 128
    s_add_u32 m0, s38, 18432
    s_nop 0
    buffer_load_dwordx4 v3, s[12:15], s36 offen lds
    s_add_u32 s36, s36, 128
    s_add_u32 m0, s41, 3072
    s_nop 0
    buffer_load_dwordx4 v2, s[8:11], s33 offen lds
    s_add_u32 s33, s33, 128
    s_add_u32 m0, s38, 19456
    s_nop 0
    buffer_load_dwordx4 v3, s[12:15], s37 offen lds
    s_add_u32 s37, s37, 128
    ds_read_b128 v[16:19], v4 offset:32768
    ds_read_b128 v[20:23], v4 offset:34816
    ds_read_b128 v[24:27], v4 offset:36864
    ds_read_b128 v[28:31], v4 offset:38912
    ds_read_b128 v[32:35], v6 offset:49152
    ds_read_b128 v[36:39], v6 offset:51200
    ds_read_b128 v[40:43], v6 offset:53248
    ds_read_b128 v[44:47], v6 offset:55296
    ds_read_b128 v[48:51], v5 offset:32768
    ds_read_b128 v[52:55], v5 offset:34816
    ds_read_b128 v[56:59], v5 offset:36864
    ds_read_b128 v[60:63], v5 offset:38912
    s_waitcnt lgkmcnt(4)
    v_mfma_f32_16x16x32_bf16 v[96:99], v[32:35], v[16:19], v[96:99]
    v_mfma_f32_16x16x32_bf16 v[100:103], v[36:39], v[16:19], v[100:103]
    v_mfma_f32_16x16x32_bf16 v[104:107], v[40:43], v[16:19], v[104:107]
    v_mfma_f32_16x16x32_bf16 v[108:111], v[44:47], v[16:19], v[108:111]
    ds_read_b128 v[64:67], v7 offset:49152
    ds_read_b128 v[68:71], v7 offset:51200
    ds_read_b128 v[72:75], v7 offset:53248
    ds_read_b128 v[76:79], v7 offset:55296
    v_mfma_f32_16x16x32_bf16 v[112:115], v[32:35], v[20:23], v[112:115]
    v_mfma_f32_16x16x32_bf16 v[116:119], v[36:39], v[20:23], v[116:119]
    v_mfma_f32_16x16x32_bf16 v[120:123], v[40:43], v[20:23], v[120:123]
    v_mfma_f32_16x16x32_bf16 v[124:127], v[44:47], v[20:23], v[124:127]
    v_mfma_f32_16x16x32_bf16 v[128:131], v[32:35], v[24:27], v[128:131]
    v_mfma_f32_16x16x32_bf16 v[132:135], v[36:39], v[24:27], v[132:135]
    v_mfma_f32_16x16x32_bf16 v[136:139], v[40:43], v[24:27], v[136:139]
    v_mfma_f32_16x16x32_bf16 v[140:143], v[44:47], v[24:27], v[140:143]
    v_mfma_f32_16x16x32_bf16 v[144:147], v[32:35], v[28:31], v[144:147]
    v_mfma_f32_16x16x32_bf16 v[148:151], v[36:39], v[28:31], v[148:151]
    v_mfma_f32_16x16x32_bf16 v[152:155], v[40:43], v[28:31], v[152:155]
    v_mfma_f32_16x16x32_bf16 v[156:159], v[44:47], v[28:31], v[156:159]
    s_waitcnt lgkmcnt(0)
    v_mfma_f32_16x16x32_bf16 v[96:99], v[64:67], v[48:51], v[96:99]
    v_mfma_f32_16x16x32_bf16 v[100:103], v[68:71], v[48:51], v[100:103]
    v_mfma_f32_16x16x32_bf16 v[104:107], v[72:75], v[48:51], v[104:107]
    v_mfma_f32_16x16x32_bf16 v[108:111], v[76:79], v[48:51], v[108:111]
    v_mfma_f32_16x16x32_bf16 v[112:115], v[64:67], v[52:55], v[112:115]
    v_mfma_f32_16x16x32_bf16 v[116:119], v[68:71], v[52:55], v[116:119]
    v_mfma_f32_16x16x32_bf16 v[120:123], v[72:75], v[52:55], v[120:123]
    v_mfma_f32_16x16x32_bf16 v[124:127], v[76:79], v[52:55], v[124:127]
    v_mfma_f32_16x16x32_bf16 v[128:131], v[64:67], v[56:59], v[128:131]
    v_mfma_f32_16x16x32_bf16 v[132:135], v[68:71], v[56:59], v[132:135]
    v_mfma_f32_16x16x32_bf16 v[136:139], v[72:75], v[56:59], v[136:139]
    v_mfma_f32_16x16x32_bf16 v[140:143], v[76:79], v[56:59], v[140:143]
    v_mfma_f32_16x16x32_bf16 v[144:147], v[64:67], v[60:63], v[144:147]
    v_mfma_f32_16x16x32_bf16 v[148:151], v[68:71], v[60:63], v[148:151]
    v_mfma_f32_16x16x32_bf16 v[152:155], v[72:75], v[60:63], v[152:155]
    v_mfma_f32_16x16x32_bf16 v[156:159], v[76:79], v[60:63], v[156:159]
    s_waitcnt vmcnt(16)
    s_barrier
    s_add_u32 m0, s41, 32768
    s_nop 0
    buffer_load_dwordx4 v2, s[8:11], s30 offen lds
    s_add_u32 s30, s30, 128
    s_add_u32 m0, s38, 49152
    s_nop 0
    buffer_load_dwordx4 v3, s[12:15], s34 offen lds
    s_add_u32 s34, s34, 128
    s_add_u32 m0, s41, 33792
    s_nop 0
    buffer_load_dwordx4 v2, s[8:11], s31 offen lds
    s_add_u32 s31, s31, 128
    s_add_u32 m0, s38, 50176
    s_nop 0
    buffer_load_dwordx4 v3, s[12:15], s35 offen lds
    s_add_u32 s35, s35, 128
    s_add_u32 m0, s41, 34816
    s_nop 0
    buffer_load_dwordx4 v2, s[8:11], s32 offen lds
    s_add_u32 s32, s32, 128
    s_add_u32 m0, s38, 51200
    s_nop 0
    buffer_load_dwordx4 v3, s[12:15], s36 offen lds
    s_add_u32 s36, s36, 128
    s_add_u32 m0, s41, 35840
    s_nop 0
    buffer_load_dwordx4 v2, s[8:11], s33 offen lds
    s_add_u32 s33, s33, 128
    s_add_u32 m0, s38, 52224
    s_nop 0
    buffer_load_dwordx4 v3, s[12:15], s37 offen lds
    s_add_u32 s37, s37, 128
    ds_read_b128 v[16:19], v12 offset:0
    ds_read_b128 v[20:23], v12 offset:2048
    ds_read_b128 v[24:27], v12 offset:4096
    ds_read_b128 v[28:31], v12 offset:6144
    ds_read_b128 v[32:35], v14 offset:16384
    ds_read_b128 v[36:39], v14 offset:18432
    ds_read_b128 v[40:43], v14 offset:20480
    ds_read_b128 v[44:47], v14 offset:22528
    ds_read_b128 v[48:51], v13 offset:0
    ds_read_b128 v[52:55], v13 offset:2048
    ds_read_b128 v[56:59], v13 offset:4096
    ds_read_b128 v[60:63], v13 offset:6144
    s_waitcnt lgkmcnt(4)
    v_mfma_f32_16x16x32_bf16 v[96:99], v[32:35], v[16:19], v[96:99]
    v_mfma_f32_16x16x32_bf16 v[100:103], v[36:39], v[16:19], v[100:103]
    v_mfma_f32_16x16x32_bf16 v[104:107], v[40:43], v[16:19], v[104:107]
    v_mfma_f32_16x16x32_bf16 v[108:111], v[44:47], v[16:19], v[108:111]
    ds_read_b128 v[64:67], v15 offset:16384
    ds_read_b128 v[68:71], v15 offset:18432
    ds_read_b128 v[72:75], v15 offset:20480
    ds_read_b128 v[76:79], v15 offset:22528
    v_mfma_f32_16x16x32_bf16 v[112:115], v[32:35], v[20:23], v[112:115]
    v_mfma_f32_16x16x32_bf16 v[116:119], v[36:39], v[20:23], v[116:119]
    v_mfma_f32_16x16x32_bf16 v[120:123], v[40:43], v[20:23], v[120:123]
    v_mfma_f32_16x16x32_bf16 v[124:127], v[44:47], v[20:23], v[124:127]
    v_mfma_f32_16x16x32_bf16 v[128:131], v[32:35], v[24:27], v[128:131]
    v_mfma_f32_16x16x32_bf16 v[132:135], v[36:39], v[24:27], v[132:135]
    v_mfma_f32_16x16x32_bf16 v[136:139], v[40:43], v[24:27], v[136:139]
    v_mfma_f32_16x16x32_bf16 v[140:143], v[44:47], v[24:27], v[140:143]
    v_mfma_f32_16x16x32_bf16 v[144:147], v[32:35], v[28:31], v[144:147]
    v_mfma_f32_16x16x32_bf16 v[148:151], v[36:39], v[28:31], v[148:151]
    v_mfma_f32_16x16x32_bf16 v[152:155], v[40:43], v[28:31], v[152:155]
    v_mfma_f32_16x16x32_bf16 v[156:159], v[44:47], v[28:31], v[156:159]
    s_waitcnt lgkmcnt(0)
    v_mfma_f32_16x16x32_bf16 v[96:99], v[64:67], v[48:51], v[96:99]
    v_mfma_f32_16x16x32_bf16 v[100:103], v[68:71], v[48:51], v[100:103]
    v_mfma_f32_16x16x32_bf16 v[104:107], v[72:75], v[48:51], v[104:107]
    v_mfma_f32_16x16x32_bf16 v[108:111], v[76:79], v[48:51], v[108:111]
    v_mfma_f32_16x16x32_bf16 v[112:115], v[64:67], v[52:55], v[112:115]
    v_mfma_f32_16x16x32_bf16 v[116:119], v[68:71], v[52:55], v[116:119]
    v_mfma_f32_16x16x32_bf16 v[120:123], v[72:75], v[52:55], v[120:123]
    v_mfma_f32_16x16x32_bf16 v[124:127], v[76:79], v[52:55], v[124:127]
    v_mfma_f32_16x16x32_bf16 v[128:131], v[64:67], v[56:59], v[128:131]
    v_mfma_f32_16x16x32_bf16 v[132:135], v[68:71], v[56:59], v[132:135]
    v_mfma_f32_16x16x32_bf16 v[136:139], v[72:75], v[56:59], v[136:139]
    v_mfma_f32_16x16x32_bf16 v[140:143], v[76:79], v[56:59], v[140:143]
    v_mfma_f32_16x16x32_bf16 v[144:147], v[64:67], v[60:63], v[144:147]
    v_mfma_f32_16x16x32_bf16 v[148:151], v[68:71], v[60:63], v[148:151]
    v_mfma_f32_16x16x32_bf16 v[152:155], v[72:75], v[60:63], v[152:155]
    v_mfma_f32_16x16x32_bf16 v[156:159], v[76:79], v[60:63], v[156:159]
    s_waitcnt vmcnt(16)
    s_barrier
    s_add_u32 m0, s41, 65536
    s_nop 0
    buffer_load_dwordx4 v2, s[8:11], s30 offen lds
    s_add_u32 s30, s30, 128
    s_add_u32 m0, s38, 81920
    s_nop 0
    buffer_load_dwordx4 v3, s[12:15], s34 offen lds
    s_add_u32 s34, s34, 128
    s_add_u32 m0, s41, 66560
    s_nop 0
    buffer_load_dwordx4 v2, s[8:11], s31 offen lds
    s_add_u32 s31, s31, 128
    s_add_u32 m0, s38, 82944
    s_nop 0
    buffer_load_dwordx4 v3, s[12:15], s35 offen lds
    s_add_u32 s35, s35, 128
    s_add_u32 m0, s41, 67584
    s_nop 0
    buffer_load_dwordx4 v2, s[8:11], s32 offen lds
    s_add_u32 s32, s32, 128
    s_add_u32 m0, s38, 83968
    s_nop 0
    buffer_load_dwordx4 v3, s[12:15], s36 offen lds
    s_add_u32 s36, s36, 128
    s_add_u32 m0, s41, 68608
    s_nop 0
    buffer_load_dwordx4 v2, s[8:11], s33 offen lds
    s_add_u32 s33, s33, 128
    s_add_u32 m0, s38, 84992
    s_nop 0
    buffer_load_dwordx4 v3, s[12:15], s37 offen lds
    s_add_u32 s37, s37, 128
    ds_read_b128 v[16:19], v12 offset:32768
    ds_read_b128 v[20:23], v12 offset:34816
    ds_read_b128 v[24:27], v12 offset:36864
    ds_read_b128 v[28:31], v12 offset:38912
    ds_read_b128 v[32:35], v14 offset:49152
    ds_read_b128 v[36:39], v14 offset:51200
    ds_read_b128 v[40:43], v14 offset:53248
    ds_read_b128 v[44:47], v14 offset:55296
    ds_read_b128 v[48:51], v13 offset:32768
    ds_read_b128 v[52:55], v13 offset:34816
    ds_read_b128 v[56:59], v13 offset:36864
    ds_read_b128 v[60:63], v13 offset:38912
    s_waitcnt lgkmcnt(4)
    v_mfma_f32_16x16x32_bf16 v[96:99], v[32:35], v[16:19], v[96:99]
    v_mfma_f32_16x16x32_bf16 v[100:103], v[36:39], v[16:19], v[100:103]
    v_mfma_f32_16x16x32_bf16 v[104:107], v[40:43], v[16:19], v[104:107]
    v_mfma_f32_16x16x32_bf16 v[108:111], v[44:47], v[16:19], v[108:111]
    ds_read_b128 v[64:67], v15 offset:49152
    ds_read_b128 v[68:71], v15 offset:51200
    ds_read_b128 v[72:75], v15 offset:53248
    ds_read_b128 v[76:79], v15 offset:55296
    v_mfma_f32_16x16x32_bf16 v[112:115], v[32:35], v[20:23], v[112:115]
    v_mfma_f32_16x16x32_bf16 v[116:119], v[36:39], v[20:23], v[116:119]
    v_mfma_f32_16x16x32_bf16 v[120:123], v[40:43], v[20:23], v[120:123]
    v_mfma_f32_16x16x32_bf16 v[124:127], v[44:47], v[20:23], v[124:127]
    v_mfma_f32_16x16x32_bf16 v[128:131], v[32:35], v[24:27], v[128:131]
    v_mfma_f32_16x16x32_bf16 v[132:135], v[36:39], v[24:27], v[132:135]
    v_mfma_f32_16x16x32_bf16 v[136:139], v[40:43], v[24:27], v[136:139]
    v_mfma_f32_16x16x32_bf16 v[140:143], v[44:47], v[24:27], v[140:143]
    v_mfma_f32_16x16x32_bf16 v[144:147], v[32:35], v[28:31], v[144:147]
    v_mfma_f32_16x16x32_bf16 v[148:151], v[36:39], v[28:31], v[148:151]
    v_mfma_f32_16x16x32_bf16 v[152:155], v[40:43], v[28:31], v[152:155]
    v_mfma_f32_16x16x32_bf16 v[156:159], v[44:47], v[28:31], v[156:159]
    s_waitcnt lgkmcnt(0)
    v_mfma_f32_16x16x32_bf16 v[96:99], v[64:67], v[48:51], v[96:99]
    v_mfma_f32_16x16x32_bf16 v[100:103], v[68:71], v[48:51], v[100:103]
    v_mfma_f32_16x16x32_bf16 v[104:107], v[72:75], v[48:51], v[104:107]
    v_mfma_f32_16x16x32_bf16 v[108:111], v[76:79], v[48:51], v[108:111]
    v_mfma_f32_16x16x32_bf16 v[112:115], v[64:67], v[52:55], v[112:115]
    v_mfma_f32_16x16x32_bf16 v[116:119], v[68:71], v[52:55], v[116:119]
    v_mfma_f32_16x16x32_bf16 v[120:123], v[72:75], v[52:55], v[120:123]
    v_mfma_f32_16x16x32_bf16 v[124:127], v[76:79], v[52:55], v[124:127]
    v_mfma_f32_16x16x32_bf16 v[128:131], v[64:67], v[56:59], v[128:131]
    v_mfma_f32_16x16x32_bf16 v[132:135], v[68:71], v[56:59], v[132:135]
    v_mfma_f32_16x16x32_bf16 v[136:139], v[72:75], v[56:59], v[136:139]
    v_mfma_f32_16x16x32_bf16 v[140:143], v[76:79], v[56:59], v[140:143]
    v_mfma_f32_16x16x32_bf16 v[144:147], v[64:67], v[60:63], v[144:147]
    v_mfma_f32_16x16x32_bf16 v[148:151], v[68:71], v[60:63], v[148:151]
    v_mfma_f32_16x16x32_bf16 v[152:155], v[72:75], v[60:63], v[152:155]
    v_mfma_f32_16x16x32_bf16 v[156:159], v[76:79], v[60:63], v[156:159]
    s_waitcnt vmcnt(16)
    s_barrier
    s_add_u32 m0, s41, 98304
    s_nop 0
    buffer_load_dwordx4 v2, s[8:11], s30 offen lds
    s_add_u32 s30, s30, 128
    s_add_u32 m0, s38, 114688
    s_nop 0
    buffer_load_dwordx4 v3, s[12:15], s34 offen lds
    s_add_u32 s34, s34, 128
    s_add_u32 m0, s41, 99328
    s_nop 0
    buffer_load_dwordx4 v2, s[8:11], s31 offen lds
    s_add_u32 s31, s31, 128
    s_add_u32 m0, s38, 115712
    s_nop 0
    buffer_load_dwordx4 v3, s[12:15], s35 offen lds
    s_add_u32 s35, s35, 128
    s_add_u32 m0, s41, 100352
    s_nop 0
    buffer_load_dwordx4 v2, s[8:11], s32 offen lds
    s_add_u32 s32, s32, 128
    s_add_u32 m0, s38, 116736
    s_nop 0
    buffer_load_dwordx4 v3, s[12:15], s36 offen lds
    s_add_u32 s36, s36, 128
    s_add_u32 m0, s41, 101376
    s_nop 0
    buffer_load_dwordx4 v2, s[8:11], s33 offen lds
    s_add_u32 s33, s33, 128
    s_add_u32 m0, s38, 117760
    s_nop 0
    buffer_load_dwordx4 v3, s[12:15], s37 offen lds
    s_add_u32 s37, s37, 128
    ds_read_b128 v[16:19], v4 offset:0
    ds_read_b128 v[20:23], v4 offset:2048
    ds_read_b128 v[24:27], v4 offset:4096
    ds_read_b128 v[28:31], v4 offset:6144
    ds_read_b128 v[32:35], v6 offset:16384
    ds_read_b128 v[36:39], v6 offset:18432
    ds_read_b128 v[40:43], v6 offset:20480
    ds_read_b128 v[44:47], v6 offset:22528
    ds_read_b128 v[48:51], v5 offset:0
    ds_read_b128 v[52:55], v5 offset:2048
    ds_read_b128 v[56:59], v5 offset:4096
    ds_read_b128 v[60:63], v5 offset:6144
    s_waitcnt lgkmcnt(4)
    v_mfma_f32_16x16x32_bf16 v[96:99], v[32:35], v[16:19], v[96:99]
    v_mfma_f32_16x16x32_bf16 v[100:103], v[36:39], v[16:19], v[100:103]
    v_mfma_f32_16x16x32_bf16 v[104:107], v[40:43], v[16:19], v[104:107]
    v_mfma_f32_16x16x32_bf16 v[108:111], v[44:47], v[16:19], v[108:111]
    ds_read_b128 v[64:67], v7 offset:16384
    ds_read_b128 v[68:71], v7 offset:18432
    ds_read_b128 v[72:75], v7 offset:20480
    ds_read_b128 v[76:79], v7 offset:22528
    v_mfma_f32_16x16x32_bf16 v[112:115], v[32:35], v[20:23], v[112:115]
    v_mfma_f32_16x16x32_bf16 v[116:119], v[36:39], v[20:23], v[116:119]
    v_mfma_f32_16x16x32_bf16 v[120:123], v[40:43], v[20:23], v[120:123]
    v_mfma_f32_16x16x32_bf16 v[124:127], v[44:47], v[20:23], v[124:127]
    v_mfma_f32_16x16x32_bf16 v[128:131], v[32:35], v[24:27], v[128:131]
    v_mfma_f32_16x16x32_bf16 v[132:135], v[36:39], v[24:27], v[132:135]
    v_mfma_f32_16x16x32_bf16 v[136:139], v[40:43], v[24:27], v[136:139]
    v_mfma_f32_16x16x32_bf16 v[140:143], v[44:47], v[24:27], v[140:143]
    v_mfma_f32_16x16x32_bf16 v[144:147], v[32:35], v[28:31], v[144:147]
    v_mfma_f32_16x16x32_bf16 v[148:151], v[36:39], v[28:31], v[148:151]
    v_mfma_f32_16x16x32_bf16 v[152:155], v[40:43], v[28:31], v[152:155]
    v_mfma_f32_16x16x32_bf16 v[156:159], v[44:47], v[28:31], v[156:159]
    s_waitcnt lgkmcnt(0)
    v_mfma_f32_16x16x32_bf16 v[96:99], v[64:67], v[48:51], v[96:99]
    v_mfma_f32_16x16x32_bf16 v[100:103], v[68:71], v[48:51], v[100:103]
    v_mfma_f32_16x16x32_bf16 v[104:107], v[72:75], v[48:51], v[104:107]
    v_mfma_f32_16x16x32_bf16 v[108:111], v[76:79], v[48:51], v[108:111]
    v_mfma_f32_16x16x32_bf16 v[112:115], v[64:67], v[52:55], v[112:115]
    v_mfma_f32_16x16x32_bf16 v[116:119], v[68:71], v[52:55], v[116:119]
    v_mfma_f32_16x16x32_bf16 v[120:123], v[72:75], v[52:55], v[120:123]
    v_mfma_f32_16x16x32_bf16 v[124:127], v[76:79], v[52:55], v[124:127]
    v_mfma_f32_16x16x32_bf16 v[128:131], v[64:67], v[56:59], v[128:131]
    v_mfma_f32_16x16x32_bf16 v[132:135], v[68:71], v[56:59], v[132:135]
    v_mfma_f32_16x16x32_bf16 v[136:139], v[72:75], v[56:59], v[136:139]
    v_mfma_f32_16x16x32_bf16 v[140:143], v[76:79], v[56:59], v[140:143]
    v_mfma_f32_16x16x32_bf16 v[144:147], v[64:67], v[60:63], v[144:147]
    v_mfma_f32_16x16x32_bf16 v[148:151], v[68:71], v[60:63], v[148:151]
    v_mfma_f32_16x16x32_bf16 v[152:155], v[72:75], v[60:63], v[152:155]
    v_mfma_f32_16x16x32_bf16 v[156:159], v[76:79], v[60:63], v[156:159]
    s_waitcnt vmcnt(16)
    s_barrier
    s_add_u32 m0, s41, 0
    s_nop 0
    buffer_load_dwordx4 v2, s[8:11], s30 offen lds
    s_add_u32 s30, s30, 128
    s_add_u32 m0, s38, 16384
    s_nop 0
    buffer_load_dwordx4 v3, s[12:15], s34 offen lds
    s_add_u32 s34, s34, 128
    s_add_u32 m0, s41, 1024
    s_nop 0
    buffer_load_dwordx4 v2, s[8:11], s31 offen lds
    s_add_u32 s31, s31, 128
    s_add_u32 m0, s38, 17408
    s_nop 0
    buffer_load_dwordx4 v3, s[12:15], s35 offen lds
    s_add_u32 s35, s35, 128
    s_add_u32 m0, s41, 2048
    s_nop 0
    buffer_load_dwordx4 v2, s[8:11], s32 offen lds
    s_add_u32 s32, s32, 128
    s_add_u32 m0, s38, 18432
    s_nop 0
    buffer_load_dwordx4 v3, s[12:15], s36 offen lds
    s_add_u32 s36, s36, 128
    s_add_u32 m0, s41, 3072
    s_nop 0
    buffer_load_dwordx4 v2, s[8:11], s33 offen lds
    s_add_u32 s33, s33, 128
    s_add_u32 m0, s38, 19456
    s_nop 0
    buffer_load_dwordx4 v3, s[12:15], s37 offen lds
    s_add_u32 s37, s37, 128
    ds_read_b128 v[16:19], v4 offset:32768
    ds_read_b128 v[20:23], v4 offset:34816
    ds_read_b128 v[24:27], v4 offset:36864
    ds_read_b128 v[28:31], v4 offset:38912
    ds_read_b128 v[32:35], v6 offset:49152
    ds_read_b128 v[36:39], v6 offset:51200
    ds_read_b128 v[40:43], v6 offset:53248
    ds_read_b128 v[44:47], v6 offset:55296
    ds_read_b128 v[48:51], v5 offset:32768
    ds_read_b128 v[52:55], v5 offset:34816
    ds_read_b128 v[56:59], v5 offset:36864
    ds_read_b128 v[60:63], v5 offset:38912
    s_waitcnt lgkmcnt(4)
    v_mfma_f32_16x16x32_bf16 v[96:99], v[32:35], v[16:19], v[96:99]
    v_mfma_f32_16x16x32_bf16 v[100:103], v[36:39], v[16:19], v[100:103]
    v_mfma_f32_16x16x32_bf16 v[104:107], v[40:43], v[16:19], v[104:107]
    v_mfma_f32_16x16x32_bf16 v[108:111], v[44:47], v[16:19], v[108:111]
    ds_read_b128 v[64:67], v7 offset:49152
    ds_read_b128 v[68:71], v7 offset:51200
    ds_read_b128 v[72:75], v7 offset:53248
    ds_read_b128 v[76:79], v7 offset:55296
    v_mfma_f32_16x16x32_bf16 v[112:115], v[32:35], v[20:23], v[112:115]
    v_mfma_f32_16x16x32_bf16 v[116:119], v[36:39], v[20:23], v[116:119]
    v_mfma_f32_16x16x32_bf16 v[120:123], v[40:43], v[20:23], v[120:123]
    v_mfma_f32_16x16x32_bf16 v[124:127], v[44:47], v[20:23], v[124:127]
    v_mfma_f32_16x16x32_bf16 v[128:131], v[32:35], v[24:27], v[128:131]
    v_mfma_f32_16x16x32_bf16 v[132:135], v[36:39], v[24:27], v[132:135]
    v_mfma_f32_16x16x32_bf16 v[136:139], v[40:43], v[24:27], v[136:139]
    v_mfma_f32_16x16x32_bf16 v[140:143], v[44:47], v[24:27], v[140:143]
    v_mfma_f32_16x16x32_bf16 v[144:147], v[32:35], v[28:31], v[144:147]
    v_mfma_f32_16x16x32_bf16 v[148:151], v[36:39], v[28:31], v[148:151]
    v_mfma_f32_16x16x32_bf16 v[152:155], v[40:43], v[28:31], v[152:155]
    v_mfma_f32_16x16x32_bf16 v[156:159], v[44:47], v[28:31], v[156:159]
    s_waitcnt lgkmcnt(0)
    v_mfma_f32_16x16x32_bf16 v[96:99], v[64:67], v[48:51], v[96:99]
    v_mfma_f32_16x16x32_bf16 v[100:103], v[68:71], v[48:51], v[100:103]
    v_mfma_f32_16x16x32_bf16 v[104:107], v[72:75], v[48:51], v[104:107]
    v_mfma_f32_16x16x32_bf16 v[108:111], v[76:79], v[48:51], v[108:111]
    v_mfma_f32_16x16x32_bf16 v[112:115], v[64:67], v[52:55], v[112:115]
    v_mfma_f32_16x16x32_bf16 v[116:119], v[68:71], v[52:55], v[116:119]
    v_mfma_f32_16x16x32_bf16 v[120:123], v[72:75], v[52:55], v[120:123]
    v_mfma_f32_16x16x32_bf16 v[124:127], v[76:79], v[52:55], v[124:127]
    v_mfma_f32_16x16x32_bf16 v[128:131], v[64:67], v[56:59], v[128:131]
    v_mfma_f32_16x16x32_bf16 v[132:135], v[68:71], v[56:59], v[132:135]
    v_mfma_f32_16x16x32_bf16 v[136:139], v[72:75], v[56:59], v[136:139]
    v_mfma_f32_16x16x32_bf16 v[140:143], v[76:79], v[56:59], v[140:143]
    v_mfma_f32_16x16x32_bf16 v[144:147], v[64:67], v[60:63], v[144:147]
    v_mfma_f32_16x16x32_bf16 v[148:151], v[68:71], v[60:63], v[148:151]
    v_mfma_f32_16x16x32_bf16 v[152:155], v[72:75], v[60:63], v[152:155]
    v_mfma_f32_16x16x32_bf16 v[156:159], v[76:79], v[60:63], v[156:159]
    s_waitcnt vmcnt(16)
    s_barrier
    s_add_u32 m0, s41, 32768
    s_nop 0
    buffer_load_dwordx4 v2, s[8:11], s30 offen lds
    s_add_u32 s30, s30, 128
    s_add_u32 m0, s38, 49152
    s_nop 0
    buffer_load_dwordx4 v3, s[12:15], s34 offen lds
    s_add_u32 s34, s34, 128
    s_add_u32 m0, s41, 33792
    s_nop 0
    buffer_load_dwordx4 v2, s[8:11], s31 offen lds
    s_add_u32 s31, s31, 128
    s_add_u32 m0, s38, 50176
    s_nop 0
    buffer_load_dwordx4 v3, s[12:15], s35 offen lds
    s_add_u32 s35, s35, 128
    s_add_u32 m0, s41, 34816
    s_nop 0
    buffer_load_dwordx4 v2, s[8:11], s32 offen lds
    s_add_u32 s32, s32, 128
    s_add_u32 m0, s38, 51200
    s_nop 0
    buffer_load_dwordx4 v3, s[12:15], s36 offen lds
    s_add_u32 s36, s36, 128
    s_add_u32 m0, s41, 35840
    s_nop 0
    buffer_load_dwordx4 v2, s[8:11], s33 offen lds
    s_add_u32 s33, s33, 128
    s_add_u32 m0, s38, 52224
    s_nop 0
    buffer_load_dwordx4 v3, s[12:15], s37 offen lds
    s_add_u32 s37, s37, 128
    ds_read_b128 v[16:19], v12 offset:0
    ds_read_b128 v[20:23], v12 offset:2048
    ds_read_b128 v[24:27], v12 offset:4096
    ds_read_b128 v[28:31], v12 offset:6144
    ds_read_b128 v[32:35], v14 offset:16384
    ds_read_b128 v[36:39], v14 offset:18432
    ds_read_b128 v[40:43], v14 offset:20480
    ds_read_b128 v[44:47], v14 offset:22528
    ds_read_b128 v[48:51], v13 offset:0
    ds_read_b128 v[52:55], v13 offset:2048
    ds_read_b128 v[56:59], v13 offset:4096
    ds_read_b128 v[60:63], v13 offset:6144
    s_waitcnt lgkmcnt(4)
    v_mfma_f32_16x16x32_bf16 v[96:99], v[32:35], v[16:19], v[96:99]
    v_mfma_f32_16x16x32_bf16 v[100:103], v[36:39], v[16:19], v[100:103]
    v_mfma_f32_16x16x32_bf16 v[104:107], v[40:43], v[16:19], v[104:107]
    v_mfma_f32_16x16x32_bf16 v[108:111], v[44:47], v[16:19], v[108:111]
    ds_read_b128 v[64:67], v15 offset:16384
    ds_read_b128 v[68:71], v15 offset:18432
    ds_read_b128 v[72:75], v15 offset:20480
    ds_read_b128 v[76:79], v15 offset:22528
    v_mfma_f32_16x16x32_bf16 v[112:115], v[32:35], v[20:23], v[112:115]
    v_mfma_f32_16x16x32_bf16 v[116:119], v[36:39], v[20:23], v[116:119]
    v_mfma_f32_16x16x32_bf16 v[120:123], v[40:43], v[20:23], v[120:123]
    v_mfma_f32_16x16x32_bf16 v[124:127], v[44:47], v[20:23], v[124:127]
    v_mfma_f32_16x16x32_bf16 v[128:131], v[32:35], v[24:27], v[128:131]
    v_mfma_f32_16x16x32_bf16 v[132:135], v[36:39], v[24:27], v[132:135]
    v_mfma_f32_16x16x32_bf16 v[136:139], v[40:43], v[24:27], v[136:139]
    v_mfma_f32_16x16x32_bf16 v[140:143], v[44:47], v[24:27], v[140:143]
    v_mfma_f32_16x16x32_bf16 v[144:147], v[32:35], v[28:31], v[144:147]
    v_mfma_f32_16x16x32_bf16 v[148:151], v[36:39], v[28:31], v[148:151]
    v_mfma_f32_16x16x32_bf16 v[152:155], v[40:43], v[28:31], v[152:155]
    v_mfma_f32_16x16x32_bf16 v[156:159], v[44:47], v[28:31], v[156:159]
    s_waitcnt lgkmcnt(0)
    v_mfma_f32_16x16x32_bf16 v[96:99], v[64:67], v[48:51], v[96:99]
    v_mfma_f32_16x16x32_bf16 v[100:103], v[68:71], v[48:51], v[100:103]
    v_mfma_f32_16x16x32_bf16 v[104:107], v[72:75], v[48:51], v[104:107]
    v_mfma_f32_16x16x32_bf16 v[108:111], v[76:79], v[48:51], v[108:111]
    v_mfma_f32_16x16x32_bf16 v[112:115], v[64:67], v[52:55], v[112:115]
    v_mfma_f32_16x16x32_bf16 v[116:119], v[68:71], v[52:55], v[116:119]
    v_mfma_f32_16x16x32_bf16 v[120:123], v[72:75], v[52:55], v[120:123]
    v_mfma_f32_16x16x32_bf16 v[124:127], v[76:79], v[52:55], v[124:127]
    v_mfma_f32_16x16x32_bf16 v[128:131], v[64:67], v[56:59], v[128:131]
    v_mfma_f32_16x16x32_bf16 v[132:135], v[68:71], v[56:59], v[132:135]
    v_mfma_f32_16x16x32_bf16 v[136:139], v[72:75], v[56:59], v[136:139]
    v_mfma_f32_16x16x32_bf16 v[140:143], v[76:79], v[56:59], v[140:143]
    v_mfma_f32_16x16x32_bf16 v[144:147], v[64:67], v[60:63], v[144:147]
    v_mfma_f32_16x16x32_bf16 v[148:151], v[68:71], v[60:63], v[148:151]
    v_mfma_f32_16x16x32_bf16 v[152:155], v[72:75], v[60:63], v[152:155]
    v_mfma_f32_16x16x32_bf16 v[156:159], v[76:79], v[60:63], v[156:159]
    s_waitcnt vmcnt(16)
    s_barrier
    s_add_u32 m0, s41, 65536
    s_nop 0
    buffer_load_dwordx4 v2, s[8:11], s30 offen lds
    s_add_u32 s30, s30, 128
    s_add_u32 m0, s38, 81920
    s_nop 0
    buffer_load_dwordx4 v3, s[12:15], s34 offen lds
    s_add_u32 s34, s34, 128
    s_add_u32 m0, s41, 66560
    s_nop 0
    buffer_load_dwordx4 v2, s[8:11], s31 offen lds
    s_add_u32 s31, s31, 128
    s_add_u32 m0, s38, 82944
    s_nop 0
    buffer_load_dwordx4 v3, s[12:15], s35 offen lds
    s_add_u32 s35, s35, 128
    s_add_u32 m0, s41, 67584
    s_nop 0
    buffer_load_dwordx4 v2, s[8:11], s32 offen lds
    s_add_u32 s32, s32, 128
    s_add_u32 m0, s38, 83968
    s_nop 0
    buffer_load_dwordx4 v3, s[12:15], s36 offen lds
    s_add_u32 s36, s36, 128
    s_add_u32 m0, s41, 68608
    s_nop 0
    buffer_load_dwordx4 v2, s[8:11], s33 offen lds
    s_add_u32 s33, s33, 128
    s_add_u32 m0, s38, 84992
    s_nop 0
    buffer_load_dwordx4 v3, s[12:15], s37 offen lds
    s_add_u32 s37, s37, 128
    ds_read_b128 v[16:19], v12 offset:32768
    ds_read_b128 v[20:23], v12 offset:34816
    ds_read_b128 v[24:27], v12 offset:36864
    ds_read_b128 v[28:31], v12 offset:38912
    ds_read_b128 v[32:35], v14 offset:49152
    ds_read_b128 v[36:39], v14 offset:51200
    ds_read_b128 v[40:43], v14 offset:53248
    ds_read_b128 v[44:47], v14 offset:55296
    ds_read_b128 v[48:51], v13 offset:32768
    ds_read_b128 v[52:55], v13 offset:34816
    ds_read_b128 v[56:59], v13 offset:36864
    ds_read_b128 v[60:63], v13 offset:38912
    s_waitcnt lgkmcnt(4)
    v_mfma_f32_16x16x32_bf16 v[96:99], v[32:35], v[16:19], v[96:99]
    v_mfma_f32_16x16x32_bf16 v[100:103], v[36:39], v[16:19], v[100:103]
    v_mfma_f32_16x16x32_bf16 v[104:107], v[40:43], v[16:19], v[104:107]
    v_mfma_f32_16x16x32_bf16 v[108:111], v[44:47], v[16:19], v[108:111]
    ds_read_b128 v[64:67], v15 offset:49152
    ds_read_b128 v[68:71], v15 offset:51200
    ds_read_b128 v[72:75], v15 offset:53248
    ds_read_b128 v[76:79], v15 offset:55296
    v_mfma_f32_16x16x32_bf16 v[112:115], v[32:35], v[20:23], v[112:115]
    v_mfma_f32_16x16x32_bf16 v[116:119], v[36:39], v[20:23], v[116:119]
    v_mfma_f32_16x16x32_bf16 v[120:123], v[40:43], v[20:23], v[120:123]
    v_mfma_f32_16x16x32_bf16 v[124:127], v[44:47], v[20:23], v[124:127]
    v_mfma_f32_16x16x32_bf16 v[128:131], v[32:35], v[24:27], v[128:131]
    v_mfma_f32_16x16x32_bf16 v[132:135], v[36:39], v[24:27], v[132:135]
    v_mfma_f32_16x16x32_bf16 v[136:139], v[40:43], v[24:27], v[136:139]
    v_mfma_f32_16x16x32_bf16 v[140:143], v[44:47], v[24:27], v[140:143]
    v_mfma_f32_16x16x32_bf16 v[144:147], v[32:35], v[28:31], v[144:147]
    v_mfma_f32_16x16x32_bf16 v[148:151], v[36:39], v[28:31], v[148:151]
    v_mfma_f32_16x16x32_bf16 v[152:155], v[40:43], v[28:31], v[152:155]
    v_mfma_f32_16x16x32_bf16 v[156:159], v[44:47], v[28:31], v[156:159]
    s_waitcnt lgkmcnt(0)
    v_mfma_f32_16x16x32_bf16 v[96:99], v[64:67], v[48:51], v[96:99]
    v_mfma_f32_16x16x32_bf16 v[100:103], v[68:71], v[48:51], v[100:103]
    v_mfma_f32_16x16x32_bf16 v[104:107], v[72:75], v[48:51], v[104:107]
    v_mfma_f32_16x16x32_bf16 v[108:111], v[76:79], v[48:51], v[108:111]
    v_mfma_f32_16x16x32_bf16 v[112:115], v[64:67], v[52:55], v[112:115]
    v_mfma_f32_16x16x32_bf16 v[116:119], v[68:71], v[52:55], v[116:119]
    v_mfma_f32_16x16x32_bf16 v[120:123], v[72:75], v[52:55], v[120:123]
    v_mfma_f32_16x16x32_bf16 v[124:127], v[76:79], v[52:55], v[124:127]
    v_mfma_f32_16x16x32_bf16 v[128:131], v[64:67], v[56:59], v[128:131]
    v_mfma_f32_16x16x32_bf16 v[132:135], v[68:71], v[56:59], v[132:135]
    v_mfma_f32_16x16x32_bf16 v[136:139], v[72:75], v[56:59], v[136:139]
    v_mfma_f32_16x16x32_bf16 v[140:143], v[76:79], v[56:59], v[140:143]
    v_mfma_f32_16x16x32_bf16 v[144:147], v[64:67], v[60:63], v[144:147]
    v_mfma_f32_16x16x32_bf16 v[148:151], v[68:71], v[60:63], v[148:151]
    v_mfma_f32_16x16x32_bf16 v[152:155], v[72:75], v[60:63], v[152:155]
    v_mfma_f32_16x16x32_bf16 v[156:159], v[76:79], v[60:63], v[156:159]
    s_waitcnt vmcnt(16)
    s_barrier
    s_add_u32 m0, s41, 98304
    s_nop 0
    buffer_load_dwordx4 v2, s[8:11], s30 offen lds
    s_add_u32 s30, s30, 128
    s_add_u32 m0, s38, 114688
    s_nop 0
    buffer_load_dwordx4 v3, s[12:15], s34 offen lds
    s_add_u32 s34, s34, 128
    s_add_u32 m0, s41, 99328
    s_nop 0
    buffer_load_dwordx4 v2, s[8:11], s31 offen lds
    s_add_u32 s31, s31, 128
    s_add_u32 m0, s38, 115712
    s_nop 0
    buffer_load_dwordx4 v3, s[12:15], s35 offen lds
    s_add_u32 s35, s35, 128
    s_add_u32 m0, s41, 100352
    s_nop 0
    buffer_load_dwordx4 v2, s[8:11], s32 offen lds
    s_add_u32 s32, s32, 128
    s_add_u32 m0, s38, 116736
    s_nop 0
    buffer_load_dwordx4 v3, s[12:15], s36 offen lds
    s_add_u32 s36, s36, 128
    s_add_u32 m0, s41, 101376
    s_nop 0
    buffer_load_dwordx4 v2, s[8:11], s33 offen lds
    s_add_u32 s33, s33, 128
    s_add_u32 m0, s38, 117760
    s_nop 0
    buffer_load_dwordx4 v3, s[12:15], s37 offen lds
    s_add_u32 s37, s37, 128
    ds_read_b128 v[16:19], v4 offset:0
    ds_read_b128 v[20:23], v4 offset:2048
    ds_read_b128 v[24:27], v4 offset:4096
    ds_read_b128 v[28:31], v4 offset:6144
    ds_read_b128 v[32:35], v6 offset:16384
    ds_read_b128 v[36:39], v6 offset:18432
    ds_read_b128 v[40:43], v6 offset:20480
    ds_read_b128 v[44:47], v6 offset:22528
    ds_read_b128 v[48:51], v5 offset:0
    ds_read_b128 v[52:55], v5 offset:2048
    ds_read_b128 v[56:59], v5 offset:4096
    ds_read_b128 v[60:63], v5 offset:6144
    s_waitcnt lgkmcnt(4)
    v_mfma_f32_16x16x32_bf16 v[96:99], v[32:35], v[16:19], v[96:99]
    v_mfma_f32_16x16x32_bf16 v[100:103], v[36:39], v[16:19], v[100:103]
    v_mfma_f32_16x16x32_bf16 v[104:107], v[40:43], v[16:19], v[104:107]
    v_mfma_f32_16x16x32_bf16 v[108:111], v[44:47], v[16:19], v[108:111]
    ds_read_b128 v[64:67], v7 offset:16384
    ds_read_b128 v[68:71], v7 offset:18432
    ds_read_b128 v[72:75], v7 offset:20480
    ds_read_b128 v[76:79], v7 offset:22528
    v_mfma_f32_16x16x32_bf16 v[112:115], v[32:35], v[20:23], v[112:115]
    v_mfma_f32_16x16x32_bf16 v[116:119], v[36:39], v[20:23], v[116:119]
    v_mfma_f32_16x16x32_bf16 v[120:123], v[40:43], v[20:23], v[120:123]
    v_mfma_f32_16x16x32_bf16 v[124:127], v[44:47], v[20:23], v[124:127]
    v_mfma_f32_16x16x32_bf16 v[128:131], v[32:35], v[24:27], v[128:131]
    v_mfma_f32_16x16x32_bf16 v[132:135], v[36:39], v[24:27], v[132:135]
    v_mfma_f32_16x16x32_bf16 v[136:139], v[40:43], v[24:27], v[136:139]
    v_mfma_f32_16x16x32_bf16 v[140:143], v[44:47], v[24:27], v[140:143]
    v_mfma_f32_16x16x32_bf16 v[144:147], v[32:35], v[28:31], v[144:147]
    v_mfma_f32_16x16x32_bf16 v[148:151], v[36:39], v[28:31], v[148:151]
    v_mfma_f32_16x16x32_bf16 v[152:155], v[40:43], v[28:31], v[152:155]
    v_mfma_f32_16x16x32_bf16 v[156:159], v[44:47], v[28:31], v[156:159]
    s_waitcnt lgkmcnt(0)
    v_mfma_f32_16x16x32_bf16 v[96:99], v[64:67], v[48:51], v[96:99]
    v_mfma_f32_16x16x32_bf16 v[100:103], v[68:71], v[48:51], v[100:103]
    v_mfma_f32_16x16x32_bf16 v[104:107], v[72:75], v[48:51], v[104:107]
    v_mfma_f32_16x16x32_bf16 v[108:111], v[76:79], v[48:51], v[108:111]
    v_mfma_f32_16x16x32_bf16 v[112:115], v[64:67], v[52:55], v[112:115]
    v_mfma_f32_16x16x32_bf16 v[116:119], v[68:71], v[52:55], v[116:119]
    v_mfma_f32_16x16x32_bf16 v[120:123], v[72:75], v[52:55], v[120:123]
    v_mfma_f32_16x16x32_bf16 v[124:127], v[76:79], v[52:55], v[124:127]
    v_mfma_f32_16x16x32_bf16 v[128:131], v[64:67], v[56:59], v[128:131]
    v_mfma_f32_16x16x32_bf16 v[132:135], v[68:71], v[56:59], v[132:135]
    v_mfma_f32_16x16x32_bf16 v[136:139], v[72:75], v[56:59], v[136:139]
    v_mfma_f32_16x16x32_bf16 v[140:143], v[76:79], v[56:59], v[140:143]
    v_mfma_f32_16x16x32_bf16 v[144:147], v[64:67], v[60:63], v[144:147]
    v_mfma_f32_16x16x32_bf16 v[148:151], v[68:71], v[60:63], v[148:151]
    v_mfma_f32_16x16x32_bf16 v[152:155], v[72:75], v[60:63], v[152:155]
    v_mfma_f32_16x16x32_bf16 v[156:159], v[76:79], v[60:63], v[156:159]
    s_waitcnt vmcnt(16)
    s_barrier
    s_add_u32 m0, s41, 0
    s_nop 0
    buffer_load_dwordx4 v2, s[8:11], s30 offen lds
    s_add_u32 s30, s30, 128
    s_add_u32 m0, s38, 16384
    s_nop 0
    buffer_load_dwordx4 v3, s[12:15], s34 offen lds
    s_add_u32 s34, s34, 128
    s_add_u32 m0, s41, 1024
    s_nop 0
    buffer_load_dwordx4 v2, s[8:11], s31 offen lds
    s_add_u32 s31, s31, 128
    s_add_u32 m0, s38, 17408
    s_nop 0
    buffer_load_dwordx4 v3, s[12:15], s35 offen lds
    s_add_u32 s35, s35, 128
    s_add_u32 m0, s41, 2048
    s_nop 0
    buffer_load_dwordx4 v2, s[8:11], s32 offen lds
    s_add_u32 s32, s32, 128
    s_add_u32 m0, s38, 18432
    s_nop 0
    buffer_load_dwordx4 v3, s[12:15], s36 offen lds
    s_add_u32 s36, s36, 128
    s_add_u32 m0, s41, 3072
    s_nop 0
    buffer_load_dwordx4 v2, s[8:11], s33 offen lds
    s_add_u32 s33, s33, 128
    s_add_u32 m0, s38, 19456
    s_nop 0
    buffer_load_dwordx4 v3, s[12:15], s37 offen lds
    s_add_u32 s37, s37, 128
    ds_read_b128 v[16:19], v4 offset:32768
    ds_read_b128 v[20:23], v4 offset:34816
    ds_read_b128 v[24:27], v4 offset:36864
    ds_read_b128 v[28:31], v4 offset:38912
    ds_read_b128 v[32:35], v6 offset:49152
    ds_read_b128 v[36:39], v6 offset:51200
    ds_read_b128 v[40:43], v6 offset:53248
    ds_read_b128 v[44:47], v6 offset:55296
    ds_read_b128 v[48:51], v5 offset:32768
    ds_read_b128 v[52:55], v5 offset:34816
    ds_read_b128 v[56:59], v5 offset:36864
    ds_read_b128 v[60:63], v5 offset:38912
    s_waitcnt lgkmcnt(4)
    v_mfma_f32_16x16x32_bf16 v[96:99], v[32:35], v[16:19], v[96:99]
    v_mfma_f32_16x16x32_bf16 v[100:103], v[36:39], v[16:19], v[100:103]
    v_mfma_f32_16x16x32_bf16 v[104:107], v[40:43], v[16:19], v[104:107]
    v_mfma_f32_16x16x32_bf16 v[108:111], v[44:47], v[16:19], v[108:111]
    ds_read_b128 v[64:67], v7 offset:49152
    ds_read_b128 v[68:71], v7 offset:51200
    ds_read_b128 v[72:75], v7 offset:53248
    ds_read_b128 v[76:79], v7 offset:55296
    v_mfma_f32_16x16x32_bf16 v[112:115], v[32:35], v[20:23], v[112:115]
    v_mfma_f32_16x16x32_bf16 v[116:119], v[36:39], v[20:23], v[116:119]
    v_mfma_f32_16x16x32_bf16 v[120:123], v[40:43], v[20:23], v[120:123]
    v_mfma_f32_16x16x32_bf16 v[124:127], v[44:47], v[20:23], v[124:127]
    v_mfma_f32_16x16x32_bf16 v[128:131], v[32:35], v[24:27], v[128:131]
    v_mfma_f32_16x16x32_bf16 v[132:135], v[36:39], v[24:27], v[132:135]
    v_mfma_f32_16x16x32_bf16 v[136:139], v[40:43], v[24:27], v[136:139]
    v_mfma_f32_16x16x32_bf16 v[140:143], v[44:47], v[24:27], v[140:143]
    v_mfma_f32_16x16x32_bf16 v[144:147], v[32:35], v[28:31], v[144:147]
    v_mfma_f32_16x16x32_bf16 v[148:151], v[36:39], v[28:31], v[148:151]
    v_mfma_f32_16x16x32_bf16 v[152:155], v[40:43], v[28:31], v[152:155]
    v_mfma_f32_16x16x32_bf16 v[156:159], v[44:47], v[28:31], v[156:159]
    s_waitcnt lgkmcnt(0)
    v_mfma_f32_16x16x32_bf16 v[96:99], v[64:67], v[48:51], v[96:99]
    v_mfma_f32_16x16x32_bf16 v[100:103], v[68:71], v[48:51], v[100:103]
    v_mfma_f32_16x16x32_bf16 v[104:107], v[72:75], v[48:51], v[104:107]
    v_mfma_f32_16x16x32_bf16 v[108:111], v[76:79], v[48:51], v[108:111]
    v_mfma_f32_16x16x32_bf16 v[112:115], v[64:67], v[52:55], v[112:115]
    v_mfma_f32_16x16x32_bf16 v[116:119], v[68:71], v[52:55], v[116:119]
    v_mfma_f32_16x16x32_bf16 v[120:123], v[72:75], v[52:55], v[120:123]
    v_mfma_f32_16x16x32_bf16 v[124:127], v[76:79], v[52:55], v[124:127]
    v_mfma_f32_16x16x32_bf16 v[128:131], v[64:67], v[56:59], v[128:131]
    v_mfma_f32_16x16x32_bf16 v[132:135], v[68:71], v[56:59], v[132:135]
    v_mfma_f32_16x16x32_bf16 v[136:139], v[72:75], v[56:59], v[136:139]
    v_mfma_f32_16x16x32_bf16 v[140:143], v[76:79], v[56:59], v[140:143]
    v_mfma_f32_16x16x32_bf16 v[144:147], v[64:67], v[60:63], v[144:147]
    v_mfma_f32_16x16x32_bf16 v[148:151], v[68:71], v[60:63], v[148:151]
    v_mfma_f32_16x16x32_bf16 v[152:155], v[72:75], v[60:63], v[152:155]
    v_mfma_f32_16x16x32_bf16 v[156:159], v[76:79], v[60:63], v[156:159]
    s_waitcnt vmcnt(16)
    s_barrier
    s_add_u32 m0, s41, 32768
    s_nop 0
    buffer_load_dwordx4 v2, s[8:11], s30 offen lds
    s_add_u32 s30, s30, 128
    s_add_u32 m0, s38, 49152
    s_nop 0
    buffer_load_dwordx4 v3, s[12:15], s34 offen lds
    s_add_u32 s34, s34, 128
    s_add_u32 m0, s41, 33792
    s_nop 0
    buffer_load_dwordx4 v2, s[8:11], s31 offen lds
    s_add_u32 s31, s31, 128
    s_add_u32 m0, s38, 50176
    s_nop 0
    buffer_load_dwordx4 v3, s[12:15], s35 offen lds
    s_add_u32 s35, s35, 128
    s_add_u32 m0, s41, 34816
    s_nop 0
    buffer_load_dwordx4 v2, s[8:11], s32 offen lds
    s_add_u32 s32, s32, 128
    s_add_u32 m0, s38, 51200
    s_nop 0
    buffer_load_dwordx4 v3, s[12:15], s36 offen lds
    s_add_u32 s36, s36, 128
    s_add_u32 m0, s41, 35840
    s_nop 0
    buffer_load_dwordx4 v2, s[8:11], s33 offen lds
    s_add_u32 s33, s33, 128
    s_add_u32 m0, s38, 52224
    s_nop 0
    buffer_load_dwordx4 v3, s[12:15], s37 offen lds
    s_add_u32 s37, s37, 128
    ds_read_b128 v[16:19], v12 offset:0
    ds_read_b128 v[20:23], v12 offset:2048
    ds_read_b128 v[24:27], v12 offset:4096
    ds_read_b128 v[28:31], v12 offset:6144
    ds_read_b128 v[32:35], v14 offset:16384
    ds_read_b128 v[36:39], v14 offset:18432
    ds_read_b128 v[40:43], v14 offset:20480
    ds_read_b128 v[44:47], v14 offset:22528
    ds_read_b128 v[48:51], v13 offset:0
    ds_read_b128 v[52:55], v13 offset:2048
    ds_read_b128 v[56:59], v13 offset:4096
    ds_read_b128 v[60:63], v13 offset:6144
    s_waitcnt lgkmcnt(4)
    v_mfma_f32_16x16x32_bf16 v[96:99], v[32:35], v[16:19], v[96:99]
    v_mfma_f32_16x16x32_bf16 v[100:103], v[36:39], v[16:19], v[100:103]
    v_mfma_f32_16x16x32_bf16 v[104:107], v[40:43], v[16:19], v[104:107]
    v_mfma_f32_16x16x32_bf16 v[108:111], v[44:47], v[16:19], v[108:111]
    ds_read_b128 v[64:67], v15 offset:16384
    ds_read_b128 v[68:71], v15 offset:18432
    ds_read_b128 v[72:75], v15 offset:20480
    ds_read_b128 v[76:79], v15 offset:22528
    v_mfma_f32_16x16x32_bf16 v[112:115], v[32:35], v[20:23], v[112:115]
    v_mfma_f32_16x16x32_bf16 v[116:119], v[36:39], v[20:23], v[116:119]
    v_mfma_f32_16x16x32_bf16 v[120:123], v[40:43], v[20:23], v[120:123]
    v_mfma_f32_16x16x32_bf16 v[124:127], v[44:47], v[20:23], v[124:127]
    v_mfma_f32_16x16x32_bf16 v[128:131], v[32:35], v[24:27], v[128:131]
    v_mfma_f32_16x16x32_bf16 v[132:135], v[36:39], v[24:27], v[132:135]
    v_mfma_f32_16x16x32_bf16 v[136:139], v[40:43], v[24:27], v[136:139]
    v_mfma_f32_16x16x32_bf16 v[140:143], v[44:47], v[24:27], v[140:143]
    v_mfma_f32_16x16x32_bf16 v[144:147], v[32:35], v[28:31], v[144:147]
    v_mfma_f32_16x16x32_bf16 v[148:151], v[36:39], v[28:31], v[148:151]
    v_mfma_f32_16x16x32_bf16 v[152:155], v[40:43], v[28:31], v[152:155]
    v_mfma_f32_16x16x32_bf16 v[156:159], v[44:47], v[28:31], v[156:159]
    s_waitcnt lgkmcnt(0)
    v_mfma_f32_16x16x32_bf16 v[96:99], v[64:67], v[48:51], v[96:99]
    v_mfma_f32_16x16x32_bf16 v[100:103], v[68:71], v[48:51], v[100:103]
    v_mfma_f32_16x16x32_bf16 v[104:107], v[72:75], v[48:51], v[104:107]
    v_mfma_f32_16x16x32_bf16 v[108:111], v[76:79], v[48:51], v[108:111]
    v_mfma_f32_16x16x32_bf16 v[112:115], v[64:67], v[52:55], v[112:115]
    v_mfma_f32_16x16x32_bf16 v[116:119], v[68:71], v[52:55], v[116:119]
    v_mfma_f32_16x16x32_bf16 v[120:123], v[72:75], v[52:55], v[120:123]
    v_mfma_f32_16x16x32_bf16 v[124:127], v[76:79], v[52:55], v[124:127]
    v_mfma_f32_16x16x32_bf16 v[128:131], v[64:67], v[56:59], v[128:131]
    v_mfma_f32_16x16x32_bf16 v[132:135], v[68:71], v[56:59], v[132:135]
    v_mfma_f32_16x16x32_bf16 v[136:139], v[72:75], v[56:59], v[136:139]
    v_mfma_f32_16x16x32_bf16 v[140:143], v[76:79], v[56:59], v[140:143]
    v_mfma_f32_16x16x32_bf16 v[144:147], v[64:67], v[60:63], v[144:147]
    v_mfma_f32_16x16x32_bf16 v[148:151], v[68:71], v[60:63], v[148:151]
    v_mfma_f32_16x16x32_bf16 v[152:155], v[72:75], v[60:63], v[152:155]
    v_mfma_f32_16x16x32_bf16 v[156:159], v[76:79], v[60:63], v[156:159]
    s_waitcnt vmcnt(16)
    s_barrier
    s_add_u32 m0, s41, 65536
    s_nop 0
    buffer_load_dwordx4 v2, s[8:11], s30 offen lds
    s_add_u32 s30, s30, 128
    s_add_u32 m0, s38, 81920
    s_nop 0
    buffer_load_dwordx4 v3, s[12:15], s34 offen lds
    s_add_u32 s34, s34, 128
    s_add_u32 m0, s41, 66560
    s_nop 0
    buffer_load_dwordx4 v2, s[8:11], s31 offen lds
    s_add_u32 s31, s31, 128
    s_add_u32 m0, s38, 82944
    s_nop 0
    buffer_load_dwordx4 v3, s[12:15], s35 offen lds
    s_add_u32 s35, s35, 128
    s_add_u32 m0, s41, 67584
    s_nop 0
    buffer_load_dwordx4 v2, s[8:11], s32 offen lds
    s_add_u32 s32, s32, 128
    s_add_u32 m0, s38, 83968
    s_nop 0
    buffer_load_dwordx4 v3, s[12:15], s36 offen lds
    s_add_u32 s36, s36, 128
    s_add_u32 m0, s41, 68608
    s_nop 0
    buffer_load_dwordx4 v2, s[8:11], s33 offen lds
    s_add_u32 s33, s33, 128
    s_add_u32 m0, s38, 84992
    s_nop 0
    buffer_load_dwordx4 v3, s[12:15], s37 offen lds
    s_add_u32 s37, s37, 128
    ds_read_b128 v[16:19], v12 offset:32768
    ds_read_b128 v[20:23], v12 offset:34816
    ds_read_b128 v[24:27], v12 offset:36864
    ds_read_b128 v[28:31], v12 offset:38912
    ds_read_b128 v[32:35], v14 offset:49152
    ds_read_b128 v[36:39], v14 offset:51200
    ds_read_b128 v[40:43], v14 offset:53248
    ds_read_b128 v[44:47], v14 offset:55296
    ds_read_b128 v[48:51], v13 offset:32768
    ds_read_b128 v[52:55], v13 offset:34816
    ds_read_b128 v[56:59], v13 offset:36864
    ds_read_b128 v[60:63], v13 offset:38912
    s_waitcnt lgkmcnt(4)
    v_mfma_f32_16x16x32_bf16 v[96:99], v[32:35], v[16:19], v[96:99]
    v_mfma_f32_16x16x32_bf16 v[100:103], v[36:39], v[16:19], v[100:103]
    v_mfma_f32_16x16x32_bf16 v[104:107], v[40:43], v[16:19], v[104:107]
    v_mfma_f32_16x16x32_bf16 v[108:111], v[44:47], v[16:19], v[108:111]
    ds_read_b128 v[64:67], v15 offset:49152
    ds_read_b128 v[68:71], v15 offset:51200
    ds_read_b128 v[72:75], v15 offset:53248
    ds_read_b128 v[76:79], v15 offset:55296
    v_mfma_f32_16x16x32_bf16 v[112:115], v[32:35], v[20:23], v[112:115]
    v_mfma_f32_16x16x32_bf16 v[116:119], v[36:39], v[20:23], v[116:119]
    v_mfma_f32_16x16x32_bf16 v[120:123], v[40:43], v[20:23], v[120:123]
    v_mfma_f32_16x16x32_bf16 v[124:127], v[44:47], v[20:23], v[124:127]
    v_mfma_f32_16x16x32_bf16 v[128:131], v[32:35], v[24:27], v[128:131]
    v_mfma_f32_16x16x32_bf16 v[132:135], v[36:39], v[24:27], v[132:135]
    v_mfma_f32_16x16x32_bf16 v[136:139], v[40:43], v[24:27], v[136:139]
    v_mfma_f32_16x16x32_bf16 v[140:143], v[44:47], v[24:27], v[140:143]
    v_mfma_f32_16x16x32_bf16 v[144:147], v[32:35], v[28:31], v[144:147]
    v_mfma_f32_16x16x32_bf16 v[148:151], v[36:39], v[28:31], v[148:151]
    v_mfma_f32_16x16x32_bf16 v[152:155], v[40:43], v[28:31], v[152:155]
    v_mfma_f32_16x16x32_bf16 v[156:159], v[44:47], v[28:31], v[156:159]
    s_waitcnt lgkmcnt(0)
    v_mfma_f32_16x16x32_bf16 v[96:99], v[64:67], v[48:51], v[96:99]
    v_mfma_f32_16x16x32_bf16 v[100:103], v[68:71], v[48:51], v[100:103]
    v_mfma_f32_16x16x32_bf16 v[104:107], v[72:75], v[48:51], v[104:107]
    v_mfma_f32_16x16x32_bf16 v[108:111], v[76:79], v[48:51], v[108:111]
    v_mfma_f32_16x16x32_bf16 v[112:115], v[64:67], v[52:55], v[112:115]
    v_mfma_f32_16x16x32_bf16 v[116:119], v[68:71], v[52:55], v[116:119]
    v_mfma_f32_16x16x32_bf16 v[120:123], v[72:75], v[52:55], v[120:123]
    v_mfma_f32_16x16x32_bf16 v[124:127], v[76:79], v[52:55], v[124:127]
    v_mfma_f32_16x16x32_bf16 v[128:131], v[64:67], v[56:59], v[128:131]
    v_mfma_f32_16x16x32_bf16 v[132:135], v[68:71], v[56:59], v[132:135]
    v_mfma_f32_16x16x32_bf16 v[136:139], v[72:75], v[56:59], v[136:139]
    v_mfma_f32_16x16x32_bf16 v[140:143], v[76:79], v[56:59], v[140:143]
    v_mfma_f32_16x16x32_bf16 v[144:147], v[64:67], v[60:63], v[144:147]
    v_mfma_f32_16x16x32_bf16 v[148:151], v[68:71], v[60:63], v[148:151]
    v_mfma_f32_16x16x32_bf16 v[152:155], v[72:75], v[60:63], v[152:155]
    v_mfma_f32_16x16x32_bf16 v[156:159], v[76:79], v[60:63], v[156:159]
    s_waitcnt vmcnt(16)
    s_barrier
    s_add_u32 m0, s41, 98304
    s_nop 0
    buffer_load_dwordx4 v2, s[8:11], s30 offen lds
    s_add_u32 s30, s30, 128
    s_add_u32 m0, s38, 114688
    s_nop 0
    buffer_load_dwordx4 v3, s[12:15], s34 offen lds
    s_add_u32 s34, s34, 128
    s_add_u32 m0, s41, 99328
    s_nop 0
    buffer_load_dwordx4 v2, s[8:11], s31 offen lds
    s_add_u32 s31, s31, 128
    s_add_u32 m0, s38, 115712
    s_nop 0
    buffer_load_dwordx4 v3, s[12:15], s35 offen lds
    s_add_u32 s35, s35, 128
    s_add_u32 m0, s41, 100352
    s_nop 0
    buffer_load_dwordx4 v2, s[8:11], s32 offen lds
    s_add_u32 s32, s32, 128
    s_add_u32 m0, s38, 116736
    s_nop 0
    buffer_load_dwordx4 v3, s[12:15], s36 offen lds
    s_add_u32 s36, s36, 128
    s_add_u32 m0, s41, 101376
    s_nop 0
    buffer_load_dwordx4 v2, s[8:11], s33 offen lds
    s_add_u32 s33, s33, 128
    s_add_u32 m0, s38, 117760
    s_nop 0
    buffer_load_dwordx4 v3, s[12:15], s37 offen lds
    s_add_u32 s37, s37, 128
    ds_read_b128 v[16:19], v4 offset:0
    ds_read_b128 v[20:23], v4 offset:2048
    ds_read_b128 v[24:27], v4 offset:4096
    ds_read_b128 v[28:31], v4 offset:6144
    ds_read_b128 v[32:35], v6 offset:16384
    ds_read_b128 v[36:39], v6 offset:18432
    ds_read_b128 v[40:43], v6 offset:20480
    ds_read_b128 v[44:47], v6 offset:22528
    ds_read_b128 v[48:51], v5 offset:0
    ds_read_b128 v[52:55], v5 offset:2048
    ds_read_b128 v[56:59], v5 offset:4096
    ds_read_b128 v[60:63], v5 offset:6144
    s_waitcnt lgkmcnt(4)
    v_mfma_f32_16x16x32_bf16 v[96:99], v[32:35], v[16:19], v[96:99]
    v_mfma_f32_16x16x32_bf16 v[100:103], v[36:39], v[16:19], v[100:103]
    v_mfma_f32_16x16x32_bf16 v[104:107], v[40:43], v[16:19], v[104:107]
    v_mfma_f32_16x16x32_bf16 v[108:111], v[44:47], v[16:19], v[108:111]
    ds_read_b128 v[64:67], v7 offset:16384
    ds_read_b128 v[68:71], v7 offset:18432
    ds_read_b128 v[72:75], v7 offset:20480
    ds_read_b128 v[76:79], v7 offset:22528
    v_mfma_f32_16x16x32_bf16 v[112:115], v[32:35], v[20:23], v[112:115]
    v_mfma_f32_16x16x32_bf16 v[116:119], v[36:39], v[20:23], v[116:119]
    v_mfma_f32_16x16x32_bf16 v[120:123], v[40:43], v[20:23], v[120:123]
    v_mfma_f32_16x16x32_bf16 v[124:127], v[44:47], v[20:23], v[124:127]
    v_mfma_f32_16x16x32_bf16 v[128:131], v[32:35], v[24:27], v[128:131]
    v_mfma_f32_16x16x32_bf16 v[132:135], v[36:39], v[24:27], v[132:135]
    v_mfma_f32_16x16x32_bf16 v[136:139], v[40:43], v[24:27], v[136:139]
    v_mfma_f32_16x16x32_bf16 v[140:143], v[44:47], v[24:27], v[140:143]
    v_mfma_f32_16x16x32_bf16 v[144:147], v[32:35], v[28:31], v[144:147]
    v_mfma_f32_16x16x32_bf16 v[148:151], v[36:39], v[28:31], v[148:151]
    v_mfma_f32_16x16x32_bf16 v[152:155], v[40:43], v[28:31], v[152:155]
    v_mfma_f32_16x16x32_bf16 v[156:159], v[44:47], v[28:31], v[156:159]
    s_waitcnt lgkmcnt(0)
    v_mfma_f32_16x16x32_bf16 v[96:99], v[64:67], v[48:51], v[96:99]
    v_mfma_f32_16x16x32_bf16 v[100:103], v[68:71], v[48:51], v[100:103]
    v_mfma_f32_16x16x32_bf16 v[104:107], v[72:75], v[48:51], v[104:107]
    v_mfma_f32_16x16x32_bf16 v[108:111], v[76:79], v[48:51], v[108:111]
    v_mfma_f32_16x16x32_bf16 v[112:115], v[64:67], v[52:55], v[112:115]
    v_mfma_f32_16x16x32_bf16 v[116:119], v[68:71], v[52:55], v[116:119]
    v_mfma_f32_16x16x32_bf16 v[120:123], v[72:75], v[52:55], v[120:123]
    v_mfma_f32_16x16x32_bf16 v[124:127], v[76:79], v[52:55], v[124:127]
    v_mfma_f32_16x16x32_bf16 v[128:131], v[64:67], v[56:59], v[128:131]
    v_mfma_f32_16x16x32_bf16 v[132:135], v[68:71], v[56:59], v[132:135]
    v_mfma_f32_16x16x32_bf16 v[136:139], v[72:75], v[56:59], v[136:139]
    v_mfma_f32_16x16x32_bf16 v[140:143], v[76:79], v[56:59], v[140:143]
    v_mfma_f32_16x16x32_bf16 v[144:147], v[64:67], v[60:63], v[144:147]
    v_mfma_f32_16x16x32_bf16 v[148:151], v[68:71], v[60:63], v[148:151]
    v_mfma_f32_16x16x32_bf16 v[152:155], v[72:75], v[60:63], v[152:155]
    v_mfma_f32_16x16x32_bf16 v[156:159], v[76:79], v[60:63], v[156:159]
    s_waitcnt vmcnt(16)
    s_barrier
    s_add_u32 m0, s41, 0
    s_nop 0
    buffer_load_dwordx4 v2, s[8:11], s30 offen lds
    s_add_u32 s30, s30, 128
    s_add_u32 m0, s38, 16384
    s_nop 0
    buffer_load_dwordx4 v3, s[12:15], s34 offen lds
    s_add_u32 s34, s34, 128
    s_add_u32 m0, s41, 1024
    s_nop 0
    buffer_load_dwordx4 v2, s[8:11], s31 offen lds
    s_add_u32 s31, s31, 128
    s_add_u32 m0, s38, 17408
    s_nop 0
    buffer_load_dwordx4 v3, s[12:15], s35 offen lds
    s_add_u32 s35, s35, 128
    s_add_u32 m0, s41, 2048
    s_nop 0
    buffer_load_dwordx4 v2, s[8:11], s32 offen lds
    s_add_u32 s32, s32, 128
    s_add_u32 m0, s38, 18432
    s_nop 0
    buffer_load_dwordx4 v3, s[12:15], s36 offen lds
    s_add_u32 s36, s36, 128
    s_add_u32 m0, s41, 3072
    s_nop 0
    buffer_load_dwordx4 v2, s[8:11], s33 offen lds
    s_add_u32 s33, s33, 128
    s_add_u32 m0, s38, 19456
    s_nop 0
    buffer_load_dwordx4 v3, s[12:15], s37 offen lds
    s_add_u32 s37, s37, 128
    ds_read_b128 v[16:19], v4 offset:32768
    ds_read_b128 v[20:23], v4 offset:34816
    ds_read_b128 v[24:27], v4 offset:36864
    ds_read_b128 v[28:31], v4 offset:38912
    ds_read_b128 v[32:35], v6 offset:49152
    ds_read_b128 v[36:39], v6 offset:51200
    ds_read_b128 v[40:43], v6 offset:53248
    ds_read_b128 v[44:47], v6 offset:55296
    ds_read_b128 v[48:51], v5 offset:32768
    ds_read_b128 v[52:55], v5 offset:34816
    ds_read_b128 v[56:59], v5 offset:36864
    ds_read_b128 v[60:63], v5 offset:38912
    s_waitcnt lgkmcnt(4)
    v_mfma_f32_16x16x32_bf16 v[96:99], v[32:35], v[16:19], v[96:99]
    v_mfma_f32_16x16x32_bf16 v[100:103], v[36:39], v[16:19], v[100:103]
    v_mfma_f32_16x16x32_bf16 v[104:107], v[40:43], v[16:19], v[104:107]
    v_mfma_f32_16x16x32_bf16 v[108:111], v[44:47], v[16:19], v[108:111]
    ds_read_b128 v[64:67], v7 offset:49152
    ds_read_b128 v[68:71], v7 offset:51200
    ds_read_b128 v[72:75], v7 offset:53248
    ds_read_b128 v[76:79], v7 offset:55296
    v_mfma_f32_16x16x32_bf16 v[112:115], v[32:35], v[20:23], v[112:115]
    v_mfma_f32_16x16x32_bf16 v[116:119], v[36:39], v[20:23], v[116:119]
    v_mfma_f32_16x16x32_bf16 v[120:123], v[40:43], v[20:23], v[120:123]
    v_mfma_f32_16x16x32_bf16 v[124:127], v[44:47], v[20:23], v[124:127]
    v_mfma_f32_16x16x32_bf16 v[128:131], v[32:35], v[24:27], v[128:131]
    v_mfma_f32_16x16x32_bf16 v[132:135], v[36:39], v[24:27], v[132:135]
    v_mfma_f32_16x16x32_bf16 v[136:139], v[40:43], v[24:27], v[136:139]
    v_mfma_f32_16x16x32_bf16 v[140:143], v[44:47], v[24:27], v[140:143]
    v_mfma_f32_16x16x32_bf16 v[144:147], v[32:35], v[28:31], v[144:147]
    v_mfma_f32_16x16x32_bf16 v[148:151], v[36:39], v[28:31], v[148:151]
    v_mfma_f32_16x16x32_bf16 v[152:155], v[40:43], v[28:31], v[152:155]
    v_mfma_f32_16x16x32_bf16 v[156:159], v[44:47], v[28:31], v[156:159]
    s_waitcnt lgkmcnt(0)
    v_mfma_f32_16x16x32_bf16 v[96:99], v[64:67], v[48:51], v[96:99]
    v_mfma_f32_16x16x32_bf16 v[100:103], v[68:71], v[48:51], v[100:103]
    v_mfma_f32_16x16x32_bf16 v[104:107], v[72:75], v[48:51], v[104:107]
    v_mfma_f32_16x16x32_bf16 v[108:111], v[76:79], v[48:51], v[108:111]
    v_mfma_f32_16x16x32_bf16 v[112:115], v[64:67], v[52:55], v[112:115]
    v_mfma_f32_16x16x32_bf16 v[116:119], v[68:71], v[52:55], v[116:119]
    v_mfma_f32_16x16x32_bf16 v[120:123], v[72:75], v[52:55], v[120:123]
    v_mfma_f32_16x16x32_bf16 v[124:127], v[76:79], v[52:55], v[124:127]
    v_mfma_f32_16x16x32_bf16 v[128:131], v[64:67], v[56:59], v[128:131]
    v_mfma_f32_16x16x32_bf16 v[132:135], v[68:71], v[56:59], v[132:135]
    v_mfma_f32_16x16x32_bf16 v[136:139], v[72:75], v[56:59], v[136:139]
    v_mfma_f32_16x16x32_bf16 v[140:143], v[76:79], v[56:59], v[140:143]
    v_mfma_f32_16x16x32_bf16 v[144:147], v[64:67], v[60:63], v[144:147]
    v_mfma_f32_16x16x32_bf16 v[148:151], v[68:71], v[60:63], v[148:151]
    v_mfma_f32_16x16x32_bf16 v[152:155], v[72:75], v[60:63], v[152:155]
    v_mfma_f32_16x16x32_bf16 v[156:159], v[76:79], v[60:63], v[156:159]
    s_waitcnt vmcnt(16)
    s_barrier
    s_add_u32 m0, s41, 32768
    s_nop 0
    buffer_load_dwordx4 v2, s[8:11], s30 offen lds
    s_add_u32 s30, s30, 128
    s_add_u32 m0, s38, 49152
    s_nop 0
    buffer_load_dwordx4 v3, s[12:15], s34 offen lds
    s_add_u32 s34, s34, 128
    s_add_u32 m0, s41, 33792
    s_nop 0
    buffer_load_dwordx4 v2, s[8:11], s31 offen lds
    s_add_u32 s31, s31, 128
    s_add_u32 m0, s38, 50176
    s_nop 0
    buffer_load_dwordx4 v3, s[12:15], s35 offen lds
    s_add_u32 s35, s35, 128
    s_add_u32 m0, s41, 34816
    s_nop 0
    buffer_load_dwordx4 v2, s[8:11], s32 offen lds
    s_add_u32 s32, s32, 128
    s_add_u32 m0, s38, 51200
    s_nop 0
    buffer_load_dwordx4 v3, s[12:15], s36 offen lds
    s_add_u32 s36, s36, 128
    s_add_u32 m0, s41, 35840
    s_nop 0
    buffer_load_dwordx4 v2, s[8:11], s33 offen lds
    s_add_u32 s33, s33, 128
    s_add_u32 m0, s38, 52224
    s_nop 0
    buffer_load_dwordx4 v3, s[12:15], s37 offen lds
    s_add_u32 s37, s37, 128
    ds_read_b128 v[16:19], v12 offset:0
    ds_read_b128 v[20:23], v12 offset:2048
    ds_read_b128 v[24:27], v12 offset:4096
    ds_read_b128 v[28:31], v12 offset:6144
    ds_read_b128 v[32:35], v14 offset:16384
    ds_read_b128 v[36:39], v14 offset:18432
    ds_read_b128 v[40:43], v14 offset:20480
    ds_read_b128 v[44:47], v14 offset:22528
    ds_read_b128 v[48:51], v13 offset:0
    ds_read_b128 v[52:55], v13 offset:2048
    ds_read_b128 v[56:59], v13 offset:4096
    ds_read_b128 v[60:63], v13 offset:6144
    s_waitcnt lgkmcnt(4)
    v_mfma_f32_16x16x32_bf16 v[96:99], v[32:35], v[16:19], v[96:99]
    v_mfma_f32_16x16x32_bf16 v[100:103], v[36:39], v[16:19], v[100:103]
    v_mfma_f32_16x16x32_bf16 v[104:107], v[40:43], v[16:19], v[104:107]
    v_mfma_f32_16x16x32_bf16 v[108:111], v[44:47], v[16:19], v[108:111]
    ds_read_b128 v[64:67], v15 offset:16384
    ds_read_b128 v[68:71], v15 offset:18432
    ds_read_b128 v[72:75], v15 offset:20480
    ds_read_b128 v[76:79], v15 offset:22528
    v_mfma_f32_16x16x32_bf16 v[112:115], v[32:35], v[20:23], v[112:115]
    v_mfma_f32_16x16x32_bf16 v[116:119], v[36:39], v[20:23], v[116:119]
    v_mfma_f32_16x16x32_bf16 v[120:123], v[40:43], v[20:23], v[120:123]
    v_mfma_f32_16x16x32_bf16 v[124:127], v[44:47], v[20:23], v[124:127]
    v_mfma_f32_16x16x32_bf16 v[128:131], v[32:35], v[24:27], v[128:131]
    v_mfma_f32_16x16x32_bf16 v[132:135], v[36:39], v[24:27], v[132:135]
    v_mfma_f32_16x16x32_bf16 v[136:139], v[40:43], v[24:27], v[136:139]
    v_mfma_f32_16x16x32_bf16 v[140:143], v[44:47], v[24:27], v[140:143]
    v_mfma_f32_16x16x32_bf16 v[144:147], v[32:35], v[28:31], v[144:147]
    v_mfma_f32_16x16x32_bf16 v[148:151], v[36:39], v[28:31], v[148:151]
    v_mfma_f32_16x16x32_bf16 v[152:155], v[40:43], v[28:31], v[152:155]
    v_mfma_f32_16x16x32_bf16 v[156:159], v[44:47], v[28:31], v[156:159]
    s_waitcnt lgkmcnt(0)
    v_mfma_f32_16x16x32_bf16 v[96:99], v[64:67], v[48:51], v[96:99]
    v_mfma_f32_16x16x32_bf16 v[100:103], v[68:71], v[48:51], v[100:103]
    v_mfma_f32_16x16x32_bf16 v[104:107], v[72:75], v[48:51], v[104:107]
    v_mfma_f32_16x16x32_bf16 v[108:111], v[76:79], v[48:51], v[108:111]
    v_mfma_f32_16x16x32_bf16 v[112:115], v[64:67], v[52:55], v[112:115]
    v_mfma_f32_16x16x32_bf16 v[116:119], v[68:71], v[52:55], v[116:119]
    v_mfma_f32_16x16x32_bf16 v[120:123], v[72:75], v[52:55], v[120:123]
    v_mfma_f32_16x16x32_bf16 v[124:127], v[76:79], v[52:55], v[124:127]
    v_mfma_f32_16x16x32_bf16 v[128:131], v[64:67], v[56:59], v[128:131]
    v_mfma_f32_16x16x32_bf16 v[132:135], v[68:71], v[56:59], v[132:135]
    v_mfma_f32_16x16x32_bf16 v[136:139], v[72:75], v[56:59], v[136:139]
    v_mfma_f32_16x16x32_bf16 v[140:143], v[76:79], v[56:59], v[140:143]
    v_mfma_f32_16x16x32_bf16 v[144:147], v[64:67], v[60:63], v[144:147]
    v_mfma_f32_16x16x32_bf16 v[148:151], v[68:71], v[60:63], v[148:151]
    v_mfma_f32_16x16x32_bf16 v[152:155], v[72:75], v[60:63], v[152:155]
    v_mfma_f32_16x16x32_bf16 v[156:159], v[76:79], v[60:63], v[156:159]
    s_waitcnt vmcnt(16)
    s_barrier
    s_add_u32 m0, s41, 65536
    s_nop 0
    buffer_load_dwordx4 v2, s[8:11], s30 offen lds
    s_add_u32 s30, s30, 128
    s_add_u32 m0, s38, 81920
    s_nop 0
    buffer_load_dwordx4 v3, s[12:15], s34 offen lds
    s_add_u32 s34, s34, 128
    s_add_u32 m0, s41, 66560
    s_nop 0
    buffer_load_dwordx4 v2, s[8:11], s31 offen lds
    s_add_u32 s31, s31, 128
    s_add_u32 m0, s38, 82944
    s_nop 0
    buffer_load_dwordx4 v3, s[12:15], s35 offen lds
    s_add_u32 s35, s35, 128
    s_add_u32 m0, s41, 67584
    s_nop 0
    buffer_load_dwordx4 v2, s[8:11], s32 offen lds
    s_add_u32 s32, s32, 128
    s_add_u32 m0, s38, 83968
    s_nop 0
    buffer_load_dwordx4 v3, s[12:15], s36 offen lds
    s_add_u32 s36, s36, 128
    s_add_u32 m0, s41, 68608
    s_nop 0
    buffer_load_dwordx4 v2, s[8:11], s33 offen lds
    s_add_u32 s33, s33, 128
    s_add_u32 m0, s38, 84992
    s_nop 0
    buffer_load_dwordx4 v3, s[12:15], s37 offen lds
    s_add_u32 s37, s37, 128
    ds_read_b128 v[16:19], v12 offset:32768
    ds_read_b128 v[20:23], v12 offset:34816
    ds_read_b128 v[24:27], v12 offset:36864
    ds_read_b128 v[28:31], v12 offset:38912
    ds_read_b128 v[32:35], v14 offset:49152
    ds_read_b128 v[36:39], v14 offset:51200
    ds_read_b128 v[40:43], v14 offset:53248
    ds_read_b128 v[44:47], v14 offset:55296
    ds_read_b128 v[48:51], v13 offset:32768
    ds_read_b128 v[52:55], v13 offset:34816
    ds_read_b128 v[56:59], v13 offset:36864
    ds_read_b128 v[60:63], v13 offset:38912
    s_waitcnt lgkmcnt(4)
    v_mfma_f32_16x16x32_bf16 v[96:99], v[32:35], v[16:19], v[96:99]
    v_mfma_f32_16x16x32_bf16 v[100:103], v[36:39], v[16:19], v[100:103]
    v_mfma_f32_16x16x32_bf16 v[104:107], v[40:43], v[16:19], v[104:107]
    v_mfma_f32_16x16x32_bf16 v[108:111], v[44:47], v[16:19], v[108:111]
    ds_read_b128 v[64:67], v15 offset:49152
    ds_read_b128 v[68:71], v15 offset:51200
    ds_read_b128 v[72:75], v15 offset:53248
    ds_read_b128 v[76:79], v15 offset:55296
    v_mfma_f32_16x16x32_bf16 v[112:115], v[32:35], v[20:23], v[112:115]
    v_mfma_f32_16x16x32_bf16 v[116:119], v[36:39], v[20:23], v[116:119]
    v_mfma_f32_16x16x32_bf16 v[120:123], v[40:43], v[20:23], v[120:123]
    v_mfma_f32_16x16x32_bf16 v[124:127], v[44:47], v[20:23], v[124:127]
    v_mfma_f32_16x16x32_bf16 v[128:131], v[32:35], v[24:27], v[128:131]
    v_mfma_f32_16x16x32_bf16 v[132:135], v[36:39], v[24:27], v[132:135]
    v_mfma_f32_16x16x32_bf16 v[136:139], v[40:43], v[24:27], v[136:139]
    v_mfma_f32_16x16x32_bf16 v[140:143], v[44:47], v[24:27], v[140:143]
    v_mfma_f32_16x16x32_bf16 v[144:147], v[32:35], v[28:31], v[144:147]
    v_mfma_f32_16x16x32_bf16 v[148:151], v[36:39], v[28:31], v[148:151]
    v_mfma_f32_16x16x32_bf16 v[152:155], v[40:43], v[28:31], v[152:155]
    v_mfma_f32_16x16x32_bf16 v[156:159], v[44:47], v[28:31], v[156:159]
    s_waitcnt lgkmcnt(0)
    v_mfma_f32_16x16x32_bf16 v[96:99], v[64:67], v[48:51], v[96:99]
    v_mfma_f32_16x16x32_bf16 v[100:103], v[68:71], v[48:51], v[100:103]
    v_mfma_f32_16x16x32_bf16 v[104:107], v[72:75], v[48:51], v[104:107]
    v_mfma_f32_16x16x32_bf16 v[108:111], v[76:79], v[48:51], v[108:111]
    v_mfma_f32_16x16x32_bf16 v[112:115], v[64:67], v[52:55], v[112:115]
    v_mfma_f32_16x16x32_bf16 v[116:119], v[68:71], v[52:55], v[116:119]
    v_mfma_f32_16x16x32_bf16 v[120:123], v[72:75], v[52:55], v[120:123]
    v_mfma_f32_16x16x32_bf16 v[124:127], v[76:79], v[52:55], v[124:127]
    v_mfma_f32_16x16x32_bf16 v[128:131], v[64:67], v[56:59], v[128:131]
    v_mfma_f32_16x16x32_bf16 v[132:135], v[68:71], v[56:59], v[132:135]
    v_mfma_f32_16x16x32_bf16 v[136:139], v[72:75], v[56:59], v[136:139]
    v_mfma_f32_16x16x32_bf16 v[140:143], v[76:79], v[56:59], v[140:143]
    v_mfma_f32_16x16x32_bf16 v[144:147], v[64:67], v[60:63], v[144:147]
    v_mfma_f32_16x16x32_bf16 v[148:151], v[68:71], v[60:63], v[148:151]
    v_mfma_f32_16x16x32_bf16 v[152:155], v[72:75], v[60:63], v[152:155]
    v_mfma_f32_16x16x32_bf16 v[156:159], v[76:79], v[60:63], v[156:159]
    s_waitcnt vmcnt(16)
    s_barrier
    s_add_u32 m0, s41, 98304
    s_nop 0
    buffer_load_dwordx4 v2, s[8:11], s30 offen lds
    s_add_u32 s30, s30, 128
    s_add_u32 m0, s38, 114688
    s_nop 0
    buffer_load_dwordx4 v3, s[12:15], s34 offen lds
    s_add_u32 s34, s34, 128
    s_add_u32 m0, s41, 99328
    s_nop 0
    buffer_load_dwordx4 v2, s[8:11], s31 offen lds
    s_add_u32 s31, s31, 128
    s_add_u32 m0, s38, 115712
    s_nop 0
    buffer_load_dwordx4 v3, s[12:15], s35 offen lds
    s_add_u32 s35, s35, 128
    s_add_u32 m0, s41, 100352
    s_nop 0
    buffer_load_dwordx4 v2, s[8:11], s32 offen lds
    s_add_u32 s32, s32, 128
    s_add_u32 m0, s38, 116736
    s_nop 0
    buffer_load_dwordx4 v3, s[12:15], s36 offen lds
    s_add_u32 s36, s36, 128
    s_add_u32 m0, s41, 101376
    s_nop 0
    buffer_load_dwordx4 v2, s[8:11], s33 offen lds
    s_add_u32 s33, s33, 128
    s_add_u32 m0, s38, 117760
    s_nop 0
    buffer_load_dwordx4 v3, s[12:15], s37 offen lds
    s_add_u32 s37, s37, 128
    ds_read_b128 v[16:19], v4 offset:0
    ds_read_b128 v[20:23], v4 offset:2048
    ds_read_b128 v[24:27], v4 offset:4096
    ds_read_b128 v[28:31], v4 offset:6144
    ds_read_b128 v[32:35], v6 offset:16384
    ds_read_b128 v[36:39], v6 offset:18432
    ds_read_b128 v[40:43], v6 offset:20480
    ds_read_b128 v[44:47], v6 offset:22528
    ds_read_b128 v[48:51], v5 offset:0
    ds_read_b128 v[52:55], v5 offset:2048
    ds_read_b128 v[56:59], v5 offset:4096
    ds_read_b128 v[60:63], v5 offset:6144
    s_waitcnt lgkmcnt(4)
    v_mfma_f32_16x16x32_bf16 v[96:99], v[32:35], v[16:19], v[96:99]
    v_mfma_f32_16x16x32_bf16 v[100:103], v[36:39], v[16:19], v[100:103]
    v_mfma_f32_16x16x32_bf16 v[104:107], v[40:43], v[16:19], v[104:107]
    v_mfma_f32_16x16x32_bf16 v[108:111], v[44:47], v[16:19], v[108:111]
    ds_read_b128 v[64:67], v7 offset:16384
    ds_read_b128 v[68:71], v7 offset:18432
    ds_read_b128 v[72:75], v7 offset:20480
    ds_read_b128 v[76:79], v7 offset:22528
    v_mfma_f32_16x16x32_bf16 v[112:115], v[32:35], v[20:23], v[112:115]
    v_mfma_f32_16x16x32_bf16 v[116:119], v[36:39], v[20:23], v[116:119]
    v_mfma_f32_16x16x32_bf16 v[120:123], v[40:43], v[20:23], v[120:123]
    v_mfma_f32_16x16x32_bf16 v[124:127], v[44:47], v[20:23], v[124:127]
    v_mfma_f32_16x16x32_bf16 v[128:131], v[32:35], v[24:27], v[128:131]
    v_mfma_f32_16x16x32_bf16 v[132:135], v[36:39], v[24:27], v[132:135]
    v_mfma_f32_16x16x32_bf16 v[136:139], v[40:43], v[24:27], v[136:139]
    v_mfma_f32_16x16x32_bf16 v[140:143], v[44:47], v[24:27], v[140:143]
    v_mfma_f32_16x16x32_bf16 v[144:147], v[32:35], v[28:31], v[144:147]
    v_mfma_f32_16x16x32_bf16 v[148:151], v[36:39], v[28:31], v[148:151]
    v_mfma_f32_16x16x32_bf16 v[152:155], v[40:43], v[28:31], v[152:155]
    v_mfma_f32_16x16x32_bf16 v[156:159], v[44:47], v[28:31], v[156:159]
    s_waitcnt lgkmcnt(0)
    v_mfma_f32_16x16x32_bf16 v[96:99], v[64:67], v[48:51], v[96:99]
    v_mfma_f32_16x16x32_bf16 v[100:103], v[68:71], v[48:51], v[100:103]
    v_mfma_f32_16x16x32_bf16 v[104:107], v[72:75], v[48:51], v[104:107]
    v_mfma_f32_16x16x32_bf16 v[108:111], v[76:79], v[48:51], v[108:111]
    v_mfma_f32_16x16x32_bf16 v[112:115], v[64:67], v[52:55], v[112:115]
    v_mfma_f32_16x16x32_bf16 v[116:119], v[68:71], v[52:55], v[116:119]
    v_mfma_f32_16x16x32_bf16 v[120:123], v[72:75], v[52:55], v[120:123]
    v_mfma_f32_16x16x32_bf16 v[124:127], v[76:79], v[52:55], v[124:127]
    v_mfma_f32_16x16x32_bf16 v[128:131], v[64:67], v[56:59], v[128:131]
    v_mfma_f32_16x16x32_bf16 v[132:135], v[68:71], v[56:59], v[132:135]
    v_mfma_f32_16x16x32_bf16 v[136:139], v[72:75], v[56:59], v[136:139]
    v_mfma_f32_16x16x32_bf16 v[140:143], v[76:79], v[56:59], v[140:143]
    v_mfma_f32_16x16x32_bf16 v[144:147], v[64:67], v[60:63], v[144:147]
    v_mfma_f32_16x16x32_bf16 v[148:151], v[68:71], v[60:63], v[148:151]
    v_mfma_f32_16x16x32_bf16 v[152:155], v[72:75], v[60:63], v[152:155]
    v_mfma_f32_16x16x32_bf16 v[156:159], v[76:79], v[60:63], v[156:159]
    s_waitcnt vmcnt(16)
    s_barrier
    ds_read_b128 v[16:19], v4 offset:32768
    ds_read_b128 v[20:23], v4 offset:34816
    ds_read_b128 v[24:27], v4 offset:36864
    ds_read_b128 v[28:31], v4 offset:38912
    ds_read_b128 v[32:35], v6 offset:49152
    ds_read_b128 v[36:39], v6 offset:51200
    ds_read_b128 v[40:43], v6 offset:53248
    ds_read_b128 v[44:47], v6 offset:55296
    ds_read_b128 v[48:51], v5 offset:32768
    ds_read_b128 v[52:55], v5 offset:34816
    ds_read_b128 v[56:59], v5 offset:36864
    ds_read_b128 v[60:63], v5 offset:38912
    s_waitcnt lgkmcnt(4)
    v_mfma_f32_16x16x32_bf16 v[96:99], v[32:35], v[16:19], v[96:99]
    v_mfma_f32_16x16x32_bf16 v[100:103], v[36:39], v[16:19], v[100:103]
    v_mfma_f32_16x16x32_bf16 v[104:107], v[40:43], v[16:19], v[104:107]
    v_mfma_f32_16x16x32_bf16 v[108:111], v[44:47], v[16:19], v[108:111]
    ds_read_b128 v[64:67], v7 offset:49152
    ds_read_b128 v[68:71], v7 offset:51200
    ds_read_b128 v[72:75], v7 offset:53248
    ds_read_b128 v[76:79], v7 offset:55296
    v_mfma_f32_16x16x32_bf16 v[112:115], v[32:35], v[20:23], v[112:115]
    v_mfma_f32_16x16x32_bf16 v[116:119], v[36:39], v[20:23], v[116:119]
    v_mfma_f32_16x16x32_bf16 v[120:123], v[40:43], v[20:23], v[120:123]
    v_mfma_f32_16x16x32_bf16 v[124:127], v[44:47], v[20:23], v[124:127]
    v_mfma_f32_16x16x32_bf16 v[128:131], v[32:35], v[24:27], v[128:131]
    v_mfma_f32_16x16x32_bf16 v[132:135], v[36:39], v[24:27], v[132:135]
    v_mfma_f32_16x16x32_bf16 v[136:139], v[40:43], v[24:27], v[136:139]
    v_mfma_f32_16x16x32_bf16 v[140:143], v[44:47], v[24:27], v[140:143]
    v_mfma_f32_16x16x32_bf16 v[144:147], v[32:35], v[28:31], v[144:147]
    v_mfma_f32_16x16x32_bf16 v[148:151], v[36:39], v[28:31], v[148:151]
    v_mfma_f32_16x16x32_bf16 v[152:155], v[40:43], v[28:31], v[152:155]
    v_mfma_f32_16x16x32_bf16 v[156:159], v[44:47], v[28:31], v[156:159]
    s_waitcnt lgkmcnt(0)
    v_mfma_f32_16x16x32_bf16 v[96:99], v[64:67], v[48:51], v[96:99]
    v_mfma_f32_16x16x32_bf16 v[100:103], v[68:71], v[48:51], v[100:103]
    v_mfma_f32_16x16x32_bf16 v[104:107], v[72:75], v[48:51], v[104:107]
    v_mfma_f32_16x16x32_bf16 v[108:111], v[76:79], v[48:51], v[108:111]
    v_mfma_f32_16x16x32_bf16 v[112:115], v[64:67], v[52:55], v[112:115]
    v_mfma_f32_16x16x32_bf16 v[116:119], v[68:71], v[52:55], v[116:119]
    v_mfma_f32_16x16x32_bf16 v[120:123], v[72:75], v[52:55], v[120:123]
    v_mfma_f32_16x16x32_bf16 v[124:127], v[76:79], v[52:55], v[124:127]
    v_mfma_f32_16x16x32_bf16 v[128:131], v[64:67], v[56:59], v[128:131]
    v_mfma_f32_16x16x32_bf16 v[132:135], v[68:71], v[56:59], v[132:135]
    v_mfma_f32_16x16x32_bf16 v[136:139], v[72:75], v[56:59], v[136:139]
    v_mfma_f32_16x16x32_bf16 v[140:143], v[76:79], v[56:59], v[140:143]
    v_mfma_f32_16x16x32_bf16 v[144:147], v[64:67], v[60:63], v[144:147]
    v_mfma_f32_16x16x32_bf16 v[148:151], v[68:71], v[60:63], v[148:151]
    v_mfma_f32_16x16x32_bf16 v[152:155], v[72:75], v[60:63], v[152:155]
    v_mfma_f32_16x16x32_bf16 v[156:159], v[76:79], v[60:63], v[156:159]
    s_waitcnt vmcnt(8)
    s_barrier
    ds_read_b128 v[16:19], v12 offset:0
    ds_read_b128 v[20:23], v12 offset:2048
    ds_read_b128 v[24:27], v12 offset:4096
    ds_read_b128 v[28:31], v12 offset:6144
    ds_read_b128 v[32:35], v14 offset:16384
    ds_read_b128 v[36:39], v14 offset:18432
    ds_read_b128 v[40:43], v14 offset:20480
    ds_read_b128 v[44:47], v14 offset:22528
    ds_read_b128 v[48:51], v13 offset:0
    ds_read_b128 v[52:55], v13 offset:2048
    ds_read_b128 v[56:59], v13 offset:4096
    ds_read_b128 v[60:63], v13 offset:6144
    s_waitcnt lgkmcnt(4)
    v_mfma_f32_16x16x32_bf16 v[96:99], v[32:35], v[16:19], v[96:99]
    v_mfma_f32_16x16x32_bf16 v[100:103], v[36:39], v[16:19], v[100:103]
    v_mfma_f32_16x16x32_bf16 v[104:107], v[40:43], v[16:19], v[104:107]
    v_mfma_f32_16x16x32_bf16 v[108:111], v[44:47], v[16:19], v[108:111]
    ds_read_b128 v[64:67], v15 offset:16384
    ds_read_b128 v[68:71], v15 offset:18432
    ds_read_b128 v[72:75], v15 offset:20480
    ds_read_b128 v[76:79], v15 offset:22528
    v_mfma_f32_16x16x32_bf16 v[112:115], v[32:35], v[20:23], v[112:115]
    v_mfma_f32_16x16x32_bf16 v[116:119], v[36:39], v[20:23], v[116:119]
    v_mfma_f32_16x16x32_bf16 v[120:123], v[40:43], v[20:23], v[120:123]
    v_mfma_f32_16x16x32_bf16 v[124:127], v[44:47], v[20:23], v[124:127]
    v_mfma_f32_16x16x32_bf16 v[128:131], v[32:35], v[24:27], v[128:131]
    v_mfma_f32_16x16x32_bf16 v[132:135], v[36:39], v[24:27], v[132:135]
    v_mfma_f32_16x16x32_bf16 v[136:139], v[40:43], v[24:27], v[136:139]
    v_mfma_f32_16x16x32_bf16 v[140:143], v[44:47], v[24:27], v[140:143]
    v_mfma_f32_16x16x32_bf16 v[144:147], v[32:35], v[28:31], v[144:147]
    v_mfma_f32_16x16x32_bf16 v[148:151], v[36:39], v[28:31], v[148:151]
    v_mfma_f32_16x16x32_bf16 v[152:155], v[40:43], v[28:31], v[152:155]
    v_mfma_f32_16x16x32_bf16 v[156:159], v[44:47], v[28:31], v[156:159]
    s_waitcnt lgkmcnt(0)
    v_mfma_f32_16x16x32_bf16 v[96:99], v[64:67], v[48:51], v[96:99]
    v_mfma_f32_16x16x32_bf16 v[100:103], v[68:71], v[48:51], v[100:103]
    v_mfma_f32_16x16x32_bf16 v[104:107], v[72:75], v[48:51], v[104:107]
    v_mfma_f32_16x16x32_bf16 v[108:111], v[76:79], v[48:51], v[108:111]
    v_mfma_f32_16x16x32_bf16 v[112:115], v[64:67], v[52:55], v[112:115]
    v_mfma_f32_16x16x32_bf16 v[116:119], v[68:71], v[52:55], v[116:119]
    v_mfma_f32_16x16x32_bf16 v[120:123], v[72:75], v[52:55], v[120:123]
    v_mfma_f32_16x16x32_bf16 v[124:127], v[76:79], v[52:55], v[124:127]
    v_mfma_f32_16x16x32_bf16 v[128:131], v[64:67], v[56:59], v[128:131]
    v_mfma_f32_16x16x32_bf16 v[132:135], v[68:71], v[56:59], v[132:135]
    v_mfma_f32_16x16x32_bf16 v[136:139], v[72:75], v[56:59], v[136:139]
    v_mfma_f32_16x16x32_bf16 v[140:143], v[76:79], v[56:59], v[140:143]
    v_mfma_f32_16x16x32_bf16 v[144:147], v[64:67], v[60:63], v[144:147]
    v_mfma_f32_16x16x32_bf16 v[148:151], v[68:71], v[60:63], v[148:151]
    v_mfma_f32_16x16x32_bf16 v[152:155], v[72:75], v[60:63], v[152:155]
    v_mfma_f32_16x16x32_bf16 v[156:159], v[76:79], v[60:63], v[156:159]
    s_waitcnt vmcnt(0)
    s_barrier
    ds_read_b128 v[16:19], v12 offset:32768
    ds_read_b128 v[20:23], v12 offset:34816
    ds_read_b128 v[24:27], v12 offset:36864
    ds_read_b128 v[28:31], v12 offset:38912
    ds_read_b128 v[32:35], v14 offset:49152
    ds_read_b128 v[36:39], v14 offset:51200
    ds_read_b128 v[40:43], v14 offset:53248
    ds_read_b128 v[44:47], v14 offset:55296
    ds_read_b128 v[48:51], v13 offset:32768
    ds_read_b128 v[52:55], v13 offset:34816
    ds_read_b128 v[56:59], v13 offset:36864
    ds_read_b128 v[60:63], v13 offset:38912
    s_waitcnt lgkmcnt(4)
    v_mfma_f32_16x16x32_bf16 v[96:99], v[32:35], v[16:19], v[96:99]
    v_mfma_f32_16x16x32_bf16 v[100:103], v[36:39], v[16:19], v[100:103]
    v_mfma_f32_16x16x32_bf16 v[104:107], v[40:43], v[16:19], v[104:107]
    v_mfma_f32_16x16x32_bf16 v[108:111], v[44:47], v[16:19], v[108:111]
    ds_read_b128 v[64:67], v15 offset:49152
    ds_read_b128 v[68:71], v15 offset:51200
    ds_read_b128 v[72:75], v15 offset:53248
    ds_read_b128 v[76:79], v15 offset:55296
    v_mfma_f32_16x16x32_bf16 v[112:115], v[32:35], v[20:23], v[112:115]
    v_mfma_f32_16x16x32_bf16 v[116:119], v[36:39], v[20:23], v[116:119]
    v_mfma_f32_16x16x32_bf16 v[120:123], v[40:43], v[20:23], v[120:123]
    v_mfma_f32_16x16x32_bf16 v[124:127], v[44:47], v[20:23], v[124:127]
    v_mfma_f32_16x16x32_bf16 v[128:131], v[32:35], v[24:27], v[128:131]
    v_mfma_f32_16x16x32_bf16 v[132:135], v[36:39], v[24:27], v[132:135]
    v_mfma_f32_16x16x32_bf16 v[136:139], v[40:43], v[24:27], v[136:139]
    v_mfma_f32_16x16x32_bf16 v[140:143], v[44:47], v[24:27], v[140:143]
    v_mfma_f32_16x16x32_bf16 v[144:147], v[32:35], v[28:31], v[144:147]
    v_mfma_f32_16x16x32_bf16 v[148:151], v[36:39], v[28:31], v[148:151]
    v_mfma_f32_16x16x32_bf16 v[152:155], v[40:43], v[28:31], v[152:155]
    v_mfma_f32_16x16x32_bf16 v[156:159], v[44:47], v[28:31], v[156:159]
    s_waitcnt lgkmcnt(0)
    v_mfma_f32_16x16x32_bf16 v[96:99], v[64:67], v[48:51], v[96:99]
    v_mfma_f32_16x16x32_bf16 v[100:103], v[68:71], v[48:51], v[100:103]
    v_mfma_f32_16x16x32_bf16 v[104:107], v[72:75], v[48:51], v[104:107]
    v_mfma_f32_16x16x32_bf16 v[108:111], v[76:79], v[48:51], v[108:111]
    v_mfma_f32_16x16x32_bf16 v[112:115], v[64:67], v[52:55], v[112:115]
    v_mfma_f32_16x16x32_bf16 v[116:119], v[68:71], v[52:55], v[116:119]
    v_mfma_f32_16x16x32_bf16 v[120:123], v[72:75], v[52:55], v[120:123]
    v_mfma_f32_16x16x32_bf16 v[124:127], v[76:79], v[52:55], v[124:127]
    v_mfma_f32_16x16x32_bf16 v[128:131], v[64:67], v[56:59], v[128:131]
    v_mfma_f32_16x16x32_bf16 v[132:135], v[68:71], v[56:59], v[132:135]
    v_mfma_f32_16x16x32_bf16 v[136:139], v[72:75], v[56:59], v[136:139]
    v_mfma_f32_16x16x32_bf16 v[140:143], v[76:79], v[56:59], v[140:143]
    v_mfma_f32_16x16x32_bf16 v[144:147], v[64:67], v[60:63], v[144:147]
    v_mfma_f32_16x16x32_bf16 v[148:151], v[68:71], v[60:63], v[148:151]
    v_mfma_f32_16x16x32_bf16 v[152:155], v[72:75], v[60:63], v[152:155]
    v_mfma_f32_16x16x32_bf16 v[156:159], v[76:79], v[60:63], v[156:159]
    s_nop 7
    s_nop 3
    s_mul_i32 s24, s20, 128
    s_mul_i32 s25, s26, 64
    s_add_u32 s24, s24, s25
    v_add_u32 v10, s24, v8
    s_mov_b32 s25, 2560
    v_mul_lo_u32 v10, v10, s25
    s_lshl_b32 s24, s21, 7
    s_lshl_b32 s25, s27, 6
    s_add_u32 s24, s24, s25
    s_mul_i32 s24, s24, 4
    v_lshlrev_b32 v11, 2, v9
    v_mul_u32_u24 v11, 4, v11
    v_add3_u32 v10, v10, v11, s24
    s_mul_i32 s40, s40, 5242880
    s_add_u32 s24, s40, 0
    buffer_store_dwordx4 v[96:99], v10, s[16:19], s24 offen offset:0
    buffer_store_dwordx4 v[100:103], v10, s[16:19], s24 offen offset:64
    buffer_store_dwordx4 v[104:107], v10, s[16:19], s24 offen offset:128
    buffer_store_dwordx4 v[108:111], v10, s[16:19], s24 offen offset:192
    s_add_u32 s24, s40, 40960
    buffer_store_dwordx4 v[112:115], v10, s[16:19], s24 offen offset:0
    buffer_store_dwordx4 v[116:119], v10, s[16:19], s24 offen offset:64
    buffer_store_dwordx4 v[120:123], v10, s[16:19], s24 offen offset:128
    buffer_store_dwordx4 v[124:127], v10, s[16:19], s24 offen offset:192
    s_add_u32 s24, s40, 81920
    buffer_store_dwordx4 v[128:131], v10, s[16:19], s24 offen offset:0
    buffer_store_dwordx4 v[132:135], v10, s[16:19], s24 offen offset:64
    buffer_store_dwordx4 v[136:139], v10, s[16:19], s24 offen offset:128
    buffer_store_dwordx4 v[140:143], v10, s[16:19], s24 offen offset:192
    s_add_u32 s24, s40, 122880
    buffer_store_dwordx4 v[144:147], v10, s[16:19], s24 offen offset:0
    buffer_store_dwordx4 v[148:151], v10, s[16:19], s24 offen offset:64
    buffer_store_dwordx4 v[152:155], v10, s[16:19], s24 offen offset:128
    buffer_store_dwordx4 v[156:159], v10, s[16:19], s24 offen offset:192
p4_end:
    s_endpgm
.section .rodata,"a"
.p2align 6
.amdhsa_kernel p4_kernel
  .amdhsa_next_free_vgpr 160
  .amdhsa_next_free_sgpr 102
  .amdhsa_accum_offset 160
  .amdhsa_group_segment_fixed_size 0
  .amdhsa_kernarg_size 112
  .amdhsa_user_sgpr_count 2
  .amdhsa_user_sgpr_kernarg_segment_ptr 1
  .amdhsa_system_sgpr_workgroup_id_x 1
  .amdhsa_float_denorm_mode_32 3
.end_amdhsa_kernel
.text
.globl red_kernel
.p2align 8
.type red_kernel,@function
red_kernel:
    s_load_dwordx2 s[4:5], s[0:1], 104
    s_load_dwordx2 s[6:7], s[0:1], 0
    s_cmp_ge_u32 s2, 512
    s_cbranch_scc1 red_end
    v_and_b32 v1, 63, v0
    v_lshrrev_b32 v2, 6, v0
    s_nop 0
    v_readfirstlane_b32 s3, v2
    s_waitcnt lgkmcnt(0)
    s_add_u32 s8, s6, 0x0
    s_addc_u32 s9, s7, 0
    s_and_b32 s9, s9, 0xffff
    s_mov_b32 s10, 0x280000
    s_mov_b32 s11, 0x20000
    s_add_u32 s12, s4, 0xb620000
    s_addc_u32 s13, s5, 0
    s_and_b32 s13, s13, 0xffff
    s_mov_b32 s14, 0x1400000
    s_mov_b32 s15, 0x20000
    s_add_u32 s16, s4, 0xca20000
    s_addc_u32 s17, s5, 0
    s_and_b32 s17, s17, 0xffff
    s_mov_b32 s18, 0x280000
    s_mov_b32 s19, 0x20000
    s_add_u32 s20, s4, 0xcca0000
    s_addc_u32 s21, s5, 0
    s_and_b32 s21, s21, 0xffff
    s_mov_b32 s22, 0x280000
    s_mov_b32 s23, 0x20000
    s_lshl_b32 s24, s2, 2
    s_add_u32 s24, s24, s3
    s_mul_i32 s25, s24, 1280
    s_mul_i32 s26, s24, 2560
    v_lshlrev_b32 v3, 2, v1
    v_lshlrev_b32 v4, 3, v1
    buffer_load_dword v10, v3, s[8:11], s25 offen offset:0
    buffer_load_dword v11, v3, s[8:11], s25 offen offset:256
    buffer_load_dword v12, v3, s[8:11], s25 offen offset:512
    buffer_load_dword v13, v3, s[8:11], s25 offen offset:768
    buffer_load_dword v14, v3, s[8:11], s25 offen offset:1024
    s_add_u32 s27, s26, 0
    buffer_load_dwordx2 v[40:41], v4, s[12:15], s27 offen offset:0
    buffer_load_dwordx2 v[42:43], v4, s[12:15], s27 offen offset:512
    buffer_load_dwordx2 v[44:45], v4, s[12:15], s27 offen offset:1024
    buffer_load_dwordx2 v[46:47], v4, s[12:15], s27 offen offset:1536
    buffer_load_dwordx2 v[48:49], v4, s[12:15], s27 offen offset:2048
    s_add_u32 s27, s26, 5242880
    buffer_load_dwordx2 v[50:51], v4, s[12:15], s27 offen offset:0
    buffer_load_dwordx2 v[52:53], v4, s[12:15], s27 offen offset:512
    buffer_load_dwordx2 v[54:55], v4, s[12:15], s27 offen offset:1024
    buffer_load_dwordx2 v[56:57], v4, s[12:15], s27 offen offset:1536
    buffer_load_dwordx2 v[58:59], v4, s[12:15], s27 offen offset:2048
    s_add_u32 s27, s26, 10485760
    buffer_load_dwordx2 v[60:61], v4, s[12:15], s27 offen offset:0
    buffer_load_dwordx2 v[62:63], v4, s[12:15], s27 offen offset:512
    buffer_load_dwordx2 v[64:65], v4, s[12:15], s27 offen offset:1024
    buffer_load_dwordx2 v[66:67], v4, s[12:15], s27 offen offset:1536
    buffer_load_dwordx2 v[68:69], v4, s[12:15], s27 offen offset:2048
    s_waitcnt vmcnt(0)
    v_add_f32 v20, v40, v50
    v_add_f32 v20, v20, v60
    v_add_f32 v21, v41, v51
    v_add_f32 v21, v21, v61
    v_cvt_pk_bf16_f32 v5, v20, v21
    v_lshlrev_b32 v20, 16, v5
    v_and_b32 v21, 0xffff0000, v5
    v_lshlrev_b32 v5, 16, v10
    v_and_b32 v6, 0xffff0000, v10
    v_add_f32 v20, v20, v5
    v_add_f32 v21, v21, v6
    v_cvt_pk_bf16_f32 v10, v20, v21
    buffer_store_dword v10, v3, s[16:19], s25 offen offset:0
    v_lshlrev_b32 v20, 16, v10
    v_and_b32 v21, 0xffff0000, v10
    v_add_f32 v22, v42, v52
    v_add_f32 v22, v22, v62
    v_add_f32 v23, v43, v53
    v_add_f32 v23, v23, v63
    v_cvt_pk_bf16_f32 v5, v22, v23
    v_lshlrev_b32 v22, 16, v5
    v_and_b32 v23, 0xffff0000, v5
    v_lshlrev_b32 v5, 16, v11
    v_and_b32 v6, 0xffff0000, v11
    v_add_f32 v22, v22, v5
    v_add_f32 v23, v23, v6
    v_cvt_pk_bf16_f32 v11, v22, v23
    buffer_store_dword v11, v3, s[16:19], s25 offen offset:256
    v_lshlrev_b32 v22, 16, v11
    v_and_b32 v23, 0xffff0000, v11
    v_add_f32 v24, v44, v54
    v_add_f32 v24, v24, v64
    v_add_f32 v25, v45, v55
    v_add_f32 v25, v25, v65
    v_cvt_pk_bf16_f32 v5, v24, v25
    v_lshlrev_b32 v24, 16, v5
    v_and_b32 v25, 0xffff0000, v5
    v_lshlrev_b32 v5, 16, v12
    v_and_b32 v6, 0xffff0000, v12
    v_add_f32 v24, v24, v5
    v_add_f32 v25, v25, v6
    v_cvt_pk_bf16_f32 v12, v24, v25
    buffer_store_dword v12, v3, s[16:19], s25 offen offset:512
    v_lshlrev_b32 v24, 16, v12
    v_and_b32 v25, 0xffff0000, v12
    v_add_f32 v26, v46, v56
    v_add_f32 v26, v26, v66
    v_add_f32 v27, v47, v57
    v_add_f32 v27, v27, v67
    v_cvt_pk_bf16_f32 v5, v26, v27
    v_lshlrev_b32 v26, 16, v5
    v_and_b32 v27, 0xffff0000, v5
    v_lshlrev_b32 v5, 16, v13
    v_and_b32 v6, 0xffff0000, v13
    v_add_f32 v26, v26, v5
    v_add_f32 v27, v27, v6
    v_cvt_pk_bf16_f32 v13, v26, v27
    buffer_store_dword v13, v3, s[16:19], s25 offen offset:768
    v_lshlrev_b32 v26, 16, v13
    v_and_b32 v27, 0xffff0000, v13
    v_add_f32 v28, v48, v58
    v_add_f32 v28, v28, v68
    v_add_f32 v29, v49, v59
    v_add_f32 v29, v29, v69
    v_cvt_pk_bf16_f32 v5, v28, v29
    v_lshlrev_b32 v28, 16, v5
    v_and_b32 v29, 0xffff0000, v5
    v_lshlrev_b32 v5, 16, v14
    v_and_b32 v6, 0xffff0000, v14
    v_add_f32 v28, v28, v5
    v_add_f32 v29, v29, v6
    v_cvt_pk_bf16_f32 v14, v28, v29
    buffer_store_dword v14, v3, s[16:19], s25 offen offset:1024
    v_lshlrev_b32 v28, 16, v14
    v_and_b32 v29, 0xffff0000, v14
    v_add_f32 v4, v20, v21
    v_add_f32 v4, v4, v22
    v_add_f32 v4, v4, v23
    v_add_f32 v4, v4, v24
    v_add_f32 v4, v4, v25
    v_add_f32 v4, v4, v26
    v_add_f32 v4, v4, v27
    v_add_f32 v4, v4, v28
    v_add_f32 v4, v4, v29
    ds_swizzle_b32 v5, v4 offset:0x41f
    s_waitcnt lgkmcnt(0)
    v_add_f32 v4, v4, v5
    ds_swizzle_b32 v5, v4 offset:0x81f
    s_waitcnt lgkmcnt(0)
    v_add_f32 v4, v4, v5
    ds_swizzle_b32 v5, v4 offset:0x101f
    s_waitcnt lgkmcnt(0)
    v_add_f32 v4, v4, v5
    ds_swizzle_b32 v5, v4 offset:0x201f
    s_waitcnt lgkmcnt(0)
    v_add_f32 v4, v4, v5
    ds_swizzle_b32 v5, v4 offset:0x401f
    s_waitcnt lgkmcnt(0)
    v_add_f32 v4, v4, v5
    s_nop 1
    v_readlane_b32 s28, v4, 0
    v_readlane_b32 s29, v4, 32
    s_nop 3
    v_mov_b32 v4, s28
    v_add_f32 v4, s29, v4
    v_mul_f32 v4, 0x3acccccd, v4
    v_sub_f32 v5, v20, v4
    v_mul_f32 v6, v5, v5
    v_sub_f32 v5, v21, v4
    v_fmac_f32 v6, v5, v5
    v_sub_f32 v5, v22, v4
    v_fmac_f32 v6, v5, v5
    v_sub_f32 v5, v23, v4
    v_fmac_f32 v6, v5, v5
    v_sub_f32 v5, v24, v4
    v_fmac_f32 v6, v5, v5
    v_sub_f32 v5, v25, v4
    v_fmac_f32 v6, v5, v5
    v_sub_f32 v5, v26, v4
    v_fmac_f32 v6, v5, v5
    v_sub_f32 v5, v27, v4
    v_fmac_f32 v6, v5, v5
    v_sub_f32 v5, v28, v4
    v_fmac_f32 v6, v5, v5
    v_sub_f32 v5, v29, v4
    v_fmac_f32 v6, v5, v5
    ds_swizzle_b32 v5, v6 offset:0x41f
    s_waitcnt lgkmcnt(0)
    v_add_f32 v6, v6, v5
    ds_swizzle_b32 v5, v6 offset:0x81f
    s_waitcnt lgkmcnt(0)
    v_add_f32 v6, v6, v5
    ds_swizzle_b32 v5, v6 offset:0x101f
    s_waitcnt lgkmcnt(0)
    v_add_f32 v6, v6, v5
    ds_swizzle_b32 v5, v6 offset:0x201f
    s_waitcnt lgkmcnt(0)
    v_add_f32 v6, v6, v5
    ds_swizzle_b32 v5, v6 offset:0x401f
    s_waitcnt lgkmcnt(0)
    v_add_f32 v6, v6, v5
    s_nop 1
    v_readlane_b32 s28, v6, 0
    v_readlane_b32 s29, v6, 32
    s_nop 3
    v_mov_b32 v6, s28
    v_add_f32 v6, s29, v6
    v_mul_f32 v6, 0x3acccccd, v6
    v_cvt_pk_bf16_f32 v5, v4, v4
    v_lshlrev_b32 v4, 16, v5
    v_cvt_pk_bf16_f32 v5, v6, v6
    v_lshlrev_b32 v6, 16, v5
    v_add_f32 v6, 0x3727c5ac, v6
    v_cvt_pk_bf16_f32 v5, v6, v6
    v_lshlrev_b32 v6, 16, v5
    v_sqrt_f32 v6, v6
    s_nop 0
    v_cvt_pk_bf16_f32 v5, v6, v6
    v_lshlrev_b32 v6, 16, v5
    v_rcp_f32 v7, v6
    s_nop 0
    v_sub_f32 v20, v20, v4
    v_cvt_pk_bf16_f32 v5, v20, v20
    v_lshlrev_b32 v20, 16, v5
    v_mul_f32 v5, v20, v7
    v_fma_f32 v20, -v5, v6, v20
    v_fmac_f32 v5, v20, v7
    v_mov_b32 v20, v5
    v_sub_f32 v21, v21, v4
    v_cvt_pk_bf16_f32 v5, v21, v21
    v_lshlrev_b32 v21, 16, v5
    v_mul_f32 v5, v21, v7
    v_fma_f32 v21, -v5, v6, v21
    v_fmac_f32 v5, v21, v7
    v_mov_b32 v21, v5
    v_sub_f32 v22, v22, v4
    v_cvt_pk_bf16_f32 v5, v22, v22
    v_lshlrev_b32 v22, 16, v5
    v_mul_f32 v5, v22, v7
    v_fma_f32 v22, -v5, v6, v22
    v_fmac_f32 v5, v22, v7
    v_mov_b32 v22, v5
    v_sub_f32 v23, v23, v4
    v_cvt_pk_bf16_f32 v5, v23, v23
    v_lshlrev_b32 v23, 16, v5
    v_mul_f32 v5, v23, v7
    v_fma_f32 v23, -v5, v6, v23
    v_fmac_f32 v5, v23, v7
    v_mov_b32 v23, v5
    v_sub_f32 v24, v24, v4
    v_cvt_pk_bf16_f32 v5, v24, v24
    v_lshlrev_b32 v24, 16, v5
    v_mul_f32 v5, v24, v7
    v_fma_f32 v24, -v5, v6, v24
    v_fmac_f32 v5, v24, v7
    v_mov_b32 v24, v5
    v_sub_f32 v25, v25, v4
    v_cvt_pk_bf16_f32 v5, v25, v25
    v_lshlrev_b32 v25, 16, v5
    v_mul_f32 v5, v25, v7
    v_fma_f32 v25, -v5, v6, v25
    v_fmac_f32 v5, v25, v7
    v_mov_b32 v25, v5
    v_sub_f32 v26, v26, v4
    v_cvt_pk_bf16_f32 v5, v26, v26
    v_lshlrev_b32 v26, 16, v5
    v_mul_f32 v5, v26, v7
    v_fma_f32 v26, -v5, v6, v26
    v_fmac_f32 v5, v26, v7
    v_mov_b32 v26, v5
    v_sub_f32 v27, v27, v4
    v_cvt_pk_bf16_f32 v5, v27, v27
    v_lshlrev_b32 v27, 16, v5
    v_mul_f32 v5, v27, v7
    v_fma_f32 v27, -v5, v6, v27
    v_fmac_f32 v5, v27, v7
    v_mov_b32 v27, v5
    v_sub_f32 v28, v28, v4
    v_cvt_pk_bf16_f32 v5, v28, v28
    v_lshlrev_b32 v28, 16, v5
    v_mul_f32 v5, v28, v7
    v_fma_f32 v28, -v5, v6, v28
    v_fmac_f32 v5, v28, v7
    v_mov_b32 v28, v5
    v_sub_f32 v29, v29, v4
    v_cvt_pk_bf16_f32 v5, v29, v29
    v_lshlrev_b32 v29, 16, v5
    v_mul_f32 v5, v29, v7
    v_fma_f32 v29, -v5, v6, v29
    v_fmac_f32 v5, v29, v7
    v_mov_b32 v29, v5
    v_cvt_pk_bf16_f32 v30, v20, v21
    buffer_store_dword v30, v3, s[20:23], s25 offen offset:0
    v_cvt_pk_bf16_f32 v31, v22, v23
    buffer_store_dword v31, v3, s[20:23], s25 offen offset:256
    v_cvt_pk_bf16_f32 v32, v24, v25
    buffer_store_dword v32, v3, s[20:23], s25 offen offset:512
    v_cvt_pk_bf16_f32 v33, v26, v27
    buffer_store_dword v33, v3, s[20:23], s25 offen offset:768
    v_cvt_pk_bf16_f32 v34, v28, v29
    buffer_store_dword v34, v3, s[20:23], s25 offen offset:1024
red_end:
    s_endpgm
.section .rodata,"a"
.p2align 6
.amdhsa_kernel red_kernel
  .amdhsa_next_free_vgpr 80
  .amdhsa_next_free_sgpr 102
  .amdhsa_accum_offset 80
  .amdhsa_group_segment_fixed_size 0
  .amdhsa_kernarg_size 112
  .amdhsa_user_sgpr_count 2
  .amdhsa_user_sgpr_kernarg_segment_ptr 1
  .amdhsa_system_sgpr_workgroup_id_x 1
  .amdhsa_float_denorm_mode_32 3
.end_amdhsa_kernel
.text
.globl p5_kernel
.p2align 8
.type p5_kernel,@function
p5_kernel:
    s_load_dwordx2 s[4:5], s[0:1], 104
    s_cmp_ge_u32 s2, 384
    s_cbranch_scc1 p5_end
    s_and_b32 s24, s2, 7
    s_lshr_b32 s25, s2, 3
    s_and_b32 s20, s25, 15
    s_lshr_b32 s25, s25, 4
    s_lshl_b32 s21, s25, 3
    s_add_u32 s21, s21, s24
    s_mov_b32 s22, 0
    s_waitcnt lgkmcnt(0)
    s_add_u32 s8, s4, 0xcca0000
    s_addc_u32 s9, s5, 0
    s_and_b32 s9, s9, 0xffff
    s_mov_b32 s10, 0x280000
    s_mov_b32 s11, 0x20000
    s_add_u32 s12, s4, 0x2080000
    s_addc_u32 s13, s5, 0
    s_and_b32 s13, s13, 0xffff
    s_mov_b32 s14, 0x3c0000
    s_mov_b32 s15, 0x20000
    s_add_u32 s16, s4, 0xcf20000
    s_addc_u32 s17, s5, 0
    s_and_b32 s17, s17, 0xffff
    s_mov_b32 s18, 0x600000
    s_mov_b32 s19, 0x20000
    v_and_b32 v1, 63, v0
    v_lshrrev_b32 v8, 6, v0
    s_nop 0
    v_readfirstlane_b32 s23, v8
    v_lshrrev_b32 v8, 3, v1
    v_and_b32 v9, 7, v1
    v_xor_b32 v9, v9, v8
    v_lshlrev_b32 v9, 4, v9
    s_mov_b32 s24, 1280
    v_mul_lo_u32 v2, v8, s24
    v_add_u32 v2, v2, v9
    s_mov_b32 s24, 1280
    v_mul_lo_u32 v3, v8, s24
    v_add_u32 v3, v3, v9
    s_mul_i32 s24, s20, 128
    s_mul_i32 s25, s23, 32
    s_add_u32 s24, s24, s25
    s_mul_i32 s24, s24, 1280
    s_mul_i32 s41, s23, 4096
    s_lshl_b32 s25, s23, 5
    s_add_u32 s30, s24, s22
    s_add_u32 s31, s30, 10240
    s_add_u32 s32, s30, 20480
    s_add_u32 s33, s30, 30720
    s_lshl_b32 s24, s21, 7
    s_add_u32 s24, s24, s25
    s_mul_i32 s24, s24, 1280
    s_add_u32 s34, s24, s22
    s_add_u32 s35, s34, 10240
    s_add_u32 s36, s34, 20480
    s_add_u32 s37, s34, 30720
    s_lshl_b32 s38, s23, 12
    v_and_b32 v8, 15, v1
    v_lshrrev_b32 v9, 4, v1
    v_and_b32 v10, 7, v8
    v_xor_b32 v10, v10, v9
    v_lshlrev_b32 v10, 4, v10
    v_lshl_add_u32 v10, v8, 7, v10
    s_lshr_b32 s26, s23, 1
    s_and_b32 s27, s23, 1
    s_mul_i32 s24, s26, 8192
    v_add_u32 v4, s24, v10
    v_xor_b32 v5, 64, v4
    s_lshl_b32 s24, s27, 13
    v_add_u32 v6, s24, v10
    v_xor_b32 v7, 64, v6
    v_add_u32 v12, 0x10000, v4
    v_add_u32 v13, 0x10000, v5
    v_add_u32 v14, 0x10000, v6
    v_add_u32 v15, 0x10000, v7
    v_mov_b32 v96, 0
    v_mov_b32 v97, 0
    v_mov_b32 v98, 0
    v_mov_b32 v99, 0
    v_mov_b32 v100, 0
    v_mov_b32 v101, 0
    v_mov_b32 v102, 0
    v_mov_b32 v103, 0
    v_mov_b32 v104, 0
    v_mov_b32 v105, 0
    v_mov_b32 v106, 0
    v_mov_b32 v107, 0
    v_mov_b32 v108, 0
    v_mov_b32 v109, 0
    v_mov_b32 v110, 0
    v_mov_b32 v111, 0
    v_mov_b32 v112, 0
    v_mov_b32 v113, 0
    v_mov_b32 v114, 0
    v_mov_b32 v115, 0
    v_mov_b32 v116, 0
    v_mov_b32 v117, 0
    v_mov_b32 v118, 0
    v_mov_b32 v119, 0
    v_mov_b32 v120, 0
    v_mov_b32 v121, 0
    v_mov_b32 v122, 0
    v_mov_b32 v123, 0
    v_mov_b32 v124, 0
    v_mov_b32 v125, 0
    v_mov_b32 v126, 0
    v_mov_b32 v127, 0
    v_mov_b32 v128, 0
    v_mov_b32 v129, 0
    v_mov_b32 v130, 0
    v_mov_b32 v131, 0
    v_mov_b32 v132, 0
    v_mov_b32 v133, 0
    v_mov_b32 v134, 0
    v_mov_b32 v135, 0
    v_mov_b32 v136, 0
    v_mov_b32 v137, 0
    v_mov_b32 v138, 0
    v_mov_b32 v139, 0
    v_mov_b32 v140, 0
    v_mov_b32 v141, 0
    v_mov_b32 v142, 0
    v_mov_b32 v143, 0
    v_mov_b32 v144, 0
    v_mov_b32 v145, 0
    v_mov_b32 v146, 0
    v_mov_b32 v147, 0
    v_mov_b32 v148, 0
    v_mov_b32 v149, 0
    v_mov_b32 v150, 0
    v_mov_b32 v151, 0
    v_mov_b32 v152, 0
    v_mov_b32 v153, 0
    v_mov_b32 v154, 0
    v_mov_b32 v155, 0
    v_mov_b32 v156, 0
    v_mov_b32 v157, 0
    v_mov_b32 v158, 0
    v_mov_b32 v159, 0
    s_add_u32 m0, s41, 0
    s_nop 0
    buffer_load_dwordx4 v2, s[8:11], s30 offen lds
    s_add_u32 s30, s30, 128
    s_add_u32 m0, s38, 16384
    s_nop 0
    buffer_load_dwordx4 v3, s[12:15], s34 offen lds
    s_add_u32 s34, s34, 128
    s_add_u32 m0, s41, 1024
    s_nop 0
    buffer_load_dwordx4 v2, s[8:11], s31 offen lds
    s_add_u32 s31, s31, 128
    s_add_u32 m0, s38, 17408
    s_nop 0
    buffer_load_dwordx4 v3, s[12:15], s35 offen lds
    s_add_u32 s35, s35, 128
    s_add_u32 m0, s41, 2048
    s_nop 0
    buffer_load_dwordx4 v2, s[8:11], s32 offen lds
    s_add_u32 s32, s32, 128
    s_add_u32 m0, s38, 18432
    s_nop 0
    buffer_load_dwordx4 v3, s[12:15], s36 offen lds
    s_add_u32 s36, s36, 128
    s_add_u32 m0, s41, 3072
    s_nop 0
    buffer_load_dwordx4 v2, s[8:11], s33 offen lds
    s_add_u32 s33, s33, 128
    s_add_u32 m0, s38, 19456
    s_nop 0
    buffer_load_dwordx4 v3, s[12:15], s37 offen lds
    s_add_u32 s37, s37, 128
    s_mov_b32 s39, 0
p5_loop:
    s_waitcnt vmcnt(0)
    s_barrier
    s_add_u32 m0, s41, 32768
    s_nop 0
    buffer_load_dwordx4 v2, s[8:11], s30 offen lds
    s_add_u32 s30, s30, 128
    s_add_u32 m0, s38, 49152
    s_nop 0
    buffer_load_dwordx4 v3, s[12:15], s34 offen lds
    s_add_u32 s34, s34, 128
    s_add_u32 m0, s41, 33792
    s_nop 0
    buffer_load_dwordx4 v2, s[8:11], s31 offen lds
    s_add_u32 s31, s31, 128
    s_add_u32 m0, s38, 50176
    s_nop 0
    buffer_load_dwordx4 v3, s[12:15], s35 offen lds
    s_add_u32 s35, s35, 128
    s_add_u32 m0, s41, 34816
    s_nop 0
    buffer_load_dwordx4 v2, s[8:11], s32 offen lds
    s_add_u32 s32, s32, 128
    s_add_u32 m0, s38, 51200
    s_nop 0
    buffer_load_dwordx4 v3, s[12:15], s36 offen lds
    s_add_u32 s36, s36, 128
    s_add_u32 m0, s41, 35840
    s_nop 0
    buffer_load_dwordx4 v2, s[8:11], s33 offen lds
    s_add_u32 s33, s33, 128
    s_add_u32 m0, s38, 52224
    s_nop 0
    buffer_load_dwordx4 v3, s[12:15], s37 offen lds
    s_add_u32 s37, s37, 128
    ds_read_b128 v[16:19], v4 offset:0
    ds_read_b128 v[20:23], v4 offset:2048
    ds_read_b128 v[24:27], v4 offset:4096
    ds_read_b128 v[28:31], v4 offset:6144
    ds_read_b128 v[32:35], v6 offset:16384
    ds_read_b128 v[36:39], v6 offset:18432
    ds_read_b128 v[40:43], v6 offset:20480
    ds_read_b128 v[44:47], v6 offset:22528
    ds_read_b128 v[48:51], v5 offset:0
    ds_read_b128 v[52:55], v5 offset:2048
    ds_read_b128 v[56:59], v5 offset:4096
    ds_read_b128 v[60:63], v5 offset:6144
    s_waitcnt lgkmcnt(4)
    v_mfma_f32_16x16x32_bf16 v[96:99], v[32:35], v[16:19], v[96:99]
    v_mfma_f32_16x16x32_bf16 v[100:103], v[36:39], v[16:19], v[100:103]
    v_mfma_f32_16x16x32_bf16 v[104:107], v[40:43], v[16:19], v[104:107]
    v_mfma_f32_16x16x32_bf16 v[108:111], v[44:47], v[16:19], v[108:111]
    ds_read_b128 v[64:67], v7 offset:16384
    ds_read_b128 v[68:71], v7 offset:18432
    ds_read_b128 v[72:75], v7 offset:20480
    ds_read_b128 v[76:79], v7 offset:22528
    v_mfma_f32_16x16x32_bf16 v[112:115], v[32:35], v[20:23], v[112:115]
    v_mfma_f32_16x16x32_bf16 v[116:119], v[36:39], v[20:23], v[116:119]
    v_mfma_f32_16x16x32_bf16 v[120:123], v[40:43], v[20:23], v[120:123]
    v_mfma_f32_16x16x32_bf16 v[124:127], v[44:47], v[20:23], v[124:127]
    v_mfma_f32_16x16x32_bf16 v[128:131], v[32:35], v[24:27], v[128:131]
    v_mfma_f32_16x16x32_bf16 v[132:135], v[36:39], v[24:27], v[132:135]
    v_mfma_f32_16x16x32_bf16 v[136:139], v[40:43], v[24:27], v[136:139]
    v_mfma_f32_16x16x32_bf16 v[140:143], v[44:47], v[24:27], v[140:143]
    v_mfma_f32_16x16x32_bf16 v[144:147], v[32:35], v[28:31], v[144:147]
    v_mfma_f32_16x16x32_bf16 v[148:151], v[36:39], v[28:31], v[148:151]
    v_mfma_f32_16x16x32_bf16 v[152:155], v[40:43], v[28:31], v[152:155]
    v_mfma_f32_16x16x32_bf16 v[156:159], v[44:47], v[28:31], v[156:159]
    s_waitcnt lgkmcnt(0)
    v_mfma_f32_16x16x32_bf16 v[96:99], v[64:67], v[48:51], v[96:99]
    v_mfma_f32_16x16x32_bf16 v[100:103], v[68:71], v[48:51], v[100:103]
    v_mfma_f32_16x16x32_bf16 v[104:107], v[72:75], v[48:51], v[104:107]
    v_mfma_f32_16x16x32_bf16 v[108:111], v[76:79], v[48:51], v[108:111]
    v_mfma_f32_16x16x32_bf16 v[112:115], v[64:67], v[52:55], v[112:115]
    v_mfma_f32_16x16x32_bf16 v[116:119], v[68:71], v[52:55], v[116:119]
    v_mfma_f32_16x16x32_bf16 v[120:123], v[72:75], v[52:55], v[120:123]
    v_mfma_f32_16x16x32_bf16 v[124:127], v[76:79], v[52:55], v[124:127]
    v_mfma_f32_16x16x32_bf16 v[128:131], v[64:67], v[56:59], v[128:131]
    v_mfma_f32_16x16x32_bf16 v[132:135], v[68:71], v[56:59], v[132:135]
    v_mfma_f32_16x16x32_bf16 v[136:139], v[72:75], v[56:59], v[136:139]
    v_mfma_f32_16x16x32_bf16 v[140:143], v[76:79], v[56:59], v[140:143]
    v_mfma_f32_16x16x32_bf16 v[144:147], v[64:67], v[60:63], v[144:147]
    v_mfma_f32_16x16x32_bf16 v[148:151], v[68:71], v[60:63], v[148:151]
    v_mfma_f32_16x16x32_bf16 v[152:155], v[72:75], v[60:63], v[152:155]
    v_mfma_f32_16x16x32_bf16 v[156:159], v[76:79], v[60:63], v[156:159]
    s_waitcnt vmcnt(0)
    s_barrier
    s_add_u32 s39, s39, 2
    s_cmp_ge_u32 s39, 10
    s_cbranch_scc1 p5_last
    s_add_u32 m0, s41, 0
    s_nop 0
    buffer_load_dwordx4 v2, s[8:11], s30 offen lds
    s_add_u32 s30, s30, 128
    s_add_u32 m0, s38, 16384
    s_nop 0
    buffer_load_dwordx4 v3, s[12:15], s34 offen lds
    s_add_u32 s34, s34, 128
    s_add_u32 m0, s41, 1024
    s_nop 0
    buffer_load_dwordx4 v2, s[8:11], s31 offen lds
    s_add_u32 s31, s31, 128
    s_add_u32 m0, s38, 17408
    s_nop 0
    buffer_load_dwordx4 v3, s[12:15], s35 offen lds
    s_add_u32 s35, s35, 128
    s_add_u32 m0, s41, 2048
    s_nop 0
    buffer_load_dwordx4 v2, s[8:11], s32 offen lds
    s_add_u32 s32, s32, 128
    s_add_u32 m0, s38, 18432
    s_nop 0
    buffer_load_dwordx4 v3, s[12:15], s36 offen lds
    s_add_u32 s36, s36, 128
    s_add_u32 m0, s41, 3072
    s_nop 0
    buffer_load_dwordx4 v2, s[8:11], s33 offen lds
    s_add_u32 s33, s33, 128
    s_add_u32 m0, s38, 19456
    s_nop 0
    buffer_load_dwordx4 v3, s[12:15], s37 offen lds
    s_add_u32 s37, s37, 128
    ds_read_b128 v[16:19], v4 offset:32768
    ds_read_b128 v[20:23], v4 offset:34816
    ds_read_b128 v[24:27], v4 offset:36864
    ds_read_b128 v[28:31], v4 offset:38912
    ds_read_b128 v[32:35], v6 offset:49152
    ds_read_b128 v[36:39], v6 offset:51200
    ds_read_b128 v[40:43], v6 offset:53248
    ds_read_b128 v[44:47], v6 offset:55296
    ds_read_b128 v[48:51], v5 offset:32768
    ds_read_b128 v[52:55], v5 offset:34816
    ds_read_b128 v[56:59], v5 offset:36864
    ds_read_b128 v[60:63], v5 offset:38912
    s_waitcnt lgkmcnt(4)
    v_mfma_f32_16x16x32_bf16 v[96:99], v[32:35], v[16:19], v[96:99]
    v_mfma_f32_16x16x32_bf16 v[100:103], v[36:39], v[16:19], v[100:103]
    v_mfma_f32_16x16x32_bf16 v[104:107], v[40:43], v[16:19], v[104:107]
    v_mfma_f32_16x16x32_bf16 v[108:111], v[44:47], v[16:19], v[108:111]
    ds_read_b128 v[64:67], v7 offset:49152
    ds_read_b128 v[68:71], v7 offset:51200
    ds_read_b128 v[72:75], v7 offset:53248
    ds_read_b128 v[76:79], v7 offset:55296
    v_mfma_f32_16x16x32_bf16 v[112:115], v[32:35], v[20:23], v[112:115]
    v_mfma_f32_16x16x32_bf16 v[116:119], v[36:39], v[20:23], v[116:119]
    v_mfma_f32_16x16x32_bf16 v[120:123], v[40:43], v[20:23], v[120:123]
    v_mfma_f32_16x16x32_bf16 v[124:127], v[44:47], v[20:23], v[124:127]
    v_mfma_f32_16x16x32_bf16 v[128:131], v[32:35], v[24:27], v[128:131]
    v_mfma_f32_16x16x32_bf16 v[132:135], v[36:39], v[24:27], v[132:135]
    v_mfma_f32_16x16x32_bf16 v[136:139], v[40:43], v[24:27], v[136:139]
    v_mfma_f32_16x16x32_bf16 v[140:143], v[44:47], v[24:27], v[140:143]
    v_mfma_f32_16x16x32_bf16 v[144:147], v[32:35], v[28:31], v[144:147]
    v_mfma_f32_16x16x32_bf16 v[148:151], v[36:39], v[28:31], v[148:151]
    v_mfma_f32_16x16x32_bf16 v[152:155], v[40:43], v[28:31], v[152:155]
    v_mfma_f32_16x16x32_bf16 v[156:159], v[44:47], v[28:31], v[156:159]
    s_waitcnt lgkmcnt(0)
    v_mfma_f32_16x16x32_bf16 v[96:99], v[64:67], v[48:51], v[96:99]
    v_mfma_f32_16x16x32_bf16 v[100:103], v[68:71], v[48:51], v[100:103]
    v_mfma_f32_16x16x32_bf16 v[104:107], v[72:75], v[48:51], v[104:107]
    v_mfma_f32_16x16x32_bf16 v[108:111], v[76:79], v[48:51], v[108:111]
    v_mfma_f32_16x16x32_bf16 v[112:115], v[64:67], v[52:55], v[112:115]
    v_mfma_f32_16x16x32_bf16 v[116:119], v[68:71], v[52:55], v[116:119]
    v_mfma_f32_16x16x32_bf16 v[120:123], v[72:75], v[52:55], v[120:123]
    v_mfma_f32_16x16x32_bf16 v[124:127], v[76:79], v[52:55], v[124:127]
    v_mfma_f32_16x16x32_bf16 v[128:131], v[64:67], v[56:59], v[128:131]
    v_mfma_f32_16x16x32_bf16 v[132:135], v[68:71], v[56:59], v[132:135]
    v_mfma_f32_16x16x32_bf16 v[136:139], v[72:75], v[56:59], v[136:139]
    v_mfma_f32_16x16x32_bf16 v[140:143], v[76:79], v[56:59], v[140:143]
    v_mfma_f32_16x16x32_bf16 v[144:147], v[64:67], v[60:63], v[144:147]
    v_mfma_f32_16x16x32_bf16 v[148:151], v[68:71], v[60:63], v[148:151]
    v_mfma_f32_16x16x32_bf16 v[152:155], v[72:75], v[60:63], v[152:155]
    v_mfma_f32_16x16x32_bf16 v[156:159], v[76:79], v[60:63], v[156:159]
    s_branch p5_loop
p5_last:
    ds_read_b128 v[16:19], v4 offset:32768
    ds_read_b128 v[20:23], v4 offset:34816
    ds_read_b128 v[24:27], v4 offset:36864
    ds_read_b128 v[28:31], v4 offset:38912
    ds_read_b128 v[32:35], v6 offset:49152
    ds_read_b128 v[36:39], v6 offset:51200
    ds_read_b128 v[40:43], v6 offset:53248
    ds_read_b128 v[44:47], v6 offset:55296
    ds_read_b128 v[48:51], v5 offset:32768
    ds_read_b128 v[52:55], v5 offset:34816
    ds_read_b128 v[56:59], v5 offset:36864
    ds_read_b128 v[60:63], v5 offset:38912
    s_waitcnt lgkmcnt(4)
    v_mfma_f32_16x16x32_bf16 v[96:99], v[32:35], v[16:19], v[96:99]
    v_mfma_f32_16x16x32_bf16 v[100:103], v[36:39], v[16:19], v[100:103]
    v_mfma_f32_16x16x32_bf16 v[104:107], v[40:43], v[16:19], v[104:107]
    v_mfma_f32_16x16x32_bf16 v[108:111], v[44:47], v[16:19], v[108:111]
    ds_read_b128 v[64:67], v7 offset:49152
    ds_read_b128 v[68:71], v7 offset:51200
    ds_read_b128 v[72:75], v7 offset:53248
    ds_read_b128 v[76:79], v7 offset:55296
    v_mfma_f32_16x16x32_bf16 v[112:115], v[32:35], v[20:23], v[112:115]
    v_mfma_f32_16x16x32_bf16 v[116:119], v[36:39], v[20:23], v[116:119]
    v_mfma_f32_16x16x32_bf16 v[120:123], v[40:43], v[20:23], v[120:123]
    v_mfma_f32_16x16x32_bf16 v[124:127], v[44:47], v[20:23], v[124:127]
    v_mfma_f32_16x16x32_bf16 v[128:131], v[32:35], v[24:27], v[128:131]
    v_mfma_f32_16x16x32_bf16 v[132:135], v[36:39], v[24:27], v[132:135]
    v_mfma_f32_16x16x32_bf16 v[136:139], v[40:43], v[24:27], v[136:139]
    v_mfma_f32_16x16x32_bf16 v[140:143], v[44:47], v[24:27], v[140:143]
    v_mfma_f32_16x16x32_bf16 v[144:147], v[32:35], v[28:31], v[144:147]
    v_mfma_f32_16x16x32_bf16 v[148:151], v[36:39], v[28:31], v[148:151]
    v_mfma_f32_16x16x32_bf16 v[152:155], v[40:43], v[28:31], v[152:155]
    v_mfma_f32_16x16x32_bf16 v[156:159], v[44:47], v[28:31], v[156:159]
    s_waitcnt lgkmcnt(0)
    v_mfma_f32_16x16x32_bf16 v[96:99], v[64:67], v[48:51], v[96:99]
    v_mfma_f32_16x16x32_bf16 v[100:103], v[68:71], v[48:51], v[100:103]
    v_mfma_f32_16x16x32_bf16 v[104:107], v[72:75], v[48:51], v[104:107]
    v_mfma_f32_16x16x32_bf16 v[108:111], v[76:79], v[48:51], v[108:111]
    v_mfma_f32_16x16x32_bf16 v[112:115], v[64:67], v[52:55], v[112:115]
    v_mfma_f32_16x16x32_bf16 v[116:119], v[68:71], v[52:55], v[116:119]
    v_mfma_f32_16x16x32_bf16 v[120:123], v[72:75], v[52:55], v[120:123]
    v_mfma_f32_16x16x32_bf16 v[124:127], v[76:79], v[52:55], v[124:127]
    v_mfma_f32_16x16x32_bf16 v[128:131], v[64:67], v[56:59], v[128:131]
    v_mfma_f32_16x16x32_bf16 v[132:135], v[68:71], v[56:59], v[132:135]
    v_mfma_f32_16x16x32_bf16 v[136:139], v[72:75], v[56:59], v[136:139]
    v_mfma_f32_16x16x32_bf16 v[140:143], v[76:79], v[56:59], v[140:143]
    v_mfma_f32_16x16x32_bf16 v[144:147], v[64:67], v[60:63], v[144:147]
    v_mfma_f32_16x16x32_bf16 v[148:151], v[68:71], v[60:63], v[148:151]
    v_mfma_f32_16x16x32_bf16 v[152:155], v[72:75], v[60:63], v[152:155]
    v_mfma_f32_16x16x32_bf16 v[156:159], v[76:79], v[60:63], v[156:159]
    s_nop 7
    s_nop 3
    s_lshl_b32 s24, s20, 7
    s_lshl_b32 s25, s26, 6
    s_add_u32 s24, s24, s25
    v_add_u32 v10, s24, v8
    s_mov_b32 s25, 3072
    v_mul_lo_u32 v10, v10, s25
    s_lshl_b32 s24, s21, 7
    s_lshl_b32 s25, s27, 6
    s_add_u32 s24, s24, s25
    v_lshl_add_u32 v10, v9, 3, v10
    v_add_u32 v10, s24, v10
    s_mov_b32 s28, 0x40135761
    s_mov_b32 s29, 0x3d372713
    s_mov_b32 s40, 0xffff0000
    s_mov_b32 s24, 0
    v_cvt_pk_bf16_f32 v12, v96, v97
    v_lshlrev_b32 v96, 16, v12
    v_and_b32 v97, s40, v12
    v_cvt_pk_bf16_f32 v12, v100, v101
    v_lshlrev_b32 v100, 16, v12
    v_and_b32 v101, s40, v12
    v_cvt_pk_bf16_f32 v12, v98, v99
    v_lshlrev_b32 v98, 16, v12
    v_and_b32 v99, s40, v12
    v_cvt_pk_bf16_f32 v12, v102, v103
    v_lshlrev_b32 v102, 16, v12
    v_and_b32 v103, s40, v12
    v_mul_f32 v16, v96, v96
    v_mul_f32 v16, s29, v16
    v_fma_f32 v16, v16, v96, v96
    v_mul_f32 v16, s28, v16
    v_exp_f32 v16, -v16
    v_mul_f32 v17, v97, v97
    v_mul_f32 v17, s29, v17
    v_fma_f32 v17, v17, v97, v97
    v_mul_f32 v17, s28, v17
    v_exp_f32 v17, -v17
    v_mul_f32 v18, v98, v98
    v_mul_f32 v18, s29, v18
    v_fma_f32 v18, v18, v98, v98
    v_mul_f32 v18, s28, v18
    v_exp_f32 v18, -v18
    v_mul_f32 v19, v99, v99
    v_mul_f32 v19, s29, v19
    v_fma_f32 v19, v19, v99, v99
    v_mul_f32 v19, s28, v19
    v_exp_f32 v19, -v19
    s_nop 0
    v_add_f32 v16, 1.0, v16
    v_add_f32 v17, 1.0, v17
    v_add_f32 v18, 1.0, v18
    v_add_f32 v19, 1.0, v19
    v_rcp_f32 v16, v16
    v_rcp_f32 v17, v17
    v_rcp_f32 v18, v18
    v_rcp_f32 v19, v19
    s_nop 0
    v_mul_f32 v16, v16, v96
    v_mul_f32 v17, v17, v97
    v_mul_f32 v18, v18, v98
    v_mul_f32 v19, v19, v99
    v_cvt_pk_bf16_f32 v12, v16, v17
    v_lshlrev_b32 v16, 16, v12
    v_and_b32 v17, s40, v12
    v_cvt_pk_bf16_f32 v12, v18, v19
    v_lshlrev_b32 v18, 16, v12
    v_and_b32 v19, s40, v12
    v_mul_f32 v16, v16, v100
    v_mul_f32 v17, v17, v101
    v_mul_f32 v18, v18, v102
    v_mul_f32 v19, v19, v103
    v_cvt_pk_bf16_f32 v20, v16, v17
    v_cvt_pk_bf16_f32 v21, v18, v19
    buffer_store_dwordx2 v[20:21], v10, s[16:19], s24 offen offset:0
    s_nop 1
    v_cvt_pk_bf16_f32 v12, v104, v105
    v_lshlrev_b32 v104, 16, v12
    v_and_b32 v105, s40, v12
    v_cvt_pk_bf16_f32 v12, v108, v109
    v_lshlrev_b32 v108, 16, v12
    v_and_b32 v109, s40, v12
    v_cvt_pk_bf16_f32 v12, v106, v107
    v_lshlrev_b32 v106, 16, v12
    v_and_b32 v107, s40, v12
    v_cvt_pk_bf16_f32 v12, v110, v111
    v_lshlrev_b32 v110, 16, v12
    v_and_b32 v111, s40, v12
    v_mul_f32 v16, v104, v104
    v_mul_f32 v16, s29, v16
    v_fma_f32 v16, v16, v104, v104
    v_mul_f32 v16, s28, v16
    v_exp_f32 v16, -v16
    v_mul_f32 v17, v105, v105
    v_mul_f32 v17, s29, v17
    v_fma_f32 v17, v17, v105, v105
    v_mul_f32 v17, s28, v17
    v_exp_f32 v17, -v17
    v_mul_f32 v18, v106, v106
    v_mul_f32 v18, s29, v18
    v_fma_f32 v18, v18, v106, v106
    v_mul_f32 v18, s28, v18
    v_exp_f32 v18, -v18
    v_mul_f32 v19, v107, v107
    v_mul_f32 v19, s29, v19
    v_fma_f32 v19, v19, v107, v107
    v_mul_f32 v19, s28, v19
    v_exp_f32 v19, -v19
    s_nop 0
    v_add_f32 v16, 1.0, v16
    v_add_f32 v17, 1.0, v17
    v_add_f32 v18, 1.0, v18
    v_add_f32 v19, 1.0, v19
    v_rcp_f32 v16, v16
    v_rcp_f32 v17, v17
    v_rcp_f32 v18, v18
    v_rcp_f32 v19, v19
    s_nop 0
    v_mul_f32 v16, v16, v104
    v_mul_f32 v17, v17, v105
    v_mul_f32 v18, v18, v106
    v_mul_f32 v19, v19, v107
    v_cvt_pk_bf16_f32 v12, v16, v17
    v_lshlrev_b32 v16, 16, v12
    v_and_b32 v17, s40, v12
    v_cvt_pk_bf16_f32 v12, v18, v19
    v_lshlrev_b32 v18, 16, v12
    v_and_b32 v19, s40, v12
    v_mul_f32 v16, v16, v108
    v_mul_f32 v17, v17, v109
    v_mul_f32 v18, v18, v110
    v_mul_f32 v19, v19, v111
    v_cvt_pk_bf16_f32 v20, v16, v17
    v_cvt_pk_bf16_f32 v21, v18, v19
    buffer_store_dwordx2 v[20:21], v10, s[16:19], s24 offen offset:32
    s_nop 1
    s_mov_b32 s24, 49152
    v_cvt_pk_bf16_f32 v12, v112, v113
    v_lshlrev_b32 v112, 16, v12
    v_and_b32 v113, s40, v12
    v_cvt_pk_bf16_f32 v12, v116, v117
    v_lshlrev_b32 v116, 16, v12
    v_and_b32 v117, s40, v12
    v_cvt_pk_bf16_f32 v12, v114, v115
    v_lshlrev_b32 v114, 16, v12
    v_and_b32 v115, s40, v12
    v_cvt_pk_bf16_f32 v12, v118, v119
    v_lshlrev_b32 v118, 16, v12
    v_and_b32 v119, s40, v12
    v_mul_f32 v16, v112, v112
    v_mul_f32 v16, s29, v16
    v_fma_f32 v16, v16, v112, v112
    v_mul_f32 v16, s28, v16
    v_exp_f32 v16, -v16
    v_mul_f32 v17, v113, v113
    v_mul_f32 v17, s29, v17
    v_fma_f32 v17, v17, v113, v113
    v_mul_f32 v17, s28, v17
    v_exp_f32 v17, -v17
    v_mul_f32 v18, v114, v114
    v_mul_f32 v18, s29, v18
    v_fma_f32 v18, v18, v114, v114
    v_mul_f32 v18, s28, v18
    v_exp_f32 v18, -v18
    v_mul_f32 v19, v115, v115
    v_mul_f32 v19, s29, v19
    v_fma_f32 v19, v19, v115, v115
    v_mul_f32 v19, s28, v19
    v_exp_f32 v19, -v19
    s_nop 0
    v_add_f32 v16, 1.0, v16
    v_add_f32 v17, 1.0, v17
    v_add_f32 v18, 1.0, v18
    v_add_f32 v19, 1.0, v19
    v_rcp_f32 v16, v16
    v_rcp_f32 v17, v17
    v_rcp_f32 v18, v18
    v_rcp_f32 v19, v19
    s_nop 0
    v_mul_f32 v16, v16, v112
    v_mul_f32 v17, v17, v113
    v_mul_f32 v18, v18, v114
    v_mul_f32 v19, v19, v115
    v_cvt_pk_bf16_f32 v12, v16, v17
    v_lshlrev_b32 v16, 16, v12
    v_and_b32 v17, s40, v12
    v_cvt_pk_bf16_f32 v12, v18, v19
    v_lshlrev_b32 v18, 16, v12
    v_and_b32 v19, s40, v12
    v_mul_f32 v16, v16, v116
    v_mul_f32 v17, v17, v117
    v_mul_f32 v18, v18, v118
    v_mul_f32 v19, v19, v119
    v_cvt_pk_bf16_f32 v20, v16, v17
    v_cvt_pk_bf16_f32 v21, v18, v19
    buffer_store_dwordx2 v[20:21], v10, s[16:19], s24 offen offset:0
    s_nop 1
    v_cvt_pk_bf16_f32 v12, v120, v121
    v_lshlrev_b32 v120, 16, v12
    v_and_b32 v121, s40, v12
    v_cvt_pk_bf16_f32 v12, v124, v125
    v_lshlrev_b32 v124, 16, v12
    v_and_b32 v125, s40, v12
    v_cvt_pk_bf16_f32 v12, v122, v123
    v_lshlrev_b32 v122, 16, v12
    v_and_b32 v123, s40, v12
    v_cvt_pk_bf16_f32 v12, v126, v127
    v_lshlrev_b32 v126, 16, v12
    v_and_b32 v127, s40, v12
    v_mul_f32 v16, v120, v120
    v_mul_f32 v16, s29, v16
    v_fma_f32 v16, v16, v120, v120
    v_mul_f32 v16, s28, v16
    v_exp_f32 v16, -v16
    v_mul_f32 v17, v121, v121
    v_mul_f32 v17, s29, v17
    v_fma_f32 v17, v17, v121, v121
    v_mul_f32 v17, s28, v17
    v_exp_f32 v17, -v17
    v_mul_f32 v18, v122, v122
    v_mul_f32 v18, s29, v18
    v_fma_f32 v18, v18, v122, v122
    v_mul_f32 v18, s28, v18
    v_exp_f32 v18, -v18
    v_mul_f32 v19, v123, v123
    v_mul_f32 v19, s29, v19
    v_fma_f32 v19, v19, v123, v123
    v_mul_f32 v19, s28, v19
    v_exp_f32 v19, -v19
    s_nop 0
    v_add_f32 v16, 1.0, v16
    v_add_f32 v17, 1.0, v17
    v_add_f32 v18, 1.0, v18
    v_add_f32 v19, 1.0, v19
    v_rcp_f32 v16, v16
    v_rcp_f32 v17, v17
    v_rcp_f32 v18, v18
    v_rcp_f32 v19, v19
    s_nop 0
    v_mul_f32 v16, v16, v120
    v_mul_f32 v17, v17, v121
    v_mul_f32 v18, v18, v122
    v_mul_f32 v19, v19, v123
    v_cvt_pk_bf16_f32 v12, v16, v17
    v_lshlrev_b32 v16, 16, v12
    v_and_b32 v17, s40, v12
    v_cvt_pk_bf16_f32 v12, v18, v19
    v_lshlrev_b32 v18, 16, v12
    v_and_b32 v19, s40, v12
    v_mul_f32 v16, v16, v124
    v_mul_f32 v17, v17, v125
    v_mul_f32 v18, v18, v126
    v_mul_f32 v19, v19, v127
    v_cvt_pk_bf16_f32 v20, v16, v17
    v_cvt_pk_bf16_f32 v21, v18, v19
    buffer_store_dwordx2 v[20:21], v10, s[16:19], s24 offen offset:32
    s_nop 1
    s_mov_b32 s24, 98304
    v_cvt_pk_bf16_f32 v12, v128, v129
    v_lshlrev_b32 v128, 16, v12
    v_and_b32 v129, s40, v12
    v_cvt_pk_bf16_f32 v12, v132, v133
    v_lshlrev_b32 v132, 16, v12
    v_and_b32 v133, s40, v12
    v_cvt_pk_bf16_f32 v12, v130, v131
    v_lshlrev_b32 v130, 16, v12
    v_and_b32 v131, s40, v12
    v_cvt_pk_bf16_f32 v12, v134, v135
    v_lshlrev_b32 v134, 16, v12
    v_and_b32 v135, s40, v12
    v_mul_f32 v16, v128, v128
    v_mul_f32 v16, s29, v16
    v_fma_f32 v16, v16, v128, v128
    v_mul_f32 v16, s28, v16
    v_exp_f32 v16, -v16
    v_mul_f32 v17, v129, v129
    v_mul_f32 v17, s29, v17
    v_fma_f32 v17, v17, v129, v129
    v_mul_f32 v17, s28, v17
    v_exp_f32 v17, -v17
    v_mul_f32 v18, v130, v130
    v_mul_f32 v18, s29, v18
    v_fma_f32 v18, v18, v130, v130
    v_mul_f32 v18, s28, v18
    v_exp_f32 v18, -v18
    v_mul_f32 v19, v131, v131
    v_mul_f32 v19, s29, v19
    v_fma_f32 v19, v19, v131, v131
    v_mul_f32 v19, s28, v19
    v_exp_f32 v19, -v19
    s_nop 0
    v_add_f32 v16, 1.0, v16
    v_add_f32 v17, 1.0, v17
    v_add_f32 v18, 1.0, v18
    v_add_f32 v19, 1.0, v19
    v_rcp_f32 v16, v16
    v_rcp_f32 v17, v17
    v_rcp_f32 v18, v18
    v_rcp_f32 v19, v19
    s_nop 0
    v_mul_f32 v16, v16, v128
    v_mul_f32 v17, v17, v129
    v_mul_f32 v18, v18, v130
    v_mul_f32 v19, v19, v131
    v_cvt_pk_bf16_f32 v12, v16, v17
    v_lshlrev_b32 v16, 16, v12
    v_and_b32 v17, s40, v12
    v_cvt_pk_bf16_f32 v12, v18, v19
    v_lshlrev_b32 v18, 16, v12
    v_and_b32 v19, s40, v12
    v_mul_f32 v16, v16, v132
    v_mul_f32 v17, v17, v133
    v_mul_f32 v18, v18, v134
    v_mul_f32 v19, v19, v135
    v_cvt_pk_bf16_f32 v20, v16, v17
    v_cvt_pk_bf16_f32 v21, v18, v19
    buffer_store_dwordx2 v[20:21], v10, s[16:19], s24 offen offset:0
    s_nop 1
    v_cvt_pk_bf16_f32 v12, v136, v137
    v_lshlrev_b32 v136, 16, v12
    v_and_b32 v137, s40, v12
    v_cvt_pk_bf16_f32 v12, v140, v141
    v_lshlrev_b32 v140, 16, v12
    v_and_b32 v141, s40, v12
    v_cvt_pk_bf16_f32 v12, v138, v139
    v_lshlrev_b32 v138, 16, v12
    v_and_b32 v139, s40, v12
    v_cvt_pk_bf16_f32 v12, v142, v143
    v_lshlrev_b32 v142, 16, v12
    v_and_b32 v143, s40, v12
    v_mul_f32 v16, v136, v136
    v_mul_f32 v16, s29, v16
    v_fma_f32 v16, v16, v136, v136
    v_mul_f32 v16, s28, v16
    v_exp_f32 v16, -v16
    v_mul_f32 v17, v137, v137
    v_mul_f32 v17, s29, v17
    v_fma_f32 v17, v17, v137, v137
    v_mul_f32 v17, s28, v17
    v_exp_f32 v17, -v17
    v_mul_f32 v18, v138, v138
    v_mul_f32 v18, s29, v18
    v_fma_f32 v18, v18, v138, v138
    v_mul_f32 v18, s28, v18
    v_exp_f32 v18, -v18
    v_mul_f32 v19, v139, v139
    v_mul_f32 v19, s29, v19
    v_fma_f32 v19, v19, v139, v139
    v_mul_f32 v19, s28, v19
    v_exp_f32 v19, -v19
    s_nop 0
    v_add_f32 v16, 1.0, v16
    v_add_f32 v17, 1.0, v17
    v_add_f32 v18, 1.0, v18
    v_add_f32 v19, 1.0, v19
    v_rcp_f32 v16, v16
    v_rcp_f32 v17, v17
    v_rcp_f32 v18, v18
    v_rcp_f32 v19, v19
    s_nop 0
    v_mul_f32 v16, v16, v136
    v_mul_f32 v17, v17, v137
    v_mul_f32 v18, v18, v138
    v_mul_f32 v19, v19, v139
    v_cvt_pk_bf16_f32 v12, v16, v17
    v_lshlrev_b32 v16, 16, v12
    v_and_b32 v17, s40, v12
    v_cvt_pk_bf16_f32 v12, v18, v19
    v_lshlrev_b32 v18, 16, v12
    v_and_b32 v19, s40, v12
    v_mul_f32 v16, v16, v140
    v_mul_f32 v17, v17, v141
    v_mul_f32 v18, v18, v142
    v_mul_f32 v19, v19, v143
    v_cvt_pk_bf16_f32 v20, v16, v17
    v_cvt_pk_bf16_f32 v21, v18, v19
    buffer_store_dwordx2 v[20:21], v10, s[16:19], s24 offen offset:32
    s_nop 1
    s_mov_b32 s24, 147456
    v_cvt_pk_bf16_f32 v12, v144, v145
    v_lshlrev_b32 v144, 16, v12
    v_and_b32 v145, s40, v12
    v_cvt_pk_bf16_f32 v12, v148, v149
    v_lshlrev_b32 v148, 16, v12
    v_and_b32 v149, s40, v12
    v_cvt_pk_bf16_f32 v12, v146, v147
    v_lshlrev_b32 v146, 16, v12
    v_and_b32 v147, s40, v12
    v_cvt_pk_bf16_f32 v12, v150, v151
    v_lshlrev_b32 v150, 16, v12
    v_and_b32 v151, s40, v12
    v_mul_f32 v16, v144, v144
    v_mul_f32 v16, s29, v16
    v_fma_f32 v16, v16, v144, v144
    v_mul_f32 v16, s28, v16
    v_exp_f32 v16, -v16
    v_mul_f32 v17, v145, v145
    v_mul_f32 v17, s29, v17
    v_fma_f32 v17, v17, v145, v145
    v_mul_f32 v17, s28, v17
    v_exp_f32 v17, -v17
    v_mul_f32 v18, v146, v146
    v_mul_f32 v18, s29, v18
    v_fma_f32 v18, v18, v146, v146
    v_mul_f32 v18, s28, v18
    v_exp_f32 v18, -v18
    v_mul_f32 v19, v147, v147
    v_mul_f32 v19, s29, v19
    v_fma_f32 v19, v19, v147, v147
    v_mul_f32 v19, s28, v19
    v_exp_f32 v19, -v19
    s_nop 0
    v_add_f32 v16, 1.0, v16
    v_add_f32 v17, 1.0, v17
    v_add_f32 v18, 1.0, v18
    v_add_f32 v19, 1.0, v19
    v_rcp_f32 v16, v16
    v_rcp_f32 v17, v17
    v_rcp_f32 v18, v18
    v_rcp_f32 v19, v19
    s_nop 0
    v_mul_f32 v16, v16, v144
    v_mul_f32 v17, v17, v145
    v_mul_f32 v18, v18, v146
    v_mul_f32 v19, v19, v147
    v_cvt_pk_bf16_f32 v12, v16, v17
    v_lshlrev_b32 v16, 16, v12
    v_and_b32 v17, s40, v12
    v_cvt_pk_bf16_f32 v12, v18, v19
    v_lshlrev_b32 v18, 16, v12
    v_and_b32 v19, s40, v12
    v_mul_f32 v16, v16, v148
    v_mul_f32 v17, v17, v149
    v_mul_f32 v18, v18, v150
    v_mul_f32 v19, v19, v151
    v_cvt_pk_bf16_f32 v20, v16, v17
    v_cvt_pk_bf16_f32 v21, v18, v19
    buffer_store_dwordx2 v[20:21], v10, s[16:19], s24 offen offset:0
    s_nop 1
    v_cvt_pk_bf16_f32 v12, v152, v153
    v_lshlrev_b32 v152, 16, v12
    v_and_b32 v153, s40, v12
    v_cvt_pk_bf16_f32 v12, v156, v157
    v_lshlrev_b32 v156, 16, v12
    v_and_b32 v157, s40, v12
    v_cvt_pk_bf16_f32 v12, v154, v155
    v_lshlrev_b32 v154, 16, v12
    v_and_b32 v155, s40, v12
    v_cvt_pk_bf16_f32 v12, v158, v159
    v_lshlrev_b32 v158, 16, v12
    v_and_b32 v159, s40, v12
    v_mul_f32 v16, v152, v152
    v_mul_f32 v16, s29, v16
    v_fma_f32 v16, v16, v152, v152
    v_mul_f32 v16, s28, v16
    v_exp_f32 v16, -v16
    v_mul_f32 v17, v153, v153
    v_mul_f32 v17, s29, v17
    v_fma_f32 v17, v17, v153, v153
    v_mul_f32 v17, s28, v17
    v_exp_f32 v17, -v17
    v_mul_f32 v18, v154, v154
    v_mul_f32 v18, s29, v18
    v_fma_f32 v18, v18, v154, v154
    v_mul_f32 v18, s28, v18
    v_exp_f32 v18, -v18
    v_mul_f32 v19, v155, v155
    v_mul_f32 v19, s29, v19
    v_fma_f32 v19, v19, v155, v155
    v_mul_f32 v19, s28, v19
    v_exp_f32 v19, -v19
    s_nop 0
    v_add_f32 v16, 1.0, v16
    v_add_f32 v17, 1.0, v17
    v_add_f32 v18, 1.0, v18
    v_add_f32 v19, 1.0, v19
    v_rcp_f32 v16, v16
    v_rcp_f32 v17, v17
    v_rcp_f32 v18, v18
    v_rcp_f32 v19, v19
    s_nop 0
    v_mul_f32 v16, v16, v152
    v_mul_f32 v17, v17, v153
    v_mul_f32 v18, v18, v154
    v_mul_f32 v19, v19, v155
    v_cvt_pk_bf16_f32 v12, v16, v17
    v_lshlrev_b32 v16, 16, v12
    v_and_b32 v17, s40, v12
    v_cvt_pk_bf16_f32 v12, v18, v19
    v_lshlrev_b32 v18, 16, v12
    v_and_b32 v19, s40, v12
    v_mul_f32 v16, v16, v156
    v_mul_f32 v17, v17, v157
    v_mul_f32 v18, v18, v158
    v_mul_f32 v19, v19, v159
    v_cvt_pk_bf16_f32 v20, v16, v17
    v_cvt_pk_bf16_f32 v21, v18, v19
    buffer_store_dwordx2 v[20:21], v10, s[16:19], s24 offen offset:32
    s_nop 1
p5_end:
    s_endpgm
.section .rodata,"a"
.p2align 6
.amdhsa_kernel p5_kernel
  .amdhsa_next_free_vgpr 160
  .amdhsa_next_free_sgpr 102
  .amdhsa_accum_offset 160
  .amdhsa_group_segment_fixed_size 0
  .amdhsa_kernarg_size 112
  .amdhsa_user_sgpr_count 2
  .amdhsa_user_sgpr_kernarg_segment_ptr 1
  .amdhsa_system_sgpr_workgroup_id_x 1
  .amdhsa_float_denorm_mode_32 3
.end_amdhsa_kernel
.text
.globl p6_kernel
.p2align 8
.type p6_kernel,@function
p6_kernel:
    s_load_dwordx2 s[4:5], s[0:1], 104
    s_load_dwordx2 s[6:7], s[0:1], 88
    s_cmp_ge_u32 s2, 160
    s_cbranch_scc1 p6_end
    s_and_b32 s20, s2, 31
    s_lshr_b32 s21, s2, 5
    s_mov_b32 s22, 0
    s_waitcnt lgkmcnt(0)
    s_add_u32 s8, s4, 0xcf20000
    s_addc_u32 s9, s5, 0
    s_and_b32 s9, s9, 0xffff
    s_mov_b32 s10, 0x600000
    s_mov_b32 s11, 0x20000
    s_add_u32 s12, s4, 0x2440000
    s_addc_u32 s13, s5, 0
    s_and_b32 s13, s13, 0xffff
    s_mov_b32 s14, 0x1e0000
    s_mov_b32 s15, 0x20000
    s_add_u32 s16, s6, 0x0
    s_addc_u32 s17, s7, 0
    s_and_b32 s17, s17, 0xffff
    s_mov_b32 s18, 0x280000
    s_mov_b32 s19, 0x20000
    s_add_u32 s44, s4, 0xca20000
    s_addc_u32 s45, s5, 0
    s_and_b32 s45, s45, 0xffff
    s_mov_b32 s46, 0x280000
    s_mov_b32 s47, 0x20000
    v_and_b32 v1, 63, v0
    v_lshrrev_b32 v8, 6, v0
    s_nop 0
    v_readfirstlane_b32 s23, v8
    v_lshrrev_b32 v8, 3, v1
    v_and_b32 v9, 7, v1
    v_xor_b32 v9, v9, v8
    v_lshlrev_b32 v9, 4, v9
    s_mov_b32 s24, 3072
    v_mul_lo_u32 v2, v8, s24
    v_add_u32 v2, v2, v9
    s_mov_b32 s24, 3072
    v_mul_lo_u32 v3, v8, s24
    v_add_u32 v3, v3, v9
    s_mul_i32 s24, s20, 64
    s_mul_i32 s25, s23, 16
    s_add_u32 s24, s24, s25
    s_mul_i32 s24, s24, 3072
    s_mul_i32 s41, s23, 2048
    s_lshl_b32 s25, s23, 5
    s_add_u32 s30, s24, s22
    s_add_u32 s31, s30, 24576
    s_add_u32 s32, s30, 49152
    s_add_u32 s33, s30, 73728
    s_lshl_b32 s24, s21, 7
    s_add_u32 s24, s24, s25
    s_mul_i32 s24, s24, 3072
    s_add_u32 s34, s24, s22
    s_add_u32 s35, s34, 24576
    s_add_u32 s36, s34, 49152
    s_add_u32 s37, s34, 73728
    s_lshl_b32 s38, s23, 12
    v_and_b32 v8, 15, v1
    v_lshrrev_b32 v9, 4, v1
    v_and_b32 v10, 7, v8
    v_xor_b32 v10, v10, v9
    v_lshlrev_b32 v10, 4, v10
    v_lshl_add_u32 v10, v8, 7, v10
    s_lshr_b32 s26, s23, 1
    s_and_b32 s27, s23, 1
    s_mul_i32 s24, s26, 4096
    v_add_u32 v4, s24, v10
    v_xor_b32 v5, 64, v4
    s_lshl_b32 s24, s27, 13
    v_add_u32 v6, s24, v10
    v_xor_b32 v7, 64, v6
    v_add_u32 v12, 0x10000, v4
    v_add_u32 v13, 0x10000, v5
    v_add_u32 v14, 0x10000, v6
    v_add_u32 v15, 0x10000, v7
    v_mov_b32 v96, 0
    v_mov_b32 v97, 0
    v_mov_b32 v98, 0
    v_mov_b32 v99, 0
    v_mov_b32 v100, 0
    v_mov_b32 v101, 0
    v_mov_b32 v102, 0
    v_mov_b32 v103, 0
    v_mov_b32 v104, 0
    v_mov_b32 v105, 0
    v_mov_b32 v106, 0
    v_mov_b32 v107, 0
    v_mov_b32 v108, 0
    v_mov_b32 v109, 0
    v_mov_b32 v110, 0
    v_mov_b32 v111, 0
    v_mov_b32 v112, 0
    v_mov_b32 v113, 0
    v_mov_b32 v114, 0
    v_mov_b32 v115, 0
    v_mov_b32 v116, 0
    v_mov_b32 v117, 0
    v_mov_b32 v118, 0
    v_mov_b32 v119, 0
    v_mov_b32 v120, 0
    v_mov_b32 v121, 0
    v_mov_b32 v122, 0
    v_mov_b32 v123, 0
    v_mov_b32 v124, 0
    v_mov_b32 v125, 0
    v_mov_b32 v126, 0
    v_mov_b32 v127, 0
    s_add_u32 m0, s41, 0
    s_nop 0
    buffer_load_dwordx4 v2, s[8:11], s30 offen lds
    s_add_u32 s30, s30, 128
    s_add_u32 m0, s38, 16384
    s_nop 0
    buffer_load_dwordx4 v3, s[12:15], s34 offen lds
    s_add_u32 s34, s34, 128
    s_add_u32 m0, s41, 1024
    s_nop 0
    buffer_load_dwordx4 v2, s[8:11], s31 offen lds
    s_add_u32 s31, s31, 128
    s_add_u32 m0, s38, 17408
    s_nop 0
    buffer_load_dwordx4 v3, s[12:15], s35 offen lds
    s_add_u32 s35, s35, 128
    s_add_u32 m0, s38, 18432
    s_nop 0
    buffer_load_dwordx4 v3, s[12:15], s36 offen lds
    s_add_u32 s36, s36, 128
    s_add_u32 m0, s38, 19456
    s_nop 0
    buffer_load_dwordx4 v3, s[12:15], s37 offen lds
    s_add_u32 s37, s37, 128
    s_add_u32 m0, s41, 32768
    s_nop 0
    buffer_load_dwordx4 v2, s[8:11], s30 offen lds
    s_add_u32 s30, s30, 128
    s_add_u32 m0, s38, 49152
    s_nop 0
    buffer_load_dwordx4 v3, s[12:15], s34 offen lds
    s_add_u32 s34, s34, 128
    s_add_u32 m0, s41, 33792
    s_nop 0
    buffer_load_dwordx4 v2, s[8:11], s31 offen lds
    s_add_u32 s31, s31, 128
    s_add_u32 m0, s38, 50176
    s_nop 0
    buffer_load_dwordx4 v3, s[12:15], s35 offen lds
    s_add_u32 s35, s35, 128
    s_add_u32 m0, s38, 51200
    s_nop 0
    buffer_load_dwordx4 v3, s[12:15], s36 offen lds
    s_add_u32 s36, s36, 128
    s_add_u32 m0, s38, 52224
    s_nop 0
    buffer_load_dwordx4 v3, s[12:15], s37 offen lds
    s_add_u32 s37, s37, 128
    s_add_u32 m0, s41, 65536
    s_nop 0
    buffer_load_dwordx4 v2, s[8:11], s30 offen lds
    s_add_u32 s30, s30, 128
    s_add_u32 m0, s38, 81920
    s_nop 0
    buffer_load_dwordx4 v3, s[12:15], s34 offen lds
    s_add_u32 s34, s34, 128
    s_add_u32 m0, s41, 66560
    s_nop 0
    buffer_load_dwordx4 v2, s[8:11], s31 offen lds
    s_add_u32 s31, s31, 128
    s_add_u32 m0, s38, 82944
    s_nop 0
    buffer_load_dwordx4 v3, s[12:15], s35 offen lds
    s_add_u32 s35, s35, 128
    s_add_u32 m0, s38, 83968
    s_nop 0
    buffer_load_dwordx4 v3, s[12:15], s36 offen lds
    s_add_u32 s36, s36, 128
    s_add_u32 m0, s38, 84992
    s_nop 0
    buffer_load_dwordx4 v3, s[12:15], s37 offen lds
    s_add_u32 s37, s37, 128
    s_waitcnt vmcnt(12)
    s_barrier
    s_add_u32 m0, s41, 98304
    s_nop 0
    buffer_load_dwordx4 v2, s[8:11], s30 offen lds
    s_add_u32 s30, s30, 128
    s_add_u32 m0, s38, 114688
    s_nop 0
    buffer_load_dwordx4 v3, s[12:15], s34 offen lds
    s_add_u32 s34, s34, 128
    s_add_u32 m0, s41, 99328
    s_nop 0
    buffer_load_dwordx4 v2, s[8:11], s31 offen lds
    s_add_u32 s31, s31, 128
    s_add_u32 m0, s38, 115712
    s_nop 0
    buffer_load_dwordx4 v3, s[12:15], s35 offen lds
    s_add_u32 s35, s35, 128
    s_add_u32 m0, s38, 116736
    s_nop 0
    buffer_load_dwordx4 v3, s[12:15], s36 offen lds
    s_add_u32 s36, s36, 128
    s_add_u32 m0, s38, 117760
    s_nop 0
    buffer_load_dwordx4 v3, s[12:15], s37 offen lds
    s_add_u32 s37, s37, 128
    ds_read_b128 v[16:19], v4 offset:0
    ds_read_b128 v[20:23], v4 offset:2048
    ds_read_b128 v[32:35], v6 offset:16384
    ds_read_b128 v[36:39], v6 offset:18432
    ds_read_b128 v[40:43], v6 offset:20480
    ds_read_b128 v[44:47], v6 offset:22528
    ds_read_b128 v[48:51], v5 offset:0
    ds_read_b128 v[52:55], v5 offset:2048
    s_waitcnt lgkmcnt(2)
    v_mfma_f32_16x16x32_bf16 v[96:99], v[32:35], v[16:19], v[96:99]
    v_mfma_f32_16x16x32_bf16 v[100:103], v[36:39], v[16:19], v[100:103]
    v_mfma_f32_16x16x32_bf16 v[104:107], v[40:43], v[16:19], v[104:107]
    v_mfma_f32_16x16x32_bf16 v[108:111], v[44:47], v[16:19], v[108:111]
    ds_read_b128 v[64:67], v7 offset:16384
    ds_read_b128 v[68:71], v7 offset:18432
    ds_read_b128 v[72:75], v7 offset:20480
    ds_read_b128 v[76:79], v7 offset:22528
    v_mfma_f32_16x16x32_bf16 v[112:115], v[32:35], v[20:23], v[112:115]
    v_mfma_f32_16x16x32_bf16 v[116:119], v[36:39], v[20:23], v[116:119]
    v_mfma_f32_16x16x32_bf16 v[120:123], v[40:43], v[20:23], v[120:123]
    v_mfma_f32_16x16x32_bf16 v[124:127], v[44:47], v[20:23], v[124:127]
    s_waitcnt lgkmcnt(0)
    v_mfma_f32_16x16x32_bf16 v[96:99], v[64:67], v[48:51], v[96:99]
    v_mfma_f32_16x16x32_bf16 v[100:103], v[68:71], v[48:51], v[100:103]
    v_mfma_f32_16x16x32_bf16 v[104:107], v[72:75], v[48:51], v[104:107]
    v_mfma_f32_16x16x32_bf16 v[108:111], v[76:79], v[48:51], v[108:111]
    v_mfma_f32_16x16x32_bf16 v[112:115], v[64:67], v[52:55], v[112:115]
    v_mfma_f32_16x16x32_bf16 v[116:119], v[68:71], v[52:55], v[116:119]
    v_mfma_f32_16x16x32_bf16 v[120:123], v[72:75], v[52:55], v[120:123]
    v_mfma_f32_16x16x32_bf16 v[124:127], v[76:79], v[52:55], v[124:127]
    s_waitcnt vmcnt(12)
    s_barrier
    s_add_u32 m0, s41, 0
    s_nop 0
    buffer_load_dwordx4 v2, s[8:11], s30 offen lds
    s_add_u32 s30, s30, 128
    s_add_u32 m0, s38, 16384
    s_nop 0
    buffer_load_dwordx4 v3, s[12:15], s34 offen lds
    s_add_u32 s34, s34, 128
    s_add_u32 m0, s41, 1024
    s_nop 0
    buffer_load_dwordx4 v2, s[8:11], s31 offen lds
    s_add_u32 s31, s31, 128
    s_add_u32 m0, s38, 17408
    s_nop 0
    buffer_load_dwordx4 v3, s[12:15], s35 offen lds
    s_add_u32 s35, s35, 128
    s_add_u32 m0, s38, 18432
    s_nop 0
    buffer_load_dwordx4 v3, s[12:15], s36 offen lds
    s_add_u32 s36, s36, 128
    s_add_u32 m0, s38, 19456
    s_nop 0
    buffer_load_dwordx4 v3, s[12:15], s37 offen lds
    s_add_u32 s37, s37, 128
    ds_read_b128 v[16:19], v4 offset:32768
    ds_read_b128 v[20:23], v4 offset:34816
    ds_read_b128 v[32:35], v6 offset:49152
    ds_read_b128 v[36:39], v6 offset:51200
    ds_read_b128 v[40:43], v6 offset:53248
    ds_read_b128 v[44:47], v6 offset:55296
    ds_read_b128 v[48:51], v5 offset:32768
    ds_read_b128 v[52:55], v5 offset:34816
    s_waitcnt lgkmcnt(2)
    v_mfma_f32_16x16x32_bf16 v[96:99], v[32:35], v[16:19], v[96:99]
    v_mfma_f32_16x16x32_bf16 v[100:103], v[36:39], v[16:19], v[100:103]
    v_mfma_f32_16x16x32_bf16 v[104:107], v[40:43], v[16:19], v[104:107]
    v_mfma_f32_16x16x32_bf16 v[108:111], v[44:47], v[16:19], v[108:111]
    ds_read_b128 v[64:67], v7 offset:49152
    ds_read_b128 v[68:71], v7 offset:51200
    ds_read_b128 v[72:75], v7 offset:53248
    ds_read_b128 v[76:79], v7 offset:55296
    v_mfma_f32_16x16x32_bf16 v[112:115], v[32:35], v[20:23], v[112:115]
    v_mfma_f32_16x16x32_bf16 v[116:119], v[36:39], v[20:23], v[116:119]
    v_mfma_f32_16x16x32_bf16 v[120:123], v[40:43], v[20:23], v[120:123]
    v_mfma_f32_16x16x32_bf16 v[124:127], v[44:47], v[20:23], v[124:127]
    s_waitcnt lgkmcnt(0)
    v_mfma_f32_16x16x32_bf16 v[96:99], v[64:67], v[48:51], v[96:99]
    v_mfma_f32_16x16x32_bf16 v[100:103], v[68:71], v[48:51], v[100:103]
    v_mfma_f32_16x16x32_bf16 v[104:107], v[72:75], v[48:51], v[104:107]
    v_mfma_f32_16x16x32_bf16 v[108:111], v[76:79], v[48:51], v[108:111]
    v_mfma_f32_16x16x32_bf16 v[112:115], v[64:67], v[52:55], v[112:115]
    v_mfma_f32_16x16x32_bf16 v[116:119], v[68:71], v[52:55], v[116:119]
    v_mfma_f32_16x16x32_bf16 v[120:123], v[72:75], v[52:55], v[120:123]
    v_mfma_f32_16x16x32_bf16 v[124:127], v[76:79], v[52:55], v[124:127]
    s_waitcnt vmcnt(12)
    s_barrier
    s_add_u32 m0, s41, 32768
    s_nop 0
    buffer_load_dwordx4 v2, s[8:11], s30 offen lds
    s_add_u32 s30, s30, 128
    s_add_u32 m0, s38, 49152
    s_nop 0
    buffer_load_dwordx4 v3, s[12:15], s34 offen lds
    s_add_u32 s34, s34, 128
    s_add_u32 m0, s41, 33792
    s_nop 0
    buffer_load_dwordx4 v2, s[8:11], s31 offen lds
    s_add_u32 s31, s31, 128
    s_add_u32 m0, s38, 50176
    s_nop 0
    buffer_load_dwordx4 v3, s[12:15], s35 offen lds
    s_add_u32 s35, s35, 128
    s_add_u32 m0, s38, 51200
    s_nop 0
    buffer_load_dwordx4 v3, s[12:15], s36 offen lds
    s_add_u32 s36, s36, 128
    s_add_u32 m0, s38, 52224
    s_nop 0
    buffer_load_dwordx4 v3, s[12:15], s37 offen lds
    s_add_u32 s37, s37, 128
    ds_read_b128 v[16:19], v12 offset:0
    ds_read_b128 v[20:23], v12 offset:2048
    ds_read_b128 v[32:35], v14 offset:16384
    ds_read_b128 v[36:39], v14 offset:18432
    ds_read_b128 v[40:43], v14 offset:20480
    ds_read_b128 v[44:47], v14 offset:22528
    ds_read_b128 v[48:51], v13 offset:0
    ds_read_b128 v[52:55], v13 offset:2048
    s_waitcnt lgkmcnt(2)
    v_mfma_f32_16x16x32_bf16 v[96:99], v[32:35], v[16:19], v[96:99]
    v_mfma_f32_16x16x32_bf16 v[100:103], v[36:39], v[16:19], v[100:103]
    v_mfma_f32_16x16x32_bf16 v[104:107], v[40:43], v[16:19], v[104:107]
    v_mfma_f32_16x16x32_bf16 v[108:111], v[44:47], v[16:19], v[108:111]
    ds_read_b128 v[64:67], v15 offset:16384
    ds_read_b128 v[68:71], v15 offset:18432
    ds_read_b128 v[72:75], v15 offset:20480
    ds_read_b128 v[76:79], v15 offset:22528
    v_mfma_f32_16x16x32_bf16 v[112:115], v[32:35], v[20:23], v[112:115]
    v_mfma_f32_16x16x32_bf16 v[116:119], v[36:39], v[20:23], v[116:119]
    v_mfma_f32_16x16x32_bf16 v[120:123], v[40:43], v[20:23], v[120:123]
    v_mfma_f32_16x16x32_bf16 v[124:127], v[44:47], v[20:23], v[124:127]
    s_waitcnt lgkmcnt(0)
    v_mfma_f32_16x16x32_bf16 v[96:99], v[64:67], v[48:51], v[96:99]
    v_mfma_f32_16x16x32_bf16 v[100:103], v[68:71], v[48:51], v[100:103]
    v_mfma_f32_16x16x32_bf16 v[104:107], v[72:75], v[48:51], v[104:107]
    v_mfma_f32_16x16x32_bf16 v[108:111], v[76:79], v[48:51], v[108:111]
    v_mfma_f32_16x16x32_bf16 v[112:115], v[64:67], v[52:55], v[112:115]
    v_mfma_f32_16x16x32_bf16 v[116:119], v[68:71], v[52:55], v[116:119]
    v_mfma_f32_16x16x32_bf16 v[120:123], v[72:75], v[52:55], v[120:123]
    v_mfma_f32_16x16x32_bf16 v[124:127], v[76:79], v[52:55], v[124:127]
    s_waitcnt vmcnt(12)
    s_barrier
    s_add_u32 m0, s41, 65536
    s_nop 0
    buffer_load_dwordx4 v2, s[8:11], s30 offen lds
    s_add_u32 s30, s30, 128
    s_add_u32 m0, s38, 81920
    s_nop 0
    buffer_load_dwordx4 v3, s[12:15], s34 offen lds
    s_add_u32 s34, s34, 128
    s_add_u32 m0, s41, 66560
    s_nop 0
    buffer_load_dwordx4 v2, s[8:11], s31 offen lds
    s_add_u32 s31, s31, 128
    s_add_u32 m0, s38, 82944
    s_nop 0
    buffer_load_dwordx4 v3, s[12:15], s35 offen lds
    s_add_u32 s35, s35, 128
    s_add_u32 m0, s38, 83968
    s_nop 0
    buffer_load_dwordx4 v3, s[12:15], s36 offen lds
    s_add_u32 s36, s36, 128
    s_add_u32 m0, s38, 84992
    s_nop 0
    buffer_load_dwordx4 v3, s[12:15], s37 offen lds
    s_add_u32 s37, s37, 128
    ds_read_b128 v[16:19], v12 offset:32768
    ds_read_b128 v[20:23], v12 offset:34816
    ds_read_b128 v[32:35], v14 offset:49152
    ds_read_b128 v[36:39], v14 offset:51200
    ds_read_b128 v[40:43], v14 offset:53248
    ds_read_b128 v[44:47], v14 offset:55296
    ds_read_b128 v[48:51], v13 offset:32768
    ds_read_b128 v[52:55], v13 offset:34816
    s_waitcnt lgkmcnt(2)
    v_mfma_f32_16x16x32_bf16 v[96:99], v[32:35], v[16:19], v[96:99]
    v_mfma_f32_16x16x32_bf16 v[100:103], v[36:39], v[16:19], v[100:103]
    v_mfma_f32_16x16x32_bf16 v[104:107], v[40:43], v[16:19], v[104:107]
    v_mfma_f32_16x16x32_bf16 v[108:111], v[44:47], v[16:19], v[108:111]
    ds_read_b128 v[64:67], v15 offset:49152
    ds_read_b128 v[68:71], v15 offset:51200
    ds_read_b128 v[72:75], v15 offset:53248
    ds_read_b128 v[76:79], v15 offset:55296
    v_mfma_f32_16x16x32_bf16 v[112:115], v[32:35], v[20:23], v[112:115]
    v_mfma_f32_16x16x32_bf16 v[116:119], v[36:39], v[20:23], v[116:119]
    v_mfma_f32_16x16x32_bf16 v[120:123], v[40:43], v[20:23], v[120:123]
    v_mfma_f32_16x16x32_bf16 v[124:127], v[44:47], v[20:23], v[124:127]
    s_waitcnt lgkmcnt(0)
    v_mfma_f32_16x16x32_bf16 v[96:99], v[64:67], v[48:51], v[96:99]
    v_mfma_f32_16x16x32_bf16 v[100:103], v[68:71], v[48:51], v[100:103]
    v_mfma_f32_16x16x32_bf16 v[104:107], v[72:75], v[48:51], v[104:107]
    v_mfma_f32_16x16x32_bf16 v[108:111], v[76:79], v[48:51], v[108:111]
    v_mfma_f32_16x16x32_bf16 v[112:115], v[64:67], v[52:55], v[112:115]
    v_mfma_f32_16x16x32_bf16 v[116:119], v[68:71], v[52:55], v[116:119]
    v_mfma_f32_16x16x32_bf16 v[120:123], v[72:75], v[52:55], v[120:123]
    v_mfma_f32_16x16x32_bf16 v[124:127], v[76:79], v[52:55], v[124:127]
    s_waitcnt vmcnt(12)
    s_barrier
    s_add_u32 m0, s41, 98304
    s_nop 0
    buffer_load_dwordx4 v2, s[8:11], s30 offen lds
    s_add_u32 s30, s30, 128
    s_add_u32 m0, s38, 114688
    s_nop 0
    buffer_load_dwordx4 v3, s[12:15], s34 offen lds
    s_add_u32 s34, s34, 128
    s_add_u32 m0, s41, 99328
    s_nop 0
    buffer_load_dwordx4 v2, s[8:11], s31 offen lds
    s_add_u32 s31, s31, 128
    s_add_u32 m0, s38, 115712
    s_nop 0
    buffer_load_dwordx4 v3, s[12:15], s35 offen lds
    s_add_u32 s35, s35, 128
    s_add_u32 m0, s38, 116736
    s_nop 0
    buffer_load_dwordx4 v3, s[12:15], s36 offen lds
    s_add_u32 s36, s36, 128
    s_add_u32 m0, s38, 117760
    s_nop 0
    buffer_load_dwordx4 v3, s[12:15], s37 offen lds
    s_add_u32 s37, s37, 128
    ds_read_b128 v[16:19], v4 offset:0
    ds_read_b128 v[20:23], v4 offset:2048
    ds_read_b128 v[32:35], v6 offset:16384
    ds_read_b128 v[36:39], v6 offset:18432
    ds_read_b128 v[40:43], v6 offset:20480
    ds_read_b128 v[44:47], v6 offset:22528
    ds_read_b128 v[48:51], v5 offset:0
    ds_read_b128 v[52:55], v5 offset:2048
    s_waitcnt lgkmcnt(2)
    v_mfma_f32_16x16x32_bf16 v[96:99], v[32:35], v[16:19], v[96:99]
    v_mfma_f32_16x16x32_bf16 v[100:103], v[36:39], v[16:19], v[100:103]
    v_mfma_f32_16x16x32_bf16 v[104:107], v[40:43], v[16:19], v[104:107]
    v_mfma_f32_16x16x32_bf16 v[108:111], v[44:47], v[16:19], v[108:111]
    ds_read_b128 v[64:67], v7 offset:16384
    ds_read_b128 v[68:71], v7 offset:18432
    ds_read_b128 v[72:75], v7 offset:20480
    ds_read_b128 v[76:79], v7 offset:22528
    v_mfma_f32_16x16x32_bf16 v[112:115], v[32:35], v[20:23], v[112:115]
    v_mfma_f32_16x16x32_bf16 v[116:119], v[36:39], v[20:23], v[116:119]
    v_mfma_f32_16x16x32_bf16 v[120:123], v[40:43], v[20:23], v[120:123]
    v_mfma_f32_16x16x32_bf16 v[124:127], v[44:47], v[20:23], v[124:127]
    s_waitcnt lgkmcnt(0)
    v_mfma_f32_16x16x32_bf16 v[96:99], v[64:67], v[48:51], v[96:99]
    v_mfma_f32_16x16x32_bf16 v[100:103], v[68:71], v[48:51], v[100:103]
    v_mfma_f32_16x16x32_bf16 v[104:107], v[72:75], v[48:51], v[104:107]
    v_mfma_f32_16x16x32_bf16 v[108:111], v[76:79], v[48:51], v[108:111]
    v_mfma_f32_16x16x32_bf16 v[112:115], v[64:67], v[52:55], v[112:115]
    v_mfma_f32_16x16x32_bf16 v[116:119], v[68:71], v[52:55], v[116:119]
    v_mfma_f32_16x16x32_bf16 v[120:123], v[72:75], v[52:55], v[120:123]
    v_mfma_f32_16x16x32_bf16 v[124:127], v[76:79], v[52:55], v[124:127]
    s_waitcnt vmcnt(12)
    s_barrier
    s_add_u32 m0, s41, 0
    s_nop 0
    buffer_load_dwordx4 v2, s[8:11], s30 offen lds
    s_add_u32 s30, s30, 128
    s_add_u32 m0, s38, 16384
    s_nop 0
    buffer_load_dwordx4 v3, s[12:15], s34 offen lds
    s_add_u32 s34, s34, 128
    s_add_u32 m0, s41, 1024
    s_nop 0
    buffer_load_dwordx4 v2, s[8:11], s31 offen lds
    s_add_u32 s31, s31, 128
    s_add_u32 m0, s38, 17408
    s_nop 0
    buffer_load_dwordx4 v3, s[12:15], s35 offen lds
    s_add_u32 s35, s35, 128
    s_add_u32 m0, s38, 18432
    s_nop 0
    buffer_load_dwordx4 v3, s[12:15], s36 offen lds
    s_add_u32 s36, s36, 128
    s_add_u32 m0, s38, 19456
    s_nop 0
    buffer_load_dwordx4 v3, s[12:15], s37 offen lds
    s_add_u32 s37, s37, 128
    ds_read_b128 v[16:19], v4 offset:32768
    ds_read_b128 v[20:23], v4 offset:34816
    ds_read_b128 v[32:35], v6 offset:49152
    ds_read_b128 v[36:39], v6 offset:51200
    ds_read_b128 v[40:43], v6 offset:53248
    ds_read_b128 v[44:47], v6 offset:55296
    ds_read_b128 v[48:51], v5 offset:32768
    ds_read_b128 v[52:55], v5 offset:34816
    s_waitcnt lgkmcnt(2)
    v_mfma_f32_16x16x32_bf16 v[96:99], v[32:35], v[16:19], v[96:99]
    v_mfma_f32_16x16x32_bf16 v[100:103], v[36:39], v[16:19], v[100:103]
    v_mfma_f32_16x16x32_bf16 v[104:107], v[40:43], v[16:19], v[104:107]
    v_mfma_f32_16x16x32_bf16 v[108:111], v[44:47], v[16:19], v[108:111]
    ds_read_b128 v[64:67], v7 offset:49152
    ds_read_b128 v[68:71], v7 offset:51200
    ds_read_b128 v[72:75], v7 offset:53248
    ds_read_b128 v[76:79], v7 offset:55296
    v_mfma_f32_16x16x32_bf16 v[112:115], v[32:35], v[20:23], v[112:115]
    v_mfma_f32_16x16x32_bf16 v[116:119], v[36:39], v[20:23], v[116:119]
    v_mfma_f32_16x16x32_bf16 v[120:123], v[40:43], v[20:23], v[120:123]
    v_mfma_f32_16x16x32_bf16 v[124:127], v[44:47], v[20:23], v[124:127]
    s_waitcnt lgkmcnt(0)
    v_mfma_f32_16x16x32_bf16 v[96:99], v[64:67], v[48:51], v[96:99]
    v_mfma_f32_16x16x32_bf16 v[100:103], v[68:71], v[48:51], v[100:103]
    v_mfma_f32_16x16x32_bf16 v[104:107], v[72:75], v[48:51], v[104:107]
    v_mfma_f32_16x16x32_bf16 v[108:111], v[76:79], v[48:51], v[108:111]
    v_mfma_f32_16x16x32_bf16 v[112:115], v[64:67], v[52:55], v[112:115]
    v_mfma_f32_16x16x32_bf16 v[116:119], v[68:71], v[52:55], v[116:119]
    v_mfma_f32_16x16x32_bf16 v[120:123], v[72:75], v[52:55], v[120:123]
    v_mfma_f32_16x16x32_bf16 v[124:127], v[76:79], v[52:55], v[124:127]
    s_waitcnt vmcnt(12)
    s_barrier
    s_add_u32 m0, s41, 32768
    s_nop 0
    buffer_load_dwordx4 v2, s[8:11], s30 offen lds
    s_add_u32 s30, s30, 128
    s_add_u32 m0, s38, 49152
    s_nop 0
    buffer_load_dwordx4 v3, s[12:15], s34 offen lds
    s_add_u32 s34, s34, 128
    s_add_u32 m0, s41, 33792
    s_nop 0
    buffer_load_dwordx4 v2, s[8:11], s31 offen lds
    s_add_u32 s31, s31, 128
    s_add_u32 m0, s38, 50176
    s_nop 0
    buffer_load_dwordx4 v3, s[12:15], s35 offen lds
    s_add_u32 s35, s35, 128
    s_add_u32 m0, s38, 51200
    s_nop 0
    buffer_load_dwordx4 v3, s[12:15], s36 offen lds
    s_add_u32 s36, s36, 128
    s_add_u32 m0, s38, 52224
    s_nop 0
    buffer_load_dwordx4 v3, s[12:15], s37 offen lds
    s_add_u32 s37, s37, 128
    ds_read_b128 v[16:19], v12 offset:0
    ds_read_b128 v[20:23], v12 offset:2048
    ds_read_b128 v[32:35], v14 offset:16384
    ds_read_b128 v[36:39], v14 offset:18432
    ds_read_b128 v[40:43], v14 offset:20480
    ds_read_b128 v[44:47], v14 offset:22528
    ds_read_b128 v[48:51], v13 offset:0
    ds_read_b128 v[52:55], v13 offset:2048
    s_waitcnt lgkmcnt(2)
    v_mfma_f32_16x16x32_bf16 v[96:99], v[32:35], v[16:19], v[96:99]
    v_mfma_f32_16x16x32_bf16 v[100:103], v[36:39], v[16:19], v[100:103]
    v_mfma_f32_16x16x32_bf16 v[104:107], v[40:43], v[16:19], v[104:107]
    v_mfma_f32_16x16x32_bf16 v[108:111], v[44:47], v[16:19], v[108:111]
    ds_read_b128 v[64:67], v15 offset:16384
    ds_read_b128 v[68:71], v15 offset:18432
    ds_read_b128 v[72:75], v15 offset:20480
    ds_read_b128 v[76:79], v15 offset:22528
    v_mfma_f32_16x16x32_bf16 v[112:115], v[32:35], v[20:23], v[112:115]
    v_mfma_f32_16x16x32_bf16 v[116:119], v[36:39], v[20:23], v[116:119]
    v_mfma_f32_16x16x32_bf16 v[120:123], v[40:43], v[20:23], v[120:123]
    v_mfma_f32_16x16x32_bf16 v[124:127], v[44:47], v[20:23], v[124:127]
    s_waitcnt lgkmcnt(0)
    v_mfma_f32_16x16x32_bf16 v[96:99], v[64:67], v[48:51], v[96:99]
    v_mfma_f32_16x16x32_bf16 v[100:103], v[68:71], v[48:51], v[100:103]
    v_mfma_f32_16x16x32_bf16 v[104:107], v[72:75], v[48:51], v[104:107]
    v_mfma_f32_16x16x32_bf16 v[108:111], v[76:79], v[48:51], v[108:111]
    v_mfma_f32_16x16x32_bf16 v[112:115], v[64:67], v[52:55], v[112:115]
    v_mfma_f32_16x16x32_bf16 v[116:119], v[68:71], v[52:55], v[116:119]
    v_mfma_f32_16x16x32_bf16 v[120:123], v[72:75], v[52:55], v[120:123]
    v_mfma_f32_16x16x32_bf16 v[124:127], v[76:79], v[52:55], v[124:127]
    s_waitcnt vmcnt(12)
    s_barrier
    s_add_u32 m0, s41, 65536
    s_nop 0
    buffer_load_dwordx4 v2, s[8:11], s30 offen lds
    s_add_u32 s30, s30, 128
    s_add_u32 m0, s38, 81920
    s_nop 0
    buffer_load_dwordx4 v3, s[12:15], s34 offen lds
    s_add_u32 s34, s34, 128
    s_add_u32 m0, s41, 66560
    s_nop 0
    buffer_load_dwordx4 v2, s[8:11], s31 offen lds
    s_add_u32 s31, s31, 128
    s_add_u32 m0, s38, 82944
    s_nop 0
    buffer_load_dwordx4 v3, s[12:15], s35 offen lds
    s_add_u32 s35, s35, 128
    s_add_u32 m0, s38, 83968
    s_nop 0
    buffer_load_dwordx4 v3, s[12:15], s36 offen lds
    s_add_u32 s36, s36, 128
    s_add_u32 m0, s38, 84992
    s_nop 0
    buffer_load_dwordx4 v3, s[12:15], s37 offen lds
    s_add_u32 s37, s37, 128
    ds_read_b128 v[16:19], v12 offset:32768
    ds_read_b128 v[20:23], v12 offset:34816
    ds_read_b128 v[32:35], v14 offset:49152
    ds_read_b128 v[36:39], v14 offset:51200
    ds_read_b128 v[40:43], v14 offset:53248
    ds_read_b128 v[44:47], v14 offset:55296
    ds_read_b128 v[48:51], v13 offset:32768
    ds_read_b128 v[52:55], v13 offset:34816
    s_waitcnt lgkmcnt(2)
    v_mfma_f32_16x16x32_bf16 v[96:99], v[32:35], v[16:19], v[96:99]
    v_mfma_f32_16x16x32_bf16 v[100:103], v[36:39], v[16:19], v[100:103]
    v_mfma_f32_16x16x32_bf16 v[104:107], v[40:43], v[16:19], v[104:107]
    v_mfma_f32_16x16x32_bf16 v[108:111], v[44:47], v[16:19], v[108:111]
    ds_read_b128 v[64:67], v15 offset:49152
    ds_read_b128 v[68:71], v15 offset:51200
    ds_read_b128 v[72:75], v15 offset:53248
    ds_read_b128 v[76:79], v15 offset:55296
    v_mfma_f32_16x16x32_bf16 v[112:115], v[32:35], v[20:23], v[112:115]
    v_mfma_f32_16x16x32_bf16 v[116:119], v[36:39], v[20:23], v[116:119]
    v_mfma_f32_16x16x32_bf16 v[120:123], v[40:43], v[20:23], v[120:123]
    v_mfma_f32_16x16x32_bf16 v[124:127], v[44:47], v[20:23], v[124:127]
    s_waitcnt lgkmcnt(0)
    v_mfma_f32_16x16x32_bf16 v[96:99], v[64:67], v[48:51], v[96:99]
    v_mfma_f32_16x16x32_bf16 v[100:103], v[68:71], v[48:51], v[100:103]
    v_mfma_f32_16x16x32_bf16 v[104:107], v[72:75], v[48:51], v[104:107]
    v_mfma_f32_16x16x32_bf16 v[108:111], v[76:79], v[48:51], v[108:111]
    v_mfma_f32_16x16x32_bf16 v[112:115], v[64:67], v[52:55], v[112:115]
    v_mfma_f32_16x16x32_bf16 v[116:119], v[68:71], v[52:55], v[116:119]
    v_mfma_f32_16x16x32_bf16 v[120:123], v[72:75], v[52:55], v[120:123]
    v_mfma_f32_16x16x32_bf16 v[124:127], v[76:79], v[52:55], v[124:127]
    s_waitcnt vmcnt(12)
    s_barrier
    s_add_u32 m0, s41, 98304
    s_nop 0
    buffer_load_dwordx4 v2, s[8:11], s30 offen lds
    s_add_u32 s30, s30, 128
    s_add_u32 m0, s38, 114688
    s_nop 0
    buffer_load_dwordx4 v3, s[12:15], s34 offen lds
    s_add_u32 s34, s34, 128
    s_add_u32 m0, s41, 99328
    s_nop 0
    buffer_load_dwordx4 v2, s[8:11], s31 offen lds
    s_add_u32 s31, s31, 128
    s_add_u32 m0, s38, 115712
    s_nop 0
    buffer_load_dwordx4 v3, s[12:15], s35 offen lds
    s_add_u32 s35, s35, 128
    s_add_u32 m0, s38, 116736
    s_nop 0
    buffer_load_dwordx4 v3, s[12:15], s36 offen lds
    s_add_u32 s36, s36, 128
    s_add_u32 m0, s38, 117760
    s_nop 0
    buffer_load_dwordx4 v3, s[12:15], s37 offen lds
    s_add_u32 s37, s37, 128
    ds_read_b128 v[16:19], v4 offset:0
    ds_read_b128 v[20:23], v4 offset:2048
    ds_read_b128 v[32:35], v6 offset:16384
    ds_read_b128 v[36:39], v6 offset:18432
    ds_read_b128 v[40:43], v6 offset:20480
    ds_read_b128 v[44:47], v6 offset:22528
    ds_read_b128 v[48:51], v5 offset:0
    ds_read_b128 v[52:55], v5 offset:2048
    s_waitcnt lgkmcnt(2)
    v_mfma_f32_16x16x32_bf16 v[96:99], v[32:35], v[16:19], v[96:99]
    v_mfma_f32_16x16x32_bf16 v[100:103], v[36:39], v[16:19], v[100:103]
    v_mfma_f32_16x16x32_bf16 v[104:107], v[40:43], v[16:19], v[104:107]
    v_mfma_f32_16x16x32_bf16 v[108:111], v[44:47], v[16:19], v[108:111]
    ds_read_b128 v[64:67], v7 offset:16384
    ds_read_b128 v[68:71], v7 offset:18432
    ds_read_b128 v[72:75], v7 offset:20480
    ds_read_b128 v[76:79], v7 offset:22528
    v_mfma_f32_16x16x32_bf16 v[112:115], v[32:35], v[20:23], v[112:115]
    v_mfma_f32_16x16x32_bf16 v[116:119], v[36:39], v[20:23], v[116:119]
    v_mfma_f32_16x16x32_bf16 v[120:123], v[40:43], v[20:23], v[120:123]
    v_mfma_f32_16x16x32_bf16 v[124:127], v[44:47], v[20:23], v[124:127]
    s_waitcnt lgkmcnt(0)
    v_mfma_f32_16x16x32_bf16 v[96:99], v[64:67], v[48:51], v[96:99]
    v_mfma_f32_16x16x32_bf16 v[100:103], v[68:71], v[48:51], v[100:103]
    v_mfma_f32_16x16x32_bf16 v[104:107], v[72:75], v[48:51], v[104:107]
    v_mfma_f32_16x16x32_bf16 v[108:111], v[76:79], v[48:51], v[108:111]
    v_mfma_f32_16x16x32_bf16 v[112:115], v[64:67], v[52:55], v[112:115]
    v_mfma_f32_16x16x32_bf16 v[116:119], v[68:71], v[52:55], v[116:119]
    v_mfma_f32_16x16x32_bf16 v[120:123], v[72:75], v[52:55], v[120:123]
    v_mfma_f32_16x16x32_bf16 v[124:127], v[76:79], v[52:55], v[124:127]
    s_waitcnt vmcnt(12)
    s_barrier
    s_add_u32 m0, s41, 0
    s_nop 0
    buffer_load_dwordx4 v2, s[8:11], s30 offen lds
    s_add_u32 s30, s30, 128
    s_add_u32 m0, s38, 16384
    s_nop 0
    buffer_load_dwordx4 v3, s[12:15], s34 offen lds
    s_add_u32 s34, s34, 128
    s_add_u32 m0, s41, 1024
    s_nop 0
    buffer_load_dwordx4 v2, s[8:11], s31 offen lds
    s_add_u32 s31, s31, 128
    s_add_u32 m0, s38, 17408
    s_nop 0
    buffer_load_dwordx4 v3, s[12:15], s35 offen lds
    s_add_u32 s35, s35, 128
    s_add_u32 m0, s38, 18432
    s_nop 0
    buffer_load_dwordx4 v3, s[12:15], s36 offen lds
    s_add_u32 s36, s36, 128
    s_add_u32 m0, s38, 19456
    s_nop 0
    buffer_load_dwordx4 v3, s[12:15], s37 offen lds
    s_add_u32 s37, s37, 128
    ds_read_b128 v[16:19], v4 offset:32768
    ds_read_b128 v[20:23], v4 offset:34816
    ds_read_b128 v[32:35], v6 offset:49152
    ds_read_b128 v[36:39], v6 offset:51200
    ds_read_b128 v[40:43], v6 offset:53248
    ds_read_b128 v[44:47], v6 offset:55296
    ds_read_b128 v[48:51], v5 offset:32768
    ds_read_b128 v[52:55], v5 offset:34816
    s_waitcnt lgkmcnt(2)
    v_mfma_f32_16x16x32_bf16 v[96:99], v[32:35], v[16:19], v[96:99]
    v_mfma_f32_16x16x32_bf16 v[100:103], v[36:39], v[16:19], v[100:103]
    v_mfma_f32_16x16x32_bf16 v[104:107], v[40:43], v[16:19], v[104:107]
    v_mfma_f32_16x16x32_bf16 v[108:111], v[44:47], v[16:19], v[108:111]
    ds_read_b128 v[64:67], v7 offset:49152
    ds_read_b128 v[68:71], v7 offset:51200
    ds_read_b128 v[72:75], v7 offset:53248
    ds_read_b128 v[76:79], v7 offset:55296
    v_mfma_f32_16x16x32_bf16 v[112:115], v[32:35], v[20:23], v[112:115]
    v_mfma_f32_16x16x32_bf16 v[116:119], v[36:39], v[20:23], v[116:119]
    v_mfma_f32_16x16x32_bf16 v[120:123], v[40:43], v[20:23], v[120:123]
    v_mfma_f32_16x16x32_bf16 v[124:127], v[44:47], v[20:23], v[124:127]
    s_waitcnt lgkmcnt(0)
    v_mfma_f32_16x16x32_bf16 v[96:99], v[64:67], v[48:51], v[96:99]
    v_mfma_f32_16x16x32_bf16 v[100:103], v[68:71], v[48:51], v[100:103]
    v_mfma_f32_16x16x32_bf16 v[104:107], v[72:75], v[48:51], v[104:107]
    v_mfma_f32_16x16x32_bf16 v[108:111], v[76:79], v[48:51], v[108:111]
    v_mfma_f32_16x16x32_bf16 v[112:115], v[64:67], v[52:55], v[112:115]
    v_mfma_f32_16x16x32_bf16 v[116:119], v[68:71], v[52:55], v[116:119]
    v_mfma_f32_16x16x32_bf16 v[120:123], v[72:75], v[52:55], v[120:123]
    v_mfma_f32_16x16x32_bf16 v[124:127], v[76:79], v[52:55], v[124:127]
    s_waitcnt vmcnt(12)
    s_barrier
    s_add_u32 m0, s41, 32768
    s_nop 0
    buffer_load_dwordx4 v2, s[8:11], s30 offen lds
    s_add_u32 s30, s30, 128
    s_add_u32 m0, s38, 49152
    s_nop 0
    buffer_load_dwordx4 v3, s[12:15], s34 offen lds
    s_add_u32 s34, s34, 128
    s_add_u32 m0, s41, 33792
    s_nop 0
    buffer_load_dwordx4 v2, s[8:11], s31 offen lds
    s_add_u32 s31, s31, 128
    s_add_u32 m0, s38, 50176
    s_nop 0
    buffer_load_dwordx4 v3, s[12:15], s35 offen lds
    s_add_u32 s35, s35, 128
    s_add_u32 m0, s38, 51200
    s_nop 0
    buffer_load_dwordx4 v3, s[12:15], s36 offen lds
    s_add_u32 s36, s36, 128
    s_add_u32 m0, s38, 52224
    s_nop 0
    buffer_load_dwordx4 v3, s[12:15], s37 offen lds
    s_add_u32 s37, s37, 128
    ds_read_b128 v[16:19], v12 offset:0
    ds_read_b128 v[20:23], v12 offset:2048
    ds_read_b128 v[32:35], v14 offset:16384
    ds_read_b128 v[36:39], v14 offset:18432
    ds_read_b128 v[40:43], v14 offset:20480
    ds_read_b128 v[44:47], v14 offset:22528
    ds_read_b128 v[48:51], v13 offset:0
    ds_read_b128 v[52:55], v13 offset:2048
    s_waitcnt lgkmcnt(2)
    v_mfma_f32_16x16x32_bf16 v[96:99], v[32:35], v[16:19], v[96:99]
    v_mfma_f32_16x16x32_bf16 v[100:103], v[36:39], v[16:19], v[100:103]
    v_mfma_f32_16x16x32_bf16 v[104:107], v[40:43], v[16:19], v[104:107]
    v_mfma_f32_16x16x32_bf16 v[108:111], v[44:47], v[16:19], v[108:111]
    ds_read_b128 v[64:67], v15 offset:16384
    ds_read_b128 v[68:71], v15 offset:18432
    ds_read_b128 v[72:75], v15 offset:20480
    ds_read_b128 v[76:79], v15 offset:22528
    v_mfma_f32_16x16x32_bf16 v[112:115], v[32:35], v[20:23], v[112:115]
    v_mfma_f32_16x16x32_bf16 v[116:119], v[36:39], v[20:23], v[116:119]
    v_mfma_f32_16x16x32_bf16 v[120:123], v[40:43], v[20:23], v[120:123]
    v_mfma_f32_16x16x32_bf16 v[124:127], v[44:47], v[20:23], v[124:127]
    s_waitcnt lgkmcnt(0)
    v_mfma_f32_16x16x32_bf16 v[96:99], v[64:67], v[48:51], v[96:99]
    v_mfma_f32_16x16x32_bf16 v[100:103], v[68:71], v[48:51], v[100:103]
    v_mfma_f32_16x16x32_bf16 v[104:107], v[72:75], v[48:51], v[104:107]
    v_mfma_f32_16x16x32_bf16 v[108:111], v[76:79], v[48:51], v[108:111]
    v_mfma_f32_16x16x32_bf16 v[112:115], v[64:67], v[52:55], v[112:115]
    v_mfma_f32_16x16x32_bf16 v[116:119], v[68:71], v[52:55], v[116:119]
    v_mfma_f32_16x16x32_bf16 v[120:123], v[72:75], v[52:55], v[120:123]
    v_mfma_f32_16x16x32_bf16 v[124:127], v[76:79], v[52:55], v[124:127]
    s_waitcnt vmcnt(12)
    s_barrier
    s_add_u32 m0, s41, 65536
    s_nop 0
    buffer_load_dwordx4 v2, s[8:11], s30 offen lds
    s_add_u32 s30, s30, 128
    s_add_u32 m0, s38, 81920
    s_nop 0
    buffer_load_dwordx4 v3, s[12:15], s34 offen lds
    s_add_u32 s34, s34, 128
    s_add_u32 m0, s41, 66560
    s_nop 0
    buffer_load_dwordx4 v2, s[8:11], s31 offen lds
    s_add_u32 s31, s31, 128
    s_add_u32 m0, s38, 82944
    s_nop 0
    buffer_load_dwordx4 v3, s[12:15], s35 offen lds
    s_add_u32 s35, s35, 128
    s_add_u32 m0, s38, 83968
    s_nop 0
    buffer_load_dwordx4 v3, s[12:15], s36 offen lds
    s_add_u32 s36, s36, 128
    s_add_u32 m0, s38, 84992
    s_nop 0
    buffer_load_dwordx4 v3, s[12:15], s37 offen lds
    s_add_u32 s37, s37, 128
    ds_read_b128 v[16:19], v12 offset:32768
    ds_read_b128 v[20:23], v12 offset:34816
    ds_read_b128 v[32:35], v14 offset:49152
    ds_read_b128 v[36:39], v14 offset:51200
    ds_read_b128 v[40:43], v14 offset:53248
    ds_read_b128 v[44:47], v14 offset:55296
    ds_read_b128 v[48:51], v13 offset:32768
    ds_read_b128 v[52:55], v13 offset:34816
    s_waitcnt lgkmcnt(2)
    v_mfma_f32_16x16x32_bf16 v[96:99], v[32:35], v[16:19], v[96:99]
    v_mfma_f32_16x16x32_bf16 v[100:103], v[36:39], v[16:19], v[100:103]
    v_mfma_f32_16x16x32_bf16 v[104:107], v[40:43], v[16:19], v[104:107]
    v_mfma_f32_16x16x32_bf16 v[108:111], v[44:47], v[16:19], v[108:111]
    ds_read_b128 v[64:67], v15 offset:49152
    ds_read_b128 v[68:71], v15 offset:51200
    ds_read_b128 v[72:75], v15 offset:53248
    ds_read_b128 v[76:79], v15 offset:55296
    v_mfma_f32_16x16x32_bf16 v[112:115], v[32:35], v[20:23], v[112:115]
    v_mfma_f32_16x16x32_bf16 v[116:119], v[36:39], v[20:23], v[116:119]
    v_mfma_f32_16x16x32_bf16 v[120:123], v[40:43], v[20:23], v[120:123]
    v_mfma_f32_16x16x32_bf16 v[124:127], v[44:47], v[20:23], v[124:127]
    s_waitcnt lgkmcnt(0)
    v_mfma_f32_16x16x32_bf16 v[96:99], v[64:67], v[48:51], v[96:99]
    v_mfma_f32_16x16x32_bf16 v[100:103], v[68:71], v[48:51], v[100:103]
    v_mfma_f32_16x16x32_bf16 v[104:107], v[72:75], v[48:51], v[104:107]
    v_mfma_f32_16x16x32_bf16 v[108:111], v[76:79], v[48:51], v[108:111]
    v_mfma_f32_16x16x32_bf16 v[112:115], v[64:67], v[52:55], v[112:115]
    v_mfma_f32_16x16x32_bf16 v[116:119], v[68:71], v[52:55], v[116:119]
    v_mfma_f32_16x16x32_bf16 v[120:123], v[72:75], v[52:55], v[120:123]
    v_mfma_f32_16x16x32_bf16 v[124:127], v[76:79], v[52:55], v[124:127]
    s_waitcnt vmcnt(12)
    s_barrier
    s_add_u32 m0, s41, 98304
    s_nop 0
    buffer_load_dwordx4 v2, s[8:11], s30 offen lds
    s_add_u32 s30, s30, 128
    s_add_u32 m0, s38, 114688
    s_nop 0
    buffer_load_dwordx4 v3, s[12:15], s34 offen lds
    s_add_u32 s34, s34, 128
    s_add_u32 m0, s41, 99328
    s_nop 0
    buffer_load_dwordx4 v2, s[8:11], s31 offen lds
    s_add_u32 s31, s31, 128
    s_add_u32 m0, s38, 115712
    s_nop 0
    buffer_load_dwordx4 v3, s[12:15], s35 offen lds
    s_add_u32 s35, s35, 128
    s_add_u32 m0, s38, 116736
    s_nop 0
    buffer_load_dwordx4 v3, s[12:15], s36 offen lds
    s_add_u32 s36, s36, 128
    s_add_u32 m0, s38, 117760
    s_nop 0
    buffer_load_dwordx4 v3, s[12:15], s37 offen lds
    s_add_u32 s37, s37, 128
    ds_read_b128 v[16:19], v4 offset:0
    ds_read_b128 v[20:23], v4 offset:2048
    ds_read_b128 v[32:35], v6 offset:16384
    ds_read_b128 v[36:39], v6 offset:18432
    ds_read_b128 v[40:43], v6 offset:20480
    ds_read_b128 v[44:47], v6 offset:22528
    ds_read_b128 v[48:51], v5 offset:0
    ds_read_b128 v[52:55], v5 offset:2048
    s_waitcnt lgkmcnt(2)
    v_mfma_f32_16x16x32_bf16 v[96:99], v[32:35], v[16:19], v[96:99]
    v_mfma_f32_16x16x32_bf16 v[100:103], v[36:39], v[16:19], v[100:103]
    v_mfma_f32_16x16x32_bf16 v[104:107], v[40:43], v[16:19], v[104:107]
    v_mfma_f32_16x16x32_bf16 v[108:111], v[44:47], v[16:19], v[108:111]
    ds_read_b128 v[64:67], v7 offset:16384
    ds_read_b128 v[68:71], v7 offset:18432
    ds_read_b128 v[72:75], v7 offset:20480
    ds_read_b128 v[76:79], v7 offset:22528
    v_mfma_f32_16x16x32_bf16 v[112:115], v[32:35], v[20:23], v[112:115]
    v_mfma_f32_16x16x32_bf16 v[116:119], v[36:39], v[20:23], v[116:119]
    v_mfma_f32_16x16x32_bf16 v[120:123], v[40:43], v[20:23], v[120:123]
    v_mfma_f32_16x16x32_bf16 v[124:127], v[44:47], v[20:23], v[124:127]
    s_waitcnt lgkmcnt(0)
    v_mfma_f32_16x16x32_bf16 v[96:99], v[64:67], v[48:51], v[96:99]
    v_mfma_f32_16x16x32_bf16 v[100:103], v[68:71], v[48:51], v[100:103]
    v_mfma_f32_16x16x32_bf16 v[104:107], v[72:75], v[48:51], v[104:107]
    v_mfma_f32_16x16x32_bf16 v[108:111], v[76:79], v[48:51], v[108:111]
    v_mfma_f32_16x16x32_bf16 v[112:115], v[64:67], v[52:55], v[112:115]
    v_mfma_f32_16x16x32_bf16 v[116:119], v[68:71], v[52:55], v[116:119]
    v_mfma_f32_16x16x32_bf16 v[120:123], v[72:75], v[52:55], v[120:123]
    v_mfma_f32_16x16x32_bf16 v[124:127], v[76:79], v[52:55], v[124:127]
    s_waitcnt vmcnt(12)
    s_barrier
    s_add_u32 m0, s41, 0
    s_nop 0
    buffer_load_dwordx4 v2, s[8:11], s30 offen lds
    s_add_u32 s30, s30, 128
    s_add_u32 m0, s38, 16384
    s_nop 0
    buffer_load_dwordx4 v3, s[12:15], s34 offen lds
    s_add_u32 s34, s34, 128
    s_add_u32 m0, s41, 1024
    s_nop 0
    buffer_load_dwordx4 v2, s[8:11], s31 offen lds
    s_add_u32 s31, s31, 128
    s_add_u32 m0, s38, 17408
    s_nop 0
    buffer_load_dwordx4 v3, s[12:15], s35 offen lds
    s_add_u32 s35, s35, 128
    s_add_u32 m0, s38, 18432
    s_nop 0
    buffer_load_dwordx4 v3, s[12:15], s36 offen lds
    s_add_u32 s36, s36, 128
    s_add_u32 m0, s38, 19456
    s_nop 0
    buffer_load_dwordx4 v3, s[12:15], s37 offen lds
    s_add_u32 s37, s37, 128
    ds_read_b128 v[16:19], v4 offset:32768
    ds_read_b128 v[20:23], v4 offset:34816
    ds_read_b128 v[32:35], v6 offset:49152
    ds_read_b128 v[36:39], v6 offset:51200
    ds_read_b128 v[40:43], v6 offset:53248
    ds_read_b128 v[44:47], v6 offset:55296
    ds_read_b128 v[48:51], v5 offset:32768
    ds_read_b128 v[52:55], v5 offset:34816
    s_waitcnt lgkmcnt(2)
    v_mfma_f32_16x16x32_bf16 v[96:99], v[32:35], v[16:19], v[96:99]
    v_mfma_f32_16x16x32_bf16 v[100:103], v[36:39], v[16:19], v[100:103]
    v_mfma_f32_16x16x32_bf16 v[104:107], v[40:43], v[16:19], v[104:107]
    v_mfma_f32_16x16x32_bf16 v[108:111], v[44:47], v[16:19], v[108:111]
    ds_read_b128 v[64:67], v7 offset:49152
    ds_read_b128 v[68:71], v7 offset:51200
    ds_read_b128 v[72:75], v7 offset:53248
    ds_read_b128 v[76:79], v7 offset:55296
    v_mfma_f32_16x16x32_bf16 v[112:115], v[32:35], v[20:23], v[112:115]
    v_mfma_f32_16x16x32_bf16 v[116:119], v[36:39], v[20:23], v[116:119]
    v_mfma_f32_16x16x32_bf16 v[120:123], v[40:43], v[20:23], v[120:123]
    v_mfma_f32_16x16x32_bf16 v[124:127], v[44:47], v[20:23], v[124:127]
    s_waitcnt lgkmcnt(0)
    v_mfma_f32_16x16x32_bf16 v[96:99], v[64:67], v[48:51], v[96:99]
    v_mfma_f32_16x16x32_bf16 v[100:103], v[68:71], v[48:51], v[100:103]
    v_mfma_f32_16x16x32_bf16 v[104:107], v[72:75], v[48:51], v[104:107]
    v_mfma_f32_16x16x32_bf16 v[108:111], v[76:79], v[48:51], v[108:111]
    v_mfma_f32_16x16x32_bf16 v[112:115], v[64:67], v[52:55], v[112:115]
    v_mfma_f32_16x16x32_bf16 v[116:119], v[68:71], v[52:55], v[116:119]
    v_mfma_f32_16x16x32_bf16 v[120:123], v[72:75], v[52:55], v[120:123]
    v_mfma_f32_16x16x32_bf16 v[124:127], v[76:79], v[52:55], v[124:127]
    s_waitcnt vmcnt(12)
    s_barrier
    s_add_u32 m0, s41, 32768
    s_nop 0
    buffer_load_dwordx4 v2, s[8:11], s30 offen lds
    s_add_u32 s30, s30, 128
    s_add_u32 m0, s38, 49152
    s_nop 0
    buffer_load_dwordx4 v3, s[12:15], s34 offen lds
    s_add_u32 s34, s34, 128
    s_add_u32 m0, s41, 33792
    s_nop 0
    buffer_load_dwordx4 v2, s[8:11], s31 offen lds
    s_add_u32 s31, s31, 128
    s_add_u32 m0, s38, 50176
    s_nop 0
    buffer_load_dwordx4 v3, s[12:15], s35 offen lds
    s_add_u32 s35, s35, 128
    s_add_u32 m0, s38, 51200
    s_nop 0
    buffer_load_dwordx4 v3, s[12:15], s36 offen lds
    s_add_u32 s36, s36, 128
    s_add_u32 m0, s38, 52224
    s_nop 0
    buffer_load_dwordx4 v3, s[12:15], s37 offen lds
    s_add_u32 s37, s37, 128
    ds_read_b128 v[16:19], v12 offset:0
    ds_read_b128 v[20:23], v12 offset:2048
    ds_read_b128 v[32:35], v14 offset:16384
    ds_read_b128 v[36:39], v14 offset:18432
    ds_read_b128 v[40:43], v14 offset:20480
    ds_read_b128 v[44:47], v14 offset:22528
    ds_read_b128 v[48:51], v13 offset:0
    ds_read_b128 v[52:55], v13 offset:2048
    s_waitcnt lgkmcnt(2)
    v_mfma_f32_16x16x32_bf16 v[96:99], v[32:35], v[16:19], v[96:99]
    v_mfma_f32_16x16x32_bf16 v[100:103], v[36:39], v[16:19], v[100:103]
    v_mfma_f32_16x16x32_bf16 v[104:107], v[40:43], v[16:19], v[104:107]
    v_mfma_f32_16x16x32_bf16 v[108:111], v[44:47], v[16:19], v[108:111]
    ds_read_b128 v[64:67], v15 offset:16384
    ds_read_b128 v[68:71], v15 offset:18432
    ds_read_b128 v[72:75], v15 offset:20480
    ds_read_b128 v[76:79], v15 offset:22528
    v_mfma_f32_16x16x32_bf16 v[112:115], v[32:35], v[20:23], v[112:115]
    v_mfma_f32_16x16x32_bf16 v[116:119], v[36:39], v[20:23], v[116:119]
    v_mfma_f32_16x16x32_bf16 v[120:123], v[40:43], v[20:23], v[120:123]
    v_mfma_f32_16x16x32_bf16 v[124:127], v[44:47], v[20:23], v[124:127]
    s_waitcnt lgkmcnt(0)
    v_mfma_f32_16x16x32_bf16 v[96:99], v[64:67], v[48:51], v[96:99]
    v_mfma_f32_16x16x32_bf16 v[100:103], v[68:71], v[48:51], v[100:103]
    v_mfma_f32_16x16x32_bf16 v[104:107], v[72:75], v[48:51], v[104:107]
    v_mfma_f32_16x16x32_bf16 v[108:111], v[76:79], v[48:51], v[108:111]
    v_mfma_f32_16x16x32_bf16 v[112:115], v[64:67], v[52:55], v[112:115]
    v_mfma_f32_16x16x32_bf16 v[116:119], v[68:71], v[52:55], v[116:119]
    v_mfma_f32_16x16x32_bf16 v[120:123], v[72:75], v[52:55], v[120:123]
    v_mfma_f32_16x16x32_bf16 v[124:127], v[76:79], v[52:55], v[124:127]
    s_waitcnt vmcnt(12)
    s_barrier
    s_add_u32 m0, s41, 65536
    s_nop 0
    buffer_load_dwordx4 v2, s[8:11], s30 offen lds
    s_add_u32 s30, s30, 128
    s_add_u32 m0, s38, 81920
    s_nop 0
    buffer_load_dwordx4 v3, s[12:15], s34 offen lds
    s_add_u32 s34, s34, 128
    s_add_u32 m0, s41, 66560
    s_nop 0
    buffer_load_dwordx4 v2, s[8:11], s31 offen lds
    s_add_u32 s31, s31, 128
    s_add_u32 m0, s38, 82944
    s_nop 0
    buffer_load_dwordx4 v3, s[12:15], s35 offen lds
    s_add_u32 s35, s35, 128
    s_add_u32 m0, s38, 83968
    s_nop 0
    buffer_load_dwordx4 v3, s[12:15], s36 offen lds
    s_add_u32 s36, s36, 128
    s_add_u32 m0, s38, 84992
    s_nop 0
    buffer_load_dwordx4 v3, s[12:15], s37 offen lds
    s_add_u32 s37, s37, 128
    ds_read_b128 v[16:19], v12 offset:32768
    ds_read_b128 v[20:23], v12 offset:34816
    ds_read_b128 v[32:35], v14 offset:49152
    ds_read_b128 v[36:39], v14 offset:51200
    ds_read_b128 v[40:43], v14 offset:53248
    ds_read_b128 v[44:47], v14 offset:55296
    ds_read_b128 v[48:51], v13 offset:32768
    ds_read_b128 v[52:55], v13 offset:34816
    s_waitcnt lgkmcnt(2)
    v_mfma_f32_16x16x32_bf16 v[96:99], v[32:35], v[16:19], v[96:99]
    v_mfma_f32_16x16x32_bf16 v[100:103], v[36:39], v[16:19], v[100:103]
    v_mfma_f32_16x16x32_bf16 v[104:107], v[40:43], v[16:19], v[104:107]
    v_mfma_f32_16x16x32_bf16 v[108:111], v[44:47], v[16:19], v[108:111]
    ds_read_b128 v[64:67], v15 offset:49152
    ds_read_b128 v[68:71], v15 offset:51200
    ds_read_b128 v[72:75], v15 offset:53248
    ds_read_b128 v[76:79], v15 offset:55296
    v_mfma_f32_16x16x32_bf16 v[112:115], v[32:35], v[20:23], v[112:115]
    v_mfma_f32_16x16x32_bf16 v[116:119], v[36:39], v[20:23], v[116:119]
    v_mfma_f32_16x16x32_bf16 v[120:123], v[40:43], v[20:23], v[120:123]
    v_mfma_f32_16x16x32_bf16 v[124:127], v[44:47], v[20:23], v[124:127]
    s_waitcnt lgkmcnt(0)
    v_mfma_f32_16x16x32_bf16 v[96:99], v[64:67], v[48:51], v[96:99]
    v_mfma_f32_16x16x32_bf16 v[100:103], v[68:71], v[48:51], v[100:103]
    v_mfma_f32_16x16x32_bf16 v[104:107], v[72:75], v[48:51], v[104:107]
    v_mfma_f32_16x16x32_bf16 v[108:111], v[76:79], v[48:51], v[108:111]
    v_mfma_f32_16x16x32_bf16 v[112:115], v[64:67], v[52:55], v[112:115]
    v_mfma_f32_16x16x32_bf16 v[116:119], v[68:71], v[52:55], v[116:119]
    v_mfma_f32_16x16x32_bf16 v[120:123], v[72:75], v[52:55], v[120:123]
    v_mfma_f32_16x16x32_bf16 v[124:127], v[76:79], v[52:55], v[124:127]
    s_waitcnt vmcnt(12)
    s_barrier
    s_add_u32 m0, s41, 98304
    s_nop 0
    buffer_load_dwordx4 v2, s[8:11], s30 offen lds
    s_add_u32 s30, s30, 128
    s_add_u32 m0, s38, 114688
    s_nop 0
    buffer_load_dwordx4 v3, s[12:15], s34 offen lds
    s_add_u32 s34, s34, 128
    s_add_u32 m0, s41, 99328
    s_nop 0
    buffer_load_dwordx4 v2, s[8:11], s31 offen lds
    s_add_u32 s31, s31, 128
    s_add_u32 m0, s38, 115712
    s_nop 0
    buffer_load_dwordx4 v3, s[12:15], s35 offen lds
    s_add_u32 s35, s35, 128
    s_add_u32 m0, s38, 116736
    s_nop 0
    buffer_load_dwordx4 v3, s[12:15], s36 offen lds
    s_add_u32 s36, s36, 128
    s_add_u32 m0, s38, 117760
    s_nop 0
    buffer_load_dwordx4 v3, s[12:15], s37 offen lds
    s_add_u32 s37, s37, 128
    ds_read_b128 v[16:19], v4 offset:0
    ds_read_b128 v[20:23], v4 offset:2048
    ds_read_b128 v[32:35], v6 offset:16384
    ds_read_b128 v[36:39], v6 offset:18432
    ds_read_b128 v[40:43], v6 offset:20480
    ds_read_b128 v[44:47], v6 offset:22528
    ds_read_b128 v[48:51], v5 offset:0
    ds_read_b128 v[52:55], v5 offset:2048
    s_waitcnt lgkmcnt(2)
    v_mfma_f32_16x16x32_bf16 v[96:99], v[32:35], v[16:19], v[96:99]
    v_mfma_f32_16x16x32_bf16 v[100:103], v[36:39], v[16:19], v[100:103]
    v_mfma_f32_16x16x32_bf16 v[104:107], v[40:43], v[16:19], v[104:107]
    v_mfma_f32_16x16x32_bf16 v[108:111], v[44:47], v[16:19], v[108:111]
    ds_read_b128 v[64:67], v7 offset:16384
    ds_read_b128 v[68:71], v7 offset:18432
    ds_read_b128 v[72:75], v7 offset:20480
    ds_read_b128 v[76:79], v7 offset:22528
    v_mfma_f32_16x16x32_bf16 v[112:115], v[32:35], v[20:23], v[112:115]
    v_mfma_f32_16x16x32_bf16 v[116:119], v[36:39], v[20:23], v[116:119]
    v_mfma_f32_16x16x32_bf16 v[120:123], v[40:43], v[20:23], v[120:123]
    v_mfma_f32_16x16x32_bf16 v[124:127], v[44:47], v[20:23], v[124:127]
    s_waitcnt lgkmcnt(0)
    v_mfma_f32_16x16x32_bf16 v[96:99], v[64:67], v[48:51], v[96:99]
    v_mfma_f32_16x16x32_bf16 v[100:103], v[68:71], v[48:51], v[100:103]
    v_mfma_f32_16x16x32_bf16 v[104:107], v[72:75], v[48:51], v[104:107]
    v_mfma_f32_16x16x32_bf16 v[108:111], v[76:79], v[48:51], v[108:111]
    v_mfma_f32_16x16x32_bf16 v[112:115], v[64:67], v[52:55], v[112:115]
    v_mfma_f32_16x16x32_bf16 v[116:119], v[68:71], v[52:55], v[116:119]
    v_mfma_f32_16x16x32_bf16 v[120:123], v[72:75], v[52:55], v[120:123]
    v_mfma_f32_16x16x32_bf16 v[124:127], v[76:79], v[52:55], v[124:127]
    s_waitcnt vmcnt(12)
    s_barrier
    s_add_u32 m0, s41, 0
    s_nop 0
    buffer_load_dwordx4 v2, s[8:11], s30 offen lds
    s_add_u32 s30, s30, 128
    s_add_u32 m0, s38, 16384
    s_nop 0
    buffer_load_dwordx4 v3, s[12:15], s34 offen lds
    s_add_u32 s34, s34, 128
    s_add_u32 m0, s41, 1024
    s_nop 0
    buffer_load_dwordx4 v2, s[8:11], s31 offen lds
    s_add_u32 s31, s31, 128
    s_add_u32 m0, s38, 17408
    s_nop 0
    buffer_load_dwordx4 v3, s[12:15], s35 offen lds
    s_add_u32 s35, s35, 128
    s_add_u32 m0, s38, 18432
    s_nop 0
    buffer_load_dwordx4 v3, s[12:15], s36 offen lds
    s_add_u32 s36, s36, 128
    s_add_u32 m0, s38, 19456
    s_nop 0
    buffer_load_dwordx4 v3, s[12:15], s37 offen lds
    s_add_u32 s37, s37, 128
    ds_read_b128 v[16:19], v4 offset:32768
    ds_read_b128 v[20:23], v4 offset:34816
    ds_read_b128 v[32:35], v6 offset:49152
    ds_read_b128 v[36:39], v6 offset:51200
    ds_read_b128 v[40:43], v6 offset:53248
    ds_read_b128 v[44:47], v6 offset:55296
    ds_read_b128 v[48:51], v5 offset:32768
    ds_read_b128 v[52:55], v5 offset:34816
    s_waitcnt lgkmcnt(2)
    v_mfma_f32_16x16x32_bf16 v[96:99], v[32:35], v[16:19], v[96:99]
    v_mfma_f32_16x16x32_bf16 v[100:103], v[36:39], v[16:19], v[100:103]
    v_mfma_f32_16x16x32_bf16 v[104:107], v[40:43], v[16:19], v[104:107]
    v_mfma_f32_16x16x32_bf16 v[108:111], v[44:47], v[16:19], v[108:111]
    ds_read_b128 v[64:67], v7 offset:49152
    ds_read_b128 v[68:71], v7 offset:51200
    ds_read_b128 v[72:75], v7 offset:53248
    ds_read_b128 v[76:79], v7 offset:55296
    v_mfma_f32_16x16x32_bf16 v[112:115], v[32:35], v[20:23], v[112:115]
    v_mfma_f32_16x16x32_bf16 v[116:119], v[36:39], v[20:23], v[116:119]
    v_mfma_f32_16x16x32_bf16 v[120:123], v[40:43], v[20:23], v[120:123]
    v_mfma_f32_16x16x32_bf16 v[124:127], v[44:47], v[20:23], v[124:127]
    s_waitcnt lgkmcnt(0)
    v_mfma_f32_16x16x32_bf16 v[96:99], v[64:67], v[48:51], v[96:99]
    v_mfma_f32_16x16x32_bf16 v[100:103], v[68:71], v[48:51], v[100:103]
    v_mfma_f32_16x16x32_bf16 v[104:107], v[72:75], v[48:51], v[104:107]
    v_mfma_f32_16x16x32_bf16 v[108:111], v[76:79], v[48:51], v[108:111]
    v_mfma_f32_16x16x32_bf16 v[112:115], v[64:67], v[52:55], v[112:115]
    v_mfma_f32_16x16x32_bf16 v[116:119], v[68:71], v[52:55], v[116:119]
    v_mfma_f32_16x16x32_bf16 v[120:123], v[72:75], v[52:55], v[120:123]
    v_mfma_f32_16x16x32_bf16 v[124:127], v[76:79], v[52:55], v[124:127]
    s_waitcnt vmcnt(12)
    s_barrier
    s_add_u32 m0, s41, 32768
    s_nop 0
    buffer_load_dwordx4 v2, s[8:11], s30 offen lds
    s_add_u32 s30, s30, 128
    s_add_u32 m0, s38, 49152
    s_nop 0
    buffer_load_dwordx4 v3, s[12:15], s34 offen lds
    s_add_u32 s34, s34, 128
    s_add_u32 m0, s41, 33792
    s_nop 0
    buffer_load_dwordx4 v2, s[8:11], s31 offen lds
    s_add_u32 s31, s31, 128
    s_add_u32 m0, s38, 50176
    s_nop 0
    buffer_load_dwordx4 v3, s[12:15], s35 offen lds
    s_add_u32 s35, s35, 128
    s_add_u32 m0, s38, 51200
    s_nop 0
    buffer_load_dwordx4 v3, s[12:15], s36 offen lds
    s_add_u32 s36, s36, 128
    s_add_u32 m0, s38, 52224
    s_nop 0
    buffer_load_dwordx4 v3, s[12:15], s37 offen lds
    s_add_u32 s37, s37, 128
    ds_read_b128 v[16:19], v12 offset:0
    ds_read_b128 v[20:23], v12 offset:2048
    ds_read_b128 v[32:35], v14 offset:16384
    ds_read_b128 v[36:39], v14 offset:18432
    ds_read_b128 v[40:43], v14 offset:20480
    ds_read_b128 v[44:47], v14 offset:22528
    ds_read_b128 v[48:51], v13 offset:0
    ds_read_b128 v[52:55], v13 offset:2048
    s_waitcnt lgkmcnt(2)
    v_mfma_f32_16x16x32_bf16 v[96:99], v[32:35], v[16:19], v[96:99]
    v_mfma_f32_16x16x32_bf16 v[100:103], v[36:39], v[16:19], v[100:103]
    v_mfma_f32_16x16x32_bf16 v[104:107], v[40:43], v[16:19], v[104:107]
    v_mfma_f32_16x16x32_bf16 v[108:111], v[44:47], v[16:19], v[108:111]
    ds_read_b128 v[64:67], v15 offset:16384
    ds_read_b128 v[68:71], v15 offset:18432
    ds_read_b128 v[72:75], v15 offset:20480
    ds_read_b128 v[76:79], v15 offset:22528
    v_mfma_f32_16x16x32_bf16 v[112:115], v[32:35], v[20:23], v[112:115]
    v_mfma_f32_16x16x32_bf16 v[116:119], v[36:39], v[20:23], v[116:119]
    v_mfma_f32_16x16x32_bf16 v[120:123], v[40:43], v[20:23], v[120:123]
    v_mfma_f32_16x16x32_bf16 v[124:127], v[44:47], v[20:23], v[124:127]
    s_waitcnt lgkmcnt(0)
    v_mfma_f32_16x16x32_bf16 v[96:99], v[64:67], v[48:51], v[96:99]
    v_mfma_f32_16x16x32_bf16 v[100:103], v[68:71], v[48:51], v[100:103]
    v_mfma_f32_16x16x32_bf16 v[104:107], v[72:75], v[48:51], v[104:107]
    v_mfma_f32_16x16x32_bf16 v[108:111], v[76:79], v[48:51], v[108:111]
    v_mfma_f32_16x16x32_bf16 v[112:115], v[64:67], v[52:55], v[112:115]
    v_mfma_f32_16x16x32_bf16 v[116:119], v[68:71], v[52:55], v[116:119]
    v_mfma_f32_16x16x32_bf16 v[120:123], v[72:75], v[52:55], v[120:123]
    v_mfma_f32_16x16x32_bf16 v[124:127], v[76:79], v[52:55], v[124:127]
    s_waitcnt vmcnt(12)
    s_barrier
    s_add_u32 m0, s41, 65536
    s_nop 0
    buffer_load_dwordx4 v2, s[8:11], s30 offen lds
    s_add_u32 s30, s30, 128
    s_add_u32 m0, s38, 81920
    s_nop 0
    buffer_load_dwordx4 v3, s[12:15], s34 offen lds
    s_add_u32 s34, s34, 128
    s_add_u32 m0, s41, 66560
    s_nop 0
    buffer_load_dwordx4 v2, s[8:11], s31 offen lds
    s_add_u32 s31, s31, 128
    s_add_u32 m0, s38, 82944
    s_nop 0
    buffer_load_dwordx4 v3, s[12:15], s35 offen lds
    s_add_u32 s35, s35, 128
    s_add_u32 m0, s38, 83968
    s_nop 0
    buffer_load_dwordx4 v3, s[12:15], s36 offen lds
    s_add_u32 s36, s36, 128
    s_add_u32 m0, s38, 84992
    s_nop 0
    buffer_load_dwordx4 v3, s[12:15], s37 offen lds
    s_add_u32 s37, s37, 128
    ds_read_b128 v[16:19], v12 offset:32768
    ds_read_b128 v[20:23], v12 offset:34816
    ds_read_b128 v[32:35], v14 offset:49152
    ds_read_b128 v[36:39], v14 offset:51200
    ds_read_b128 v[40:43], v14 offset:53248
    ds_read_b128 v[44:47], v14 offset:55296
    ds_read_b128 v[48:51], v13 offset:32768
    ds_read_b128 v[52:55], v13 offset:34816
    s_waitcnt lgkmcnt(2)
    v_mfma_f32_16x16x32_bf16 v[96:99], v[32:35], v[16:19], v[96:99]
    v_mfma_f32_16x16x32_bf16 v[100:103], v[36:39], v[16:19], v[100:103]
    v_mfma_f32_16x16x32_bf16 v[104:107], v[40:43], v[16:19], v[104:107]
    v_mfma_f32_16x16x32_bf16 v[108:111], v[44:47], v[16:19], v[108:111]
    ds_read_b128 v[64:67], v15 offset:49152
    ds_read_b128 v[68:71], v15 offset:51200
    ds_read_b128 v[72:75], v15 offset:53248
    ds_read_b128 v[76:79], v15 offset:55296
    v_mfma_f32_16x16x32_bf16 v[112:115], v[32:35], v[20:23], v[112:115]
    v_mfma_f32_16x16x32_bf16 v[116:119], v[36:39], v[20:23], v[116:119]
    v_mfma_f32_16x16x32_bf16 v[120:123], v[40:43], v[20:23], v[120:123]
    v_mfma_f32_16x16x32_bf16 v[124:127], v[44:47], v[20:23], v[124:127]
    s_waitcnt lgkmcnt(0)
    v_mfma_f32_16x16x32_bf16 v[96:99], v[64:67], v[48:51], v[96:99]
    v_mfma_f32_16x16x32_bf16 v[100:103], v[68:71], v[48:51], v[100:103]
    v_mfma_f32_16x16x32_bf16 v[104:107], v[72:75], v[48:51], v[104:107]
    v_mfma_f32_16x16x32_bf16 v[108:111], v[76:79], v[48:51], v[108:111]
    v_mfma_f32_16x16x32_bf16 v[112:115], v[64:67], v[52:55], v[112:115]
    v_mfma_f32_16x16x32_bf16 v[116:119], v[68:71], v[52:55], v[116:119]
    v_mfma_f32_16x16x32_bf16 v[120:123], v[72:75], v[52:55], v[120:123]
    v_mfma_f32_16x16x32_bf16 v[124:127], v[76:79], v[52:55], v[124:127]
    s_waitcnt vmcnt(12)
    s_barrier
    s_add_u32 m0, s41, 98304
    s_nop 0
    buffer_load_dwordx4 v2, s[8:11], s30 offen lds
    s_add_u32 s30, s30, 128
    s_add_u32 m0, s38, 114688
    s_nop 0
    buffer_load_dwordx4 v3, s[12:15], s34 offen lds
    s_add_u32 s34, s34, 128
    s_add_u32 m0, s41, 99328
    s_nop 0
    buffer_load_dwordx4 v2, s[8:11], s31 offen lds
    s_add_u32 s31, s31, 128
    s_add_u32 m0, s38, 115712
    s_nop 0
    buffer_load_dwordx4 v3, s[12:15], s35 offen lds
    s_add_u32 s35, s35, 128
    s_add_u32 m0, s38, 116736
    s_nop 0
    buffer_load_dwordx4 v3, s[12:15], s36 offen lds
    s_add_u32 s36, s36, 128
    s_add_u32 m0, s38, 117760
    s_nop 0
    buffer_load_dwordx4 v3, s[12:15], s37 offen lds
    s_add_u32 s37, s37, 128
    ds_read_b128 v[16:19], v4 offset:0
    ds_read_b128 v[20:23], v4 offset:2048
    ds_read_b128 v[32:35], v6 offset:16384
    ds_read_b128 v[36:39], v6 offset:18432
    ds_read_b128 v[40:43], v6 offset:20480
    ds_read_b128 v[44:47], v6 offset:22528
    ds_read_b128 v[48:51], v5 offset:0
    ds_read_b128 v[52:55], v5 offset:2048
    s_waitcnt lgkmcnt(2)
    v_mfma_f32_16x16x32_bf16 v[96:99], v[32:35], v[16:19], v[96:99]
    v_mfma_f32_16x16x32_bf16 v[100:103], v[36:39], v[16:19], v[100:103]
    v_mfma_f32_16x16x32_bf16 v[104:107], v[40:43], v[16:19], v[104:107]
    v_mfma_f32_16x16x32_bf16 v[108:111], v[44:47], v[16:19], v[108:111]
    ds_read_b128 v[64:67], v7 offset:16384
    ds_read_b128 v[68:71], v7 offset:18432
    ds_read_b128 v[72:75], v7 offset:20480
    ds_read_b128 v[76:79], v7 offset:22528
    v_mfma_f32_16x16x32_bf16 v[112:115], v[32:35], v[20:23], v[112:115]
    v_mfma_f32_16x16x32_bf16 v[116:119], v[36:39], v[20:23], v[116:119]
    v_mfma_f32_16x16x32_bf16 v[120:123], v[40:43], v[20:23], v[120:123]
    v_mfma_f32_16x16x32_bf16 v[124:127], v[44:47], v[20:23], v[124:127]
    s_waitcnt lgkmcnt(0)
    v_mfma_f32_16x16x32_bf16 v[96:99], v[64:67], v[48:51], v[96:99]
    v_mfma_f32_16x16x32_bf16 v[100:103], v[68:71], v[48:51], v[100:103]
    v_mfma_f32_16x16x32_bf16 v[104:107], v[72:75], v[48:51], v[104:107]
    v_mfma_f32_16x16x32_bf16 v[108:111], v[76:79], v[48:51], v[108:111]
    v_mfma_f32_16x16x32_bf16 v[112:115], v[64:67], v[52:55], v[112:115]
    v_mfma_f32_16x16x32_bf16 v[116:119], v[68:71], v[52:55], v[116:119]
    v_mfma_f32_16x16x32_bf16 v[120:123], v[72:75], v[52:55], v[120:123]
    v_mfma_f32_16x16x32_bf16 v[124:127], v[76:79], v[52:55], v[124:127]
    s_waitcnt vmcnt(12)
    s_barrier
    ds_read_b128 v[16:19], v4 offset:32768
    ds_read_b128 v[20:23], v4 offset:34816
    ds_read_b128 v[32:35], v6 offset:49152
    ds_read_b128 v[36:39], v6 offset:51200
    ds_read_b128 v[40:43], v6 offset:53248
    ds_read_b128 v[44:47], v6 offset:55296
    ds_read_b128 v[48:51], v5 offset:32768
    ds_read_b128 v[52:55], v5 offset:34816
    s_waitcnt lgkmcnt(2)
    v_mfma_f32_16x16x32_bf16 v[96:99], v[32:35], v[16:19], v[96:99]
    v_mfma_f32_16x16x32_bf16 v[100:103], v[36:39], v[16:19], v[100:103]
    v_mfma_f32_16x16x32_bf16 v[104:107], v[40:43], v[16:19], v[104:107]
    v_mfma_f32_16x16x32_bf16 v[108:111], v[44:47], v[16:19], v[108:111]
    ds_read_b128 v[64:67], v7 offset:49152
    ds_read_b128 v[68:71], v7 offset:51200
    ds_read_b128 v[72:75], v7 offset:53248
    ds_read_b128 v[76:79], v7 offset:55296
    v_mfma_f32_16x16x32_bf16 v[112:115], v[32:35], v[20:23], v[112:115]
    v_mfma_f32_16x16x32_bf16 v[116:119], v[36:39], v[20:23], v[116:119]
    v_mfma_f32_16x16x32_bf16 v[120:123], v[40:43], v[20:23], v[120:123]
    v_mfma_f32_16x16x32_bf16 v[124:127], v[44:47], v[20:23], v[124:127]
    s_waitcnt lgkmcnt(0)
    v_mfma_f32_16x16x32_bf16 v[96:99], v[64:67], v[48:51], v[96:99]
    v_mfma_f32_16x16x32_bf16 v[100:103], v[68:71], v[48:51], v[100:103]
    v_mfma_f32_16x16x32_bf16 v[104:107], v[72:75], v[48:51], v[104:107]
    v_mfma_f32_16x16x32_bf16 v[108:111], v[76:79], v[48:51], v[108:111]
    v_mfma_f32_16x16x32_bf16 v[112:115], v[64:67], v[52:55], v[112:115]
    v_mfma_f32_16x16x32_bf16 v[116:119], v[68:71], v[52:55], v[116:119]
    v_mfma_f32_16x16x32_bf16 v[120:123], v[72:75], v[52:55], v[120:123]
    v_mfma_f32_16x16x32_bf16 v[124:127], v[76:79], v[52:55], v[124:127]
    s_waitcnt vmcnt(6)
    s_barrier
    ds_read_b128 v[16:19], v12 offset:0
    ds_read_b128 v[20:23], v12 offset:2048
    ds_read_b128 v[32:35], v14 offset:16384
    ds_read_b128 v[36:39], v14 offset:18432
    ds_read_b128 v[40:43], v14 offset:20480
    ds_read_b128 v[44:47], v14 offset:22528
    ds_read_b128 v[48:51], v13 offset:0
    ds_read_b128 v[52:55], v13 offset:2048
    s_waitcnt lgkmcnt(2)
    v_mfma_f32_16x16x32_bf16 v[96:99], v[32:35], v[16:19], v[96:99]
    v_mfma_f32_16x16x32_bf16 v[100:103], v[36:39], v[16:19], v[100:103]
    v_mfma_f32_16x16x32_bf16 v[104:107], v[40:43], v[16:19], v[104:107]
    v_mfma_f32_16x16x32_bf16 v[108:111], v[44:47], v[16:19], v[108:111]
    ds_read_b128 v[64:67], v15 offset:16384
    ds_read_b128 v[68:71], v15 offset:18432
    ds_read_b128 v[72:75], v15 offset:20480
    ds_read_b128 v[76:79], v15 offset:22528
    v_mfma_f32_16x16x32_bf16 v[112:115], v[32:35], v[20:23], v[112:115]
    v_mfma_f32_16x16x32_bf16 v[116:119], v[36:39], v[20:23], v[116:119]
    v_mfma_f32_16x16x32_bf16 v[120:123], v[40:43], v[20:23], v[120:123]
    v_mfma_f32_16x16x32_bf16 v[124:127], v[44:47], v[20:23], v[124:127]
    s_waitcnt lgkmcnt(0)
    v_mfma_f32_16x16x32_bf16 v[96:99], v[64:67], v[48:51], v[96:99]
    v_mfma_f32_16x16x32_bf16 v[100:103], v[68:71], v[48:51], v[100:103]
    v_mfma_f32_16x16x32_bf16 v[104:107], v[72:75], v[48:51], v[104:107]
    v_mfma_f32_16x16x32_bf16 v[108:111], v[76:79], v[48:51], v[108:111]
    v_mfma_f32_16x16x32_bf16 v[112:115], v[64:67], v[52:55], v[112:115]
    v_mfma_f32_16x16x32_bf16 v[116:119], v[68:71], v[52:55], v[116:119]
    v_mfma_f32_16x16x32_bf16 v[120:123], v[72:75], v[52:55], v[120:123]
    v_mfma_f32_16x16x32_bf16 v[124:127], v[76:79], v[52:55], v[124:127]
    s_waitcnt vmcnt(0)
    s_barrier
    ds_read_b128 v[16:19], v12 offset:32768
    ds_read_b128 v[20:23], v12 offset:34816
    ds_read_b128 v[32:35], v14 offset:49152
    ds_read_b128 v[36:39], v14 offset:51200
    ds_read_b128 v[40:43], v14 offset:53248
    ds_read_b128 v[44:47], v14 offset:55296
    ds_read_b128 v[48:51], v13 offset:32768
    ds_read_b128 v[52:55], v13 offset:34816
    s_waitcnt lgkmcnt(2)
    v_mfma_f32_16x16x32_bf16 v[96:99], v[32:35], v[16:19], v[96:99]
    v_mfma_f32_16x16x32_bf16 v[100:103], v[36:39], v[16:19], v[100:103]
    v_mfma_f32_16x16x32_bf16 v[104:107], v[40:43], v[16:19], v[104:107]
    v_mfma_f32_16x16x32_bf16 v[108:111], v[44:47], v[16:19], v[108:111]
    ds_read_b128 v[64:67], v15 offset:49152
    ds_read_b128 v[68:71], v15 offset:51200
    ds_read_b128 v[72:75], v15 offset:53248
    ds_read_b128 v[76:79], v15 offset:55296
    v_mfma_f32_16x16x32_bf16 v[112:115], v[32:35], v[20:23], v[112:115]
    v_mfma_f32_16x16x32_bf16 v[116:119], v[36:39], v[20:23], v[116:119]
    v_mfma_f32_16x16x32_bf16 v[120:123], v[40:43], v[20:23], v[120:123]
    v_mfma_f32_16x16x32_bf16 v[124:127], v[44:47], v[20:23], v[124:127]
    s_waitcnt lgkmcnt(0)
    v_mfma_f32_16x16x32_bf16 v[96:99], v[64:67], v[48:51], v[96:99]
    v_mfma_f32_16x16x32_bf16 v[100:103], v[68:71], v[48:51], v[100:103]
    v_mfma_f32_16x16x32_bf16 v[104:107], v[72:75], v[48:51], v[104:107]
    v_mfma_f32_16x16x32_bf16 v[108:111], v[76:79], v[48:51], v[108:111]
    v_mfma_f32_16x16x32_bf16 v[112:115], v[64:67], v[52:55], v[112:115]
    v_mfma_f32_16x16x32_bf16 v[116:119], v[68:71], v[52:55], v[116:119]
    v_mfma_f32_16x16x32_bf16 v[120:123], v[72:75], v[52:55], v[120:123]
    v_mfma_f32_16x16x32_bf16 v[124:127], v[76:79], v[52:55], v[124:127]
    s_nop 7
    s_nop 3
    s_mul_i32 s24, s20, 64
    s_mul_i32 s25, s26, 32
    s_add_u32 s24, s24, s25
    v_add_u32 v10, s24, v8
    s_mov_b32 s25, 1280
    v_mul_lo_u32 v10, v10, s25
    s_lshl_b32 s24, s21, 7
    s_lshl_b32 s25, s27, 6
    s_add_u32 s24, s24, s25
    s_mul_i32 s24, s24, 2
    v_lshlrev_b32 v11, 2, v9
    v_mul_u32_u24 v11, 2, v11
    v_add3_u32 v10, v10, v11, s24
    s_mov_b32 s24, 0
    buffer_load_dwordx2 v[16:17], v10, s[44:47], s24 offen offset:0
    buffer_load_dwordx2 v[18:19], v10, s[44:47], s24 offen offset:32
    buffer_load_dwordx2 v[20:21], v10, s[44:47], s24 offen offset:64
    buffer_load_dwordx2 v[22:23], v10, s[44:47], s24 offen offset:96
    s_waitcnt vmcnt(0)
    v_cvt_pk_bf16_f32 v12, v96, v97
    v_lshlrev_b32 v96, 16, v12
    v_and_b32 v97, 0xffff0000, v12
    v_lshlrev_b32 v12, 16, v16
    v_and_b32 v13, 0xffff0000, v16
    v_add_f32 v96, v96, v12
    v_add_f32 v97, v97, v13
    v_cvt_pk_bf16_f32 v12, v98, v99
    v_lshlrev_b32 v98, 16, v12
    v_and_b32 v99, 0xffff0000, v12
    v_lshlrev_b32 v12, 16, v17
    v_and_b32 v13, 0xffff0000, v17
    v_add_f32 v98, v98, v12
    v_add_f32 v99, v99, v13
    v_cvt_pk_bf16_f32 v24, v96, v97
    v_cvt_pk_bf16_f32 v25, v98, v99
    buffer_store_dwordx2 v[24:25], v10, s[16:19], s24 offen offset:0
    v_cvt_pk_bf16_f32 v12, v100, v101
    v_lshlrev_b32 v100, 16, v12
    v_and_b32 v101, 0xffff0000, v12
    v_lshlrev_b32 v12, 16, v18
    v_and_b32 v13, 0xffff0000, v18
    v_add_f32 v100, v100, v12
    v_add_f32 v101, v101, v13
    v_cvt_pk_bf16_f32 v12, v102, v103
    v_lshlrev_b32 v102, 16, v12
    v_and_b32 v103, 0xffff0000, v12
    v_lshlrev_b32 v12, 16, v19
    v_and_b32 v13, 0xffff0000, v19
    v_add_f32 v102, v102, v12
    v_add_f32 v103, v103, v13
    v_cvt_pk_bf16_f32 v26, v100, v101
    v_cvt_pk_bf16_f32 v27, v102, v103
    buffer_store_dwordx2 v[26:27], v10, s[16:19], s24 offen offset:32
    v_cvt_pk_bf16_f32 v12, v104, v105
    v_lshlrev_b32 v104, 16, v12
    v_and_b32 v105, 0xffff0000, v12
    v_lshlrev_b32 v12, 16, v20
    v_and_b32 v13, 0xffff0000, v20
    v_add_f32 v104, v104, v12
    v_add_f32 v105, v105, v13
    v_cvt_pk_bf16_f32 v12, v106, v107
    v_lshlrev_b32 v106, 16, v12
    v_and_b32 v107, 0xffff0000, v12
    v_lshlrev_b32 v12, 16, v21
    v_and_b32 v13, 0xffff0000, v21
    v_add_f32 v106, v106, v12
    v_add_f32 v107, v107, v13
    v_cvt_pk_bf16_f32 v28, v104, v105
    v_cvt_pk_bf16_f32 v29, v106, v107
    buffer_store_dwordx2 v[28:29], v10, s[16:19], s24 offen offset:64
    v_cvt_pk_bf16_f32 v12, v108, v109
    v_lshlrev_b32 v108, 16, v12
    v_and_b32 v109, 0xffff0000, v12
    v_lshlrev_b32 v12, 16, v22
    v_and_b32 v13, 0xffff0000, v22
    v_add_f32 v108, v108, v12
    v_add_f32 v109, v109, v13
    v_cvt_pk_bf16_f32 v12, v110, v111
    v_lshlrev_b32 v110, 16, v12
    v_and_b32 v111, 0xffff0000, v12
    v_lshlrev_b32 v12, 16, v23
    v_and_b32 v13, 0xffff0000, v23
    v_add_f32 v110, v110, v12
    v_add_f32 v111, v111, v13
    v_cvt_pk_bf16_f32 v30, v108, v109
    v_cvt_pk_bf16_f32 v31, v110, v111
    buffer_store_dwordx2 v[30:31], v10, s[16:19], s24 offen offset:96
    s_nop 1
    s_mov_b32 s24, 20480
    buffer_load_dwordx2 v[16:17], v10, s[44:47], s24 offen offset:0
    buffer_load_dwordx2 v[18:19], v10, s[44:47], s24 offen offset:32
    buffer_load_dwordx2 v[20:21], v10, s[44:47], s24 offen offset:64
    buffer_load_dwordx2 v[22:23], v10, s[44:47], s24 offen offset:96
    s_waitcnt vmcnt(0)
    v_cvt_pk_bf16_f32 v12, v112, v113
    v_lshlrev_b32 v112, 16, v12
    v_and_b32 v113, 0xffff0000, v12
    v_lshlrev_b32 v12, 16, v16
    v_and_b32 v13, 0xffff0000, v16
    v_add_f32 v112, v112, v12
    v_add_f32 v113, v113, v13
    v_cvt_pk_bf16_f32 v12, v114, v115
    v_lshlrev_b32 v114, 16, v12
    v_and_b32 v115, 0xffff0000, v12
    v_lshlrev_b32 v12, 16, v17
    v_and_b32 v13, 0xffff0000, v17
    v_add_f32 v114, v114, v12
    v_add_f32 v115, v115, v13
    v_cvt_pk_bf16_f32 v24, v112, v113
    v_cvt_pk_bf16_f32 v25, v114, v115
    buffer_store_dwordx2 v[24:25], v10, s[16:19], s24 offen offset:0
    v_cvt_pk_bf16_f32 v12, v116, v117
    v_lshlrev_b32 v116, 16, v12
    v_and_b32 v117, 0xffff0000, v12
    v_lshlrev_b32 v12, 16, v18
    v_and_b32 v13, 0xffff0000, v18
    v_add_f32 v116, v116, v12
    v_add_f32 v117, v117, v13
    v_cvt_pk_bf16_f32 v12, v118, v119
    v_lshlrev_b32 v118, 16, v12
    v_and_b32 v119, 0xffff0000, v12
    v_lshlrev_b32 v12, 16, v19
    v_and_b32 v13, 0xffff0000, v19
    v_add_f32 v118, v118, v12
    v_add_f32 v119, v119, v13
    v_cvt_pk_bf16_f32 v26, v116, v117
    v_cvt_pk_bf16_f32 v27, v118, v119
    buffer_store_dwordx2 v[26:27], v10, s[16:19], s24 offen offset:32
    v_cvt_pk_bf16_f32 v12, v120, v121
    v_lshlrev_b32 v120, 16, v12
    v_and_b32 v121, 0xffff0000, v12
    v_lshlrev_b32 v12, 16, v20
    v_and_b32 v13, 0xffff0000, v20
    v_add_f32 v120, v120, v12
    v_add_f32 v121, v121, v13
    v_cvt_pk_bf16_f32 v12, v122, v123
    v_lshlrev_b32 v122, 16, v12
    v_and_b32 v123, 0xffff0000, v12
    v_lshlrev_b32 v12, 16, v21
    v_and_b32 v13, 0xffff0000, v21
    v_add_f32 v122, v122, v12
    v_add_f32 v123, v123, v13
    v_cvt_pk_bf16_f32 v28, v120, v121
    v_cvt_pk_bf16_f32 v29, v122, v123
    buffer_store_dwordx2 v[28:29], v10, s[16:19], s24 offen offset:64
    v_cvt_pk_bf16_f32 v12, v124, v125
    v_lshlrev_b32 v124, 16, v12
    v_and_b32 v125, 0xffff0000, v12
    v_lshlrev_b32 v12, 16, v22
    v_and_b32 v13, 0xffff0000, v22
    v_add_f32 v124, v124, v12
    v_add_f32 v125, v125, v13
    v_cvt_pk_bf16_f32 v12, v126, v127
    v_lshlrev_b32 v126, 16, v12
    v_and_b32 v127, 0xffff0000, v12
    v_lshlrev_b32 v12, 16, v23
    v_and_b32 v13, 0xffff0000, v23
    v_add_f32 v126, v126, v12
    v_add_f32 v127, v127, v13
    v_cvt_pk_bf16_f32 v30, v124, v125
    v_cvt_pk_bf16_f32 v31, v126, v127
    buffer_store_dwordx2 v[30:31], v10, s[16:19], s24 offen offset:96
    s_nop 1
p6_end:
    s_endpgm
.section .rodata,"a"
.p2align 6
.amdhsa_kernel p6_kernel
  .amdhsa_next_free_vgpr 160
  .amdhsa_next_free_sgpr 102
  .amdhsa_accum_offset 160
  .amdhsa_group_segment_fixed_size 0
  .amdhsa_kernarg_size 112
  .amdhsa_user_sgpr_count 2
  .amdhsa_user_sgpr_kernarg_segment_ptr 1
  .amdhsa_system_sgpr_workgroup_id_x 1
  .amdhsa_float_denorm_mode_32 3
.end_amdhsa_kernel
```
